```python
import torch

def _softmax(x, axis=-1):
    return torch.softmax(x, dim=axis)
def _gelu(x):
    return torch.nn.functional.gelu(x, approximate="tanh")
def _silu(x):
    return torch.nn.functional.silu(x)
def _sigmoid(x):
    return torch.sigmoid(x)
def _layernorm(x, axis=-1, eps=1e-5):
    m = x.mean(dim=axis, keepdim=True)
    v = x.var(dim=axis, keepdim=True, unbiased=False)
    return (x - m) / torch.sqrt(v + eps)
def _scatter_add(tgt, idx, src, axis=0):
    return tgt.clone().index_add_(axis, idx, src)
def _segment_sum(src, seg, n):
    out = torch.zeros((n,) + src.shape[1:], dtype=src.dtype)
    return out.index_add_(0, seg, src)
def _pad(x, pw):
    flat = tuple(v for pair in reversed(pw) for v in pair)
    return torch.nn.functional.pad(x, flat)

kernel_name = 'concat_heads__linear_attn_block__sliding_block__prompt'

def setup_inputs():

    _w = (lambda a: (lambda t: t.to(torch.bfloat16) if t.is_floating_point() else t)(torch.as_tensor(a)))
    def _A_setup():
        B, S, D = 1, 2048, 640
        return {
            "x": _w((lambda *s: torch.randn(*s, dtype=torch.bfloat16) * 0.05)(B, S, D)),
            "wqkv": _w((lambda *s: torch.randn(*s, dtype=torch.bfloat16) * 1.6)(D, 3 * D)),
            "wo": _w((lambda *s: torch.randn(*s, dtype=torch.bfloat16) * 0.8)(D, D)),
        }
    _A_in = _A_setup()

    def _B_setup():
        B, S, D = 1, 2048, 640
        return {
            "x": _w((lambda *s: torch.randn(*s, dtype=torch.bfloat16) * 0.2)(B, S, D)),
            "wqkv": _w((lambda *s: torch.randn(*s, dtype=torch.bfloat16) * 0.2)(D, 3 * D)),
            "wo": _w((lambda *s: torch.randn(*s, dtype=torch.bfloat16) * 0.05)(D, D)),
        }
    _B_in = _B_setup()

    return {
        "A_x": _A_in["x"],
        "A_wqkv": _A_in["wqkv"],
        "A_wo": _A_in["wo"],
        "B_x": _B_in["x"],
        "B_wqkv": _B_in["wqkv"],
        "B_wo": _B_in["wo"],
    }

def reference(A_x, A_wqkv, A_wo, B_x, B_wqkv, B_wo):
    def _A_ref(x, wqkv, wo):
        B, S, D = x.shape
        H = 32; Dh = D // H
        qkv = (lambda x, *d: x.permute(*d))((x @ wqkv).reshape(B, S, 3, H, Dh), 2, 0, 3, 1, 4)
        q, k, v = qkv[0], qkv[1], qkv[2]
        phi = lambda t: torch.where(t > 0, t + 1, torch.exp(t)) + 1e-6
        pq, pk = phi(q), phi(k)
        kv = torch.einsum("bhsd,bhse->bhde", pk, v)
        z = torch.einsum("bhsd->bhd", pk)
        num = torch.einsum("bhqd,bhde->bhqe", pq, kv)
        den = torch.einsum("bhqd,bhd->bhq", pq, z)[..., None] + 1e-6
        o = num / den
        return (lambda x, *d: x.permute(*d))(o, 0, 2, 1, 3).reshape(B, S, D) @ wo

    def _B_ref(x, wqkv, wo):
        B, S, D = x.shape
        H = 32; Dh = D // H; W = 256
        qkv = (lambda x, *d: x.permute(*d))((x @ wqkv).reshape(B, S, 3, H, Dh), 2, 0, 3, 1, 4)
        q, k, v = qkv[0], qkv[1], qkv[2]
        scores = torch.einsum("bhqd,bhkd->bhqk", q, k) * (Dh ** -0.5)
        idx = torch.arange(S)
        mask = (idx[:, None] - idx[None, :] >= 0) & (idx[:, None] - idx[None, :] < W)
        scores = torch.where(mask[None, None], scores, -1e9)
        p = _softmax(scores, axis=-1)
        o = torch.einsum("bhqk,bhkd->bhqd", p, v)
        return (lambda x, *d: x.permute(*d))(o, 0, 2, 1, 3).reshape(B, S, D) @ wo

    a = _A_ref(A_x, A_wqkv, A_wo)
    b = _B_ref(B_x, B_wqkv, B_wo)
    return torch.concatenate([a, b], axis=-1)
```

```asm
; @launch grid=(256,1,1) block=(768,1,1) lds=159744
.amdgcn_target "amdgcn-amd-amdhsa--gfx950"
.text
.globl concat_heads__linear_attn_block__sliding_block__prompt_kernel
.p2align 8
.type concat_heads__linear_attn_block__sliding_block__prompt_kernel,@function
concat_heads__linear_attn_block__sliding_block__prompt_kernel:
    s_cmp_ge_u32 s2, 256
    s_cbranch_scc1 k1_end_2
    s_load_dwordx4 s[4:7], s[0:1], 0
    s_load_dwordx4 s[44:47], s[0:1], 24
    s_load_dwordx2 s[28:29], s[0:1], 64
    s_load_dwordx2 s[96:97], s[0:1], 56
    s_and_b32 s3, s2, 7
    s_lshr_b32 s30, s2, 3
    s_lshr_b32 s31, s3, 2
    s_and_b32 s20, s3, 1
    s_lshl_b32 s20, s20, 2
    s_and_b32 s23, s30, 3
    s_add_u32 s20, s20, s23
    s_lshr_b32 s38, s3, 1
    s_and_b32 s38, s38, 1
    s_lshr_b32 s34, s30, 2
    s_mov_b32 s62, s34
    v_lshrrev_b32 v13, 6, v0
    v_and_b32 v1, 63, v0
    s_cmp_eq_u32 s31, 0
    s_cbranch_scc0 k1_decB_3
    s_lshl_b32 s24, s38, 2
    s_sub_u32 s23, 12, s24
    s_mul_i32 s25, s38, 3
    s_add_u32 s21, s34, s25
    s_mov_b32 s61, 0
    s_cmp_lt_u32 s30, s23
    s_cbranch_scc1 k1_decAq_5
    s_sub_u32 s25, s30, s23
    s_mul_i32 s23, s25, 52
    s_lshr_b32 s23, s23, 8
    s_add_u32 s21, s24, s23
    s_mul_i32 s23, s23, 5
    s_sub_u32 s23, s25, s23
    s_and_b32 s20, s3, 1
    s_mul_i32 s20, s20, 5
    s_add_u32 s20, s20, s23
    s_cmp_ge_u32 s25, 20
    s_cselect_b32 s61, 2, 1
k1_decAq_5:
    s_mul_i32 s50, s38, 6
    s_lshl_b32 s24, s38, 1
    s_sub_u32 s51, 6, s24
    s_add_u32 s52, s38, 4
    s_add_u32 s53, s51, 5
    s_bitcmp1_b32 s3, 0
    s_cselect_b32 s54, 32, 35
    s_branch k1_dec_4
k1_decB_3:
    s_lshl_b32 s21, s38, 3
    s_add_u32 s21, s21, s34
    s_cmp_ge_u32 s21, 15
    s_cselect_b32 s61, 2, 0
    s_lshl_b32 s50, s38, 4
    s_mov_b32 s51, 16
    s_mov_b32 s52, 0
    s_mov_b32 s53, 16
    s_mov_b32 s54, 32
k1_dec_4:
    v_readfirstlane_b32 s22, v13
    v_mov_b32 v2, 0x7f000000
    v_mov_b32 v3, 0x7f000000
    s_cmp_ge_u32 s22, 8
    s_cbranch_scc1 k1_early_6
    s_and_b32 s23, s3, 1
    s_lshl_b32 s23, s23, 10
    s_mul_i32 s24, s30, s54
    s_add_u32 s23, s23, s24
    v_add_u32 v13, s23, v1
    v_mul_u32_u24 v13, 1280, v13
    v_mov_b32 v14, 0x7f000000
    v_cmp_gt_u32 s[48:49], s54, v1
    s_nop 1
    v_cndmask_b32 v2, v14, v13, s[48:49]
    v_cmp_gt_u32 s[48:49], 32, v1
    v_and_b32 v15, 15, v1
    v_add_u32 v13, s50, v15
    v_mov_b32 v16, s52
    v_cmp_le_u32 s[36:37], s51, v15
    s_nop 1
    v_cndmask_b32 v16, 0, v16, s[36:37]
    v_cmp_le_u32 s[36:37], s53, v15
    s_nop 1
    v_cndmask_b32 v17, 0, 5, s[36:37]
    v_add3_u32 v13, v13, v16, v17
    v_lshlrev_b32 v13, 7, v13
    v_bfe_u32 v15, v1, 4, 1
    s_lshl_b32 s24, s30, 1
    v_add_u32 v15, s24, v15
    v_mul_u32_u24 v15, 3840, v15
    v_add_u32 v13, v13, v15
    v_cndmask_b32 v3, v13, v14, s[48:49]
k1_early_6:
    s_waitcnt lgkmcnt(0)
    s_cmp_eq_u32 s31, 0
    s_cselect_b32 s4, s4, s44
    s_cselect_b32 s5, s5, s45
    s_cselect_b32 s6, s6, s46
    s_cselect_b32 s7, s7, s47
    s_mov_b32 s8, s4
    s_mov_b32 s9, s5
    s_mov_b32 s10, 2621440
    s_mov_b32 s11, 0x20000
    s_mov_b32 s12, s6
    s_mov_b32 s13, s7
    s_mov_b32 s14, 2457600
    s_mov_b32 s15, 0x20000
    s_mov_b32 s16, s28
    s_mov_b32 s17, s29
    s_mov_b32 s18, 16809984
    s_mov_b32 s19, 0x20000
    s_mov_b32 s98, 256
    s_mov_b32 s99, 0x20000
    s_cmp_lg_u32 s22, 7
    s_cbranch_scc1 k1_noreset_7
    s_lshr_b32 s23, s2, 6
    s_lshl_b32 s23, s23, 3
    s_add_u32 s23, s23, s3
    s_and_b32 s24, s30, 7
    s_lshl_b32 s24, s24, 5
    s_add_u32 s23, s23, s24
    v_mov_b32 v14, s23
    v_add_u32 v15, 256, v14
    v_cmp_eq_u32 s[36:37], 1, v1
    s_nop 1
    v_cndmask_b32 v14, v14, v15, s[36:37]
    s_add_u32 s24, s2, 512
    v_mov_b32 v15, s24
    v_cmp_eq_u32 s[36:37], 2, v1
    s_nop 1
    v_cndmask_b32 v14, v14, v15, s[36:37]
    v_lshlrev_b32 v14, 7, v14
    v_add_u32 v14, 16711680, v14
    v_mov_b32 v15, 0
    s_mov_b64 exec, 7
    buffer_store_dword v15, v14, s[16:19], 0 offen sc1
    s_mov_b64 exec, 1
    s_lshl_b32 s24, s3, 5
    v_mov_b32 v14, s24
    v_mov_b32 v15, 1
    s_waitcnt vmcnt(0)
    buffer_atomic_add v15, v14, s[96:99], 0 offen
    s_mov_b64 exec, -1
k1_noreset_7:
    s_cmp_eq_u32 s61, 2
    s_cbranch_scc1 k1_spare_8
    s_cmp_lt_u32 s22, 8
    s_cbranch_scc1 k1_mfma_9
    s_cmp_eq_u32 s61, 1
    s_cbranch_scc1 k1_ldkv_10
    s_sub_u32 s24, s22, 8
    s_mov_b32 s63, s24
    v_lshrrev_b32 v13, 3, v1
    v_and_b32 v14, 7, v1
    v_lshrrev_b32 v15, 1, v13
    v_xor_b32 v14, v14, v15
    s_mul_i32 s23, s20, 256
    s_mul_i32 s25, s24, 64
    s_add_u32 s23, s23, s25
    v_add_u32 v13, s23, v13
    v_mul_u32_u24 v13, 1280, v13
    v_lshl_add_u32 v2, v14, 4, v13
    s_mul_i32 s26, s24, 8192
    s_add_u32 s26, s26, 61440
    v_xor_b32 v3, 64, v2
    s_and_b32 s42, s20, 3
    s_mul_i32 s42, s42, 3
    s_add_u32 s42, s42, s62
    s_cmp_ge_u32 s42, 10
    s_cselect_b32 s43, 10, 0
    s_sub_u32 s42, s42, s43
    s_mov_b32 s42, 0
    s_lshl_b32 s44, s42, 7
    s_mul_i32 s45, s42, 245760
    s_add_u32 s42, s42, 1
    s_cmp_eq_u32 s42, 10
    s_cselect_b32 s42, 0, s42
    s_add_u32 m0, s26, 0
    s_add_u32 s35, s44, 0
    buffer_load_dwordx4 v2, s[8:11], s35 offen lds
    s_add_u32 m0, s26, 1024
    s_add_u32 s35, s44, 10240
    buffer_load_dwordx4 v3, s[8:11], s35 offen lds
    s_add_u32 m0, s26, 2048
    s_add_u32 s35, s44, 20480
    buffer_load_dwordx4 v2, s[8:11], s35 offen lds
    s_add_u32 m0, s26, 3072
    s_add_u32 s35, s44, 30720
    buffer_load_dwordx4 v3, s[8:11], s35 offen lds
    s_add_u32 m0, s26, 4096
    s_add_u32 s35, s44, 40960
    buffer_load_dwordx4 v2, s[8:11], s35 offen lds
    s_add_u32 m0, s26, 5120
    s_add_u32 s35, s44, 51200
    buffer_load_dwordx4 v3, s[8:11], s35 offen lds
    s_add_u32 m0, s26, 6144
    s_add_u32 s35, s44, 61440
    buffer_load_dwordx4 v2, s[8:11], s35 offen lds
    s_add_u32 m0, s26, 7168
    s_add_u32 s35, s44, 71680
    buffer_load_dwordx4 v3, s[8:11], s35 offen lds
    v_lshrrev_b32 v13, 4, v1
    v_lshlrev_b32 v14, 1, v13
    v_and_b32 v15, 15, v1
    v_xor_b32 v14, v14, v15
    s_lshl_b32 s25, s24, 4
    v_add_u32 v13, s25, v13
    v_mul_u32_u24 v13, 3840, v13
    v_lshl_add_u32 v13, v14, 4, v13
    s_lshl_b32 s25, s21, 8
    v_add_u32 v4, s25, v13
    v_xor_b32 v5, 128, v4
    s_lshl_b32 s27, s24, 12
    s_add_u32 s27, s27, 0
    s_add_u32 m0, s27, 0
    s_nop 0
    buffer_load_dwordx4 v4, s[12:15], s45 offen lds
    s_add_u32 m0, s27, 1024
    s_add_u32 s35, s45, 15360
    buffer_load_dwordx4 v4, s[12:15], s35 offen lds
    s_add_u32 m0, s27, 2048
    s_add_u32 s35, s45, 30720
    buffer_load_dwordx4 v5, s[12:15], s35 offen lds
    s_add_u32 m0, s27, 3072
    s_add_u32 s35, s45, 46080
    buffer_load_dwordx4 v5, s[12:15], s35 offen lds
    s_lshl_b32 s44, s42, 7
    s_mul_i32 s45, s42, 245760
    s_add_u32 s42, s42, 1
    s_cmp_eq_u32 s42, 10
    s_cselect_b32 s42, 0, s42
    s_add_u32 m0, s27, 16384
    s_nop 0
    buffer_load_dwordx4 v4, s[12:15], s45 offen lds
    s_add_u32 m0, s26, 32768
    s_add_u32 s35, s44, 0
    buffer_load_dwordx4 v2, s[8:11], s35 offen lds
    s_add_u32 m0, s26, 33792
    s_add_u32 s35, s44, 10240
    buffer_load_dwordx4 v3, s[8:11], s35 offen lds
    s_add_u32 m0, s27, 17408
    s_add_u32 s35, s45, 15360
    buffer_load_dwordx4 v4, s[12:15], s35 offen lds
    s_add_u32 m0, s26, 34816
    s_add_u32 s35, s44, 20480
    buffer_load_dwordx4 v2, s[8:11], s35 offen lds
    s_add_u32 m0, s26, 35840
    s_add_u32 s35, s44, 30720
    buffer_load_dwordx4 v3, s[8:11], s35 offen lds
    s_add_u32 m0, s27, 18432
    s_add_u32 s35, s45, 30720
    buffer_load_dwordx4 v5, s[12:15], s35 offen lds
    s_add_u32 m0, s26, 36864
    s_add_u32 s35, s44, 40960
    buffer_load_dwordx4 v2, s[8:11], s35 offen lds
    s_add_u32 m0, s26, 37888
    s_add_u32 s35, s44, 51200
    buffer_load_dwordx4 v3, s[8:11], s35 offen lds
    s_add_u32 m0, s27, 19456
    s_add_u32 s35, s45, 46080
    buffer_load_dwordx4 v5, s[12:15], s35 offen lds
    s_add_u32 m0, s26, 38912
    s_add_u32 s35, s44, 61440
    buffer_load_dwordx4 v2, s[8:11], s35 offen lds
    s_add_u32 m0, s26, 39936
    s_add_u32 s35, s44, 71680
    buffer_load_dwordx4 v3, s[8:11], s35 offen lds
    s_and_b32 s23, s3, 1
    s_lshl_b32 s23, s23, 10
    s_mul_i32 s24, s30, s54
    s_add_u32 s23, s23, s24
    v_add_u32 v13, s23, v1
    v_mul_u32_u24 v13, 1280, v13
    v_mov_b32 v14, 0x7f000000
    v_cmp_gt_u32 s[48:49], s54, v1
    s_nop 1
    v_cndmask_b32 v10, v14, v13, s[48:49]
    v_cmp_gt_u32 s[48:49], 32, v1
    v_and_b32 v15, 15, v1
    v_add_u32 v13, s50, v15
    v_mov_b32 v16, s52
    v_cmp_le_u32 s[36:37], s51, v15
    s_nop 1
    v_cndmask_b32 v16, 0, v16, s[36:37]
    v_cmp_le_u32 s[36:37], s53, v15
    s_nop 1
    v_cndmask_b32 v17, 0, 5, s[36:37]
    v_add3_u32 v13, v13, v16, v17
    v_lshlrev_b32 v13, 7, v13
    v_bfe_u32 v15, v1, 4, 1
    s_lshl_b32 s24, s30, 1
    v_add_u32 v15, s24, v15
    v_mul_u32_u24 v15, 3840, v15
    v_add_u32 v13, v13, v15
    v_cndmask_b32 v11, v13, v14, s[48:49]
    s_bitcmp1_b32 s63, 1
    s_cselect_b32 s60, 1, 0
    s_waitcnt vmcnt(12)
    s_barrier
    s_lshl_b32 s44, s42, 7
    s_mul_i32 s45, s42, 245760
    s_add_u32 s42, s42, 1
    s_cmp_eq_u32 s42, 10
    s_cselect_b32 s42, 0, s42
    s_add_u32 m0, s27, 32768
    s_nop 0
    buffer_load_dwordx4 v4, s[12:15], s45 offen lds
    s_add_u32 m0, s26, 65536
    s_add_u32 s35, s44, 0
    buffer_load_dwordx4 v2, s[8:11], s35 offen lds
    s_add_u32 m0, s26, 66560
    s_add_u32 s35, s44, 10240
    buffer_load_dwordx4 v3, s[8:11], s35 offen lds
    s_add_u32 m0, s27, 33792
    s_add_u32 s35, s45, 15360
    buffer_load_dwordx4 v4, s[12:15], s35 offen lds
    s_add_u32 m0, s26, 67584
    s_add_u32 s35, s44, 20480
    buffer_load_dwordx4 v2, s[8:11], s35 offen lds
    s_add_u32 m0, s26, 68608
    s_add_u32 s35, s44, 30720
    buffer_load_dwordx4 v3, s[8:11], s35 offen lds
    s_add_u32 m0, s27, 34816
    s_add_u32 s35, s45, 30720
    buffer_load_dwordx4 v5, s[12:15], s35 offen lds
    s_add_u32 m0, s26, 69632
    s_add_u32 s35, s44, 40960
    buffer_load_dwordx4 v2, s[8:11], s35 offen lds
    s_add_u32 m0, s26, 70656
    s_add_u32 s35, s44, 51200
    buffer_load_dwordx4 v3, s[8:11], s35 offen lds
    s_add_u32 m0, s27, 35840
    s_add_u32 s35, s45, 46080
    buffer_load_dwordx4 v5, s[12:15], s35 offen lds
    s_add_u32 m0, s26, 71680
    s_add_u32 s35, s44, 61440
    buffer_load_dwordx4 v2, s[8:11], s35 offen lds
    s_add_u32 m0, s26, 72704
    s_add_u32 s35, s44, 71680
    buffer_load_dwordx4 v3, s[8:11], s35 offen lds
    s_waitcnt vmcnt(12)
    s_barrier
    s_lshl_b32 s44, s42, 7
    s_mul_i32 s45, s42, 245760
    s_add_u32 s42, s42, 1
    s_cmp_eq_u32 s42, 10
    s_cselect_b32 s42, 0, s42
    s_add_u32 m0, s27, 0
    s_nop 0
    buffer_load_dwordx4 v4, s[12:15], s45 offen lds
    s_add_u32 m0, s26, 0
    s_add_u32 s35, s44, 0
    buffer_load_dwordx4 v2, s[8:11], s35 offen lds
    s_add_u32 m0, s26, 1024
    s_add_u32 s35, s44, 10240
    buffer_load_dwordx4 v3, s[8:11], s35 offen lds
    s_add_u32 m0, s27, 1024
    s_add_u32 s35, s45, 15360
    buffer_load_dwordx4 v4, s[12:15], s35 offen lds
    s_add_u32 m0, s26, 2048
    s_add_u32 s35, s44, 20480
    buffer_load_dwordx4 v2, s[8:11], s35 offen lds
    s_add_u32 m0, s26, 3072
    s_add_u32 s35, s44, 30720
    buffer_load_dwordx4 v3, s[8:11], s35 offen lds
    s_add_u32 m0, s27, 2048
    s_add_u32 s35, s45, 30720
    buffer_load_dwordx4 v5, s[12:15], s35 offen lds
    s_add_u32 m0, s26, 4096
    s_add_u32 s35, s44, 40960
    buffer_load_dwordx4 v2, s[8:11], s35 offen lds
    s_add_u32 m0, s26, 5120
    s_add_u32 s35, s44, 51200
    buffer_load_dwordx4 v3, s[8:11], s35 offen lds
    s_add_u32 m0, s27, 3072
    s_add_u32 s35, s45, 46080
    buffer_load_dwordx4 v5, s[12:15], s35 offen lds
    s_add_u32 m0, s26, 6144
    s_add_u32 s35, s44, 61440
    buffer_load_dwordx4 v2, s[8:11], s35 offen lds
    s_add_u32 m0, s26, 7168
    s_add_u32 s35, s44, 71680
    buffer_load_dwordx4 v3, s[8:11], s35 offen lds
    s_add_u32 s59, s60, 4
    s_bitcmp1_b32 s63, 0
    s_cbranch_scc1 k1_ltw_12
    s_lshl_b32 s35, s59, 7
    buffer_load_dword v12, v10, s[8:11], s35 offen
    s_branch k1_ltj_13
k1_ltw_12:
    s_mul_i32 s35, s59, 245760
    buffer_load_dword v12, v11, s[12:15], s35 offen
k1_ltj_13:
    s_waitcnt vmcnt(13)
    s_barrier
    s_lshl_b32 s44, s42, 7
    s_mul_i32 s45, s42, 245760
    s_add_u32 s42, s42, 1
    s_cmp_eq_u32 s42, 10
    s_cselect_b32 s42, 0, s42
    s_add_u32 m0, s27, 16384
    s_nop 0
    buffer_load_dwordx4 v4, s[12:15], s45 offen lds
    s_add_u32 m0, s26, 32768
    s_add_u32 s35, s44, 0
    buffer_load_dwordx4 v2, s[8:11], s35 offen lds
    s_add_u32 m0, s26, 33792
    s_add_u32 s35, s44, 10240
    buffer_load_dwordx4 v3, s[8:11], s35 offen lds
    s_add_u32 m0, s27, 17408
    s_add_u32 s35, s45, 15360
    buffer_load_dwordx4 v4, s[12:15], s35 offen lds
    s_add_u32 m0, s26, 34816
    s_add_u32 s35, s44, 20480
    buffer_load_dwordx4 v2, s[8:11], s35 offen lds
    s_add_u32 m0, s26, 35840
    s_add_u32 s35, s44, 30720
    buffer_load_dwordx4 v3, s[8:11], s35 offen lds
    s_add_u32 m0, s27, 18432
    s_add_u32 s35, s45, 30720
    buffer_load_dwordx4 v5, s[12:15], s35 offen lds
    s_add_u32 m0, s26, 36864
    s_add_u32 s35, s44, 40960
    buffer_load_dwordx4 v2, s[8:11], s35 offen lds
    s_add_u32 m0, s26, 37888
    s_add_u32 s35, s44, 51200
    buffer_load_dwordx4 v3, s[8:11], s35 offen lds
    s_add_u32 m0, s27, 19456
    s_add_u32 s35, s45, 46080
    buffer_load_dwordx4 v5, s[12:15], s35 offen lds
    s_add_u32 m0, s26, 38912
    s_add_u32 s35, s44, 61440
    buffer_load_dwordx4 v2, s[8:11], s35 offen lds
    s_add_u32 m0, s26, 39936
    s_add_u32 s35, s44, 71680
    buffer_load_dwordx4 v3, s[8:11], s35 offen lds
    s_waitcnt vmcnt(13)
    s_barrier
    s_lshl_b32 s44, s42, 7
    s_mul_i32 s45, s42, 245760
    s_add_u32 s42, s42, 1
    s_cmp_eq_u32 s42, 10
    s_cselect_b32 s42, 0, s42
    s_add_u32 m0, s27, 32768
    s_nop 0
    buffer_load_dwordx4 v4, s[12:15], s45 offen lds
    s_add_u32 m0, s26, 65536
    s_add_u32 s35, s44, 0
    buffer_load_dwordx4 v2, s[8:11], s35 offen lds
    s_add_u32 m0, s26, 66560
    s_add_u32 s35, s44, 10240
    buffer_load_dwordx4 v3, s[8:11], s35 offen lds
    s_add_u32 m0, s27, 33792
    s_add_u32 s35, s45, 15360
    buffer_load_dwordx4 v4, s[12:15], s35 offen lds
    s_add_u32 m0, s26, 67584
    s_add_u32 s35, s44, 20480
    buffer_load_dwordx4 v2, s[8:11], s35 offen lds
    s_add_u32 m0, s26, 68608
    s_add_u32 s35, s44, 30720
    buffer_load_dwordx4 v3, s[8:11], s35 offen lds
    s_add_u32 m0, s27, 34816
    s_add_u32 s35, s45, 30720
    buffer_load_dwordx4 v5, s[12:15], s35 offen lds
    s_add_u32 m0, s26, 69632
    s_add_u32 s35, s44, 40960
    buffer_load_dwordx4 v2, s[8:11], s35 offen lds
    s_add_u32 m0, s26, 70656
    s_add_u32 s35, s44, 51200
    buffer_load_dwordx4 v3, s[8:11], s35 offen lds
    s_add_u32 m0, s27, 35840
    s_add_u32 s35, s45, 46080
    buffer_load_dwordx4 v5, s[12:15], s35 offen lds
    s_add_u32 m0, s26, 71680
    s_add_u32 s35, s44, 61440
    buffer_load_dwordx4 v2, s[8:11], s35 offen lds
    s_add_u32 m0, s26, 72704
    s_add_u32 s35, s44, 71680
    buffer_load_dwordx4 v3, s[8:11], s35 offen lds
    s_add_u32 s59, s60, 6
    s_bitcmp1_b32 s63, 0
    s_cbranch_scc1 k1_ltw_14
    s_lshl_b32 s35, s59, 7
    buffer_load_dword v12, v10, s[8:11], s35 offen
    s_branch k1_ltj_15
k1_ltw_14:
    s_mul_i32 s35, s59, 245760
    buffer_load_dword v12, v11, s[12:15], s35 offen
k1_ltj_15:
    s_waitcnt vmcnt(13)
    s_barrier
    s_lshl_b32 s44, s42, 7
    s_mul_i32 s45, s42, 245760
    s_add_u32 s42, s42, 1
    s_cmp_eq_u32 s42, 10
    s_cselect_b32 s42, 0, s42
    s_add_u32 m0, s27, 0
    s_nop 0
    buffer_load_dwordx4 v4, s[12:15], s45 offen lds
    s_add_u32 m0, s26, 0
    s_add_u32 s35, s44, 0
    buffer_load_dwordx4 v2, s[8:11], s35 offen lds
    s_add_u32 m0, s26, 1024
    s_add_u32 s35, s44, 10240
    buffer_load_dwordx4 v3, s[8:11], s35 offen lds
    s_add_u32 m0, s27, 1024
    s_add_u32 s35, s45, 15360
    buffer_load_dwordx4 v4, s[12:15], s35 offen lds
    s_add_u32 m0, s26, 2048
    s_add_u32 s35, s44, 20480
    buffer_load_dwordx4 v2, s[8:11], s35 offen lds
    s_add_u32 m0, s26, 3072
    s_add_u32 s35, s44, 30720
    buffer_load_dwordx4 v3, s[8:11], s35 offen lds
    s_add_u32 m0, s27, 2048
    s_add_u32 s35, s45, 30720
    buffer_load_dwordx4 v5, s[12:15], s35 offen lds
    s_add_u32 m0, s26, 4096
    s_add_u32 s35, s44, 40960
    buffer_load_dwordx4 v2, s[8:11], s35 offen lds
    s_add_u32 m0, s26, 5120
    s_add_u32 s35, s44, 51200
    buffer_load_dwordx4 v3, s[8:11], s35 offen lds
    s_add_u32 m0, s27, 3072
    s_add_u32 s35, s45, 46080
    buffer_load_dwordx4 v5, s[12:15], s35 offen lds
    s_add_u32 m0, s26, 6144
    s_add_u32 s35, s44, 61440
    buffer_load_dwordx4 v2, s[8:11], s35 offen lds
    s_add_u32 m0, s26, 7168
    s_add_u32 s35, s44, 71680
    buffer_load_dwordx4 v3, s[8:11], s35 offen lds
    s_waitcnt vmcnt(13)
    s_barrier
    s_lshl_b32 s44, s42, 7
    s_mul_i32 s45, s42, 245760
    s_add_u32 s42, s42, 1
    s_cmp_eq_u32 s42, 10
    s_cselect_b32 s42, 0, s42
    s_add_u32 m0, s27, 16384
    s_nop 0
    buffer_load_dwordx4 v4, s[12:15], s45 offen lds
    s_add_u32 m0, s26, 32768
    s_add_u32 s35, s44, 0
    buffer_load_dwordx4 v2, s[8:11], s35 offen lds
    s_add_u32 m0, s26, 33792
    s_add_u32 s35, s44, 10240
    buffer_load_dwordx4 v3, s[8:11], s35 offen lds
    s_add_u32 m0, s27, 17408
    s_add_u32 s35, s45, 15360
    buffer_load_dwordx4 v4, s[12:15], s35 offen lds
    s_add_u32 m0, s26, 34816
    s_add_u32 s35, s44, 20480
    buffer_load_dwordx4 v2, s[8:11], s35 offen lds
    s_add_u32 m0, s26, 35840
    s_add_u32 s35, s44, 30720
    buffer_load_dwordx4 v3, s[8:11], s35 offen lds
    s_add_u32 m0, s27, 18432
    s_add_u32 s35, s45, 30720
    buffer_load_dwordx4 v5, s[12:15], s35 offen lds
    s_add_u32 m0, s26, 36864
    s_add_u32 s35, s44, 40960
    buffer_load_dwordx4 v2, s[8:11], s35 offen lds
    s_add_u32 m0, s26, 37888
    s_add_u32 s35, s44, 51200
    buffer_load_dwordx4 v3, s[8:11], s35 offen lds
    s_add_u32 m0, s27, 19456
    s_add_u32 s35, s45, 46080
    buffer_load_dwordx4 v5, s[12:15], s35 offen lds
    s_add_u32 m0, s26, 38912
    s_add_u32 s35, s44, 61440
    buffer_load_dwordx4 v2, s[8:11], s35 offen lds
    s_add_u32 m0, s26, 39936
    s_add_u32 s35, s44, 71680
    buffer_load_dwordx4 v3, s[8:11], s35 offen lds
    s_add_u32 s59, s60, 8
    s_bitcmp1_b32 s63, 0
    s_cbranch_scc1 k1_ltw_16
    s_lshl_b32 s35, s59, 7
    buffer_load_dword v12, v10, s[8:11], s35 offen
    s_branch k1_ltj_17
k1_ltw_16:
    s_mul_i32 s35, s59, 245760
    buffer_load_dword v12, v11, s[12:15], s35 offen
k1_ltj_17:
    s_waitcnt vmcnt(13)
    s_barrier
    s_lshl_b32 s44, s42, 7
    s_mul_i32 s45, s42, 245760
    s_add_u32 s42, s42, 1
    s_cmp_eq_u32 s42, 10
    s_cselect_b32 s42, 0, s42
    s_add_u32 m0, s27, 32768
    s_nop 0
    buffer_load_dwordx4 v4, s[12:15], s45 offen lds
    s_add_u32 m0, s26, 65536
    s_add_u32 s35, s44, 0
    buffer_load_dwordx4 v2, s[8:11], s35 offen lds
    s_add_u32 m0, s26, 66560
    s_add_u32 s35, s44, 10240
    buffer_load_dwordx4 v3, s[8:11], s35 offen lds
    s_add_u32 m0, s27, 33792
    s_add_u32 s35, s45, 15360
    buffer_load_dwordx4 v4, s[12:15], s35 offen lds
    s_add_u32 m0, s26, 67584
    s_add_u32 s35, s44, 20480
    buffer_load_dwordx4 v2, s[8:11], s35 offen lds
    s_add_u32 m0, s26, 68608
    s_add_u32 s35, s44, 30720
    buffer_load_dwordx4 v3, s[8:11], s35 offen lds
    s_add_u32 m0, s27, 34816
    s_add_u32 s35, s45, 30720
    buffer_load_dwordx4 v5, s[12:15], s35 offen lds
    s_add_u32 m0, s26, 69632
    s_add_u32 s35, s44, 40960
    buffer_load_dwordx4 v2, s[8:11], s35 offen lds
    s_add_u32 m0, s26, 70656
    s_add_u32 s35, s44, 51200
    buffer_load_dwordx4 v3, s[8:11], s35 offen lds
    s_add_u32 m0, s27, 35840
    s_add_u32 s35, s45, 46080
    buffer_load_dwordx4 v5, s[12:15], s35 offen lds
    s_add_u32 m0, s26, 71680
    s_add_u32 s35, s44, 61440
    buffer_load_dwordx4 v2, s[8:11], s35 offen lds
    s_add_u32 m0, s26, 72704
    s_add_u32 s35, s44, 71680
    buffer_load_dwordx4 v3, s[8:11], s35 offen lds
    s_waitcnt vmcnt(13)
    s_barrier
    s_lshl_b32 s44, s42, 7
    s_mul_i32 s45, s42, 245760
    s_add_u32 s42, s42, 1
    s_cmp_eq_u32 s42, 10
    s_cselect_b32 s42, 0, s42
    s_add_u32 m0, s27, 0
    s_nop 0
    buffer_load_dwordx4 v4, s[12:15], s45 offen lds
    s_add_u32 m0, s26, 0
    s_add_u32 s35, s44, 0
    buffer_load_dwordx4 v2, s[8:11], s35 offen lds
    s_add_u32 m0, s26, 1024
    s_add_u32 s35, s44, 10240
    buffer_load_dwordx4 v3, s[8:11], s35 offen lds
    s_add_u32 m0, s27, 1024
    s_add_u32 s35, s45, 15360
    buffer_load_dwordx4 v4, s[12:15], s35 offen lds
    s_add_u32 m0, s26, 2048
    s_add_u32 s35, s44, 20480
    buffer_load_dwordx4 v2, s[8:11], s35 offen lds
    s_add_u32 m0, s26, 3072
    s_add_u32 s35, s44, 30720
    buffer_load_dwordx4 v3, s[8:11], s35 offen lds
    s_add_u32 m0, s27, 2048
    s_add_u32 s35, s45, 30720
    buffer_load_dwordx4 v5, s[12:15], s35 offen lds
    s_add_u32 m0, s26, 4096
    s_add_u32 s35, s44, 40960
    buffer_load_dwordx4 v2, s[8:11], s35 offen lds
    s_add_u32 m0, s26, 5120
    s_add_u32 s35, s44, 51200
    buffer_load_dwordx4 v3, s[8:11], s35 offen lds
    s_add_u32 m0, s27, 3072
    s_add_u32 s35, s45, 46080
    buffer_load_dwordx4 v5, s[12:15], s35 offen lds
    s_add_u32 m0, s26, 6144
    s_add_u32 s35, s44, 61440
    buffer_load_dwordx4 v2, s[8:11], s35 offen lds
    s_add_u32 m0, s26, 7168
    s_add_u32 s35, s44, 71680
    buffer_load_dwordx4 v3, s[8:11], s35 offen lds
    s_waitcnt vmcnt(12)
    s_barrier
    s_waitcnt vmcnt(0)
    s_barrier
    s_waitcnt vmcnt(0)
    s_cmp_lg_u32 s22, 8
    s_cbranch_scc1 k1_cnt0_18
    v_and_b32 v14, 7, v1
    v_lshlrev_b32 v14, 5, v14
    s_mov_b32 s24, 0
k1_cntp_19:
    buffer_load_dword v15, v14, s[96:99], 0 offen sc1
    s_add_u32 s24, s24, 1
    s_waitcnt vmcnt(0)
    v_cmp_gt_u32 s[46:47], 32, v15
    s_nop 1
    s_cmp_eq_u64 s[46:47], 0
    s_cbranch_scc1 k1_cntok_20
    s_sleep 4
    s_cmp_lt_u32 s24, 0x8000
    s_cbranch_scc1 k1_cntp_19
k1_cntok_20:
k1_cnt0_18:
    s_load_dwordx4 s[88:91], s[0:1], 40
    s_load_dwordx2 s[86:87], s[0:1], 16
    s_barrier
    s_branch phase2_1
k1_ldkv_10:
    s_sub_u32 s24, s22, 8
    s_mov_b32 s63, s24
    v_lshrrev_b32 v13, 3, v1
    v_and_b32 v14, 7, v1
    v_lshrrev_b32 v15, 1, v13
    v_xor_b32 v14, v14, v15
    s_mul_i32 s23, s20, 224
    s_mul_i32 s25, s24, 56
    s_add_u32 s23, s23, s25
    v_add_u32 v13, s23, v13
    v_mul_u32_u24 v13, 1280, v13
    v_lshl_add_u32 v2, v14, 4, v13
    s_mul_i32 s26, s24, 7168
    s_add_u32 s26, s26, 61440
    s_and_b32 s25, s24, 1
    s_lshl_b32 s25, s25, 6
    v_xor_b32 v2, s25, v2
    v_xor_b32 v3, 64, v2
    s_and_b32 s42, s20, 3
    s_mul_i32 s42, s42, 3
    s_add_u32 s42, s42, s62
    s_cmp_ge_u32 s42, 10
    s_cselect_b32 s43, 10, 0
    s_sub_u32 s42, s42, s43
    s_mov_b32 s42, 0
    s_lshl_b32 s44, s42, 7
    s_mul_i32 s45, s42, 245760
    s_add_u32 s42, s42, 1
    s_cmp_eq_u32 s42, 10
    s_cselect_b32 s42, 0, s42
    s_add_u32 m0, s26, 0
    s_add_u32 s35, s44, 0
    buffer_load_dwordx4 v2, s[8:11], s35 offen lds
    s_add_u32 m0, s26, 1024
    s_add_u32 s35, s44, 10240
    buffer_load_dwordx4 v3, s[8:11], s35 offen lds
    s_add_u32 m0, s26, 2048
    s_add_u32 s35, s44, 20480
    buffer_load_dwordx4 v2, s[8:11], s35 offen lds
    s_add_u32 m0, s26, 3072
    s_add_u32 s35, s44, 30720
    buffer_load_dwordx4 v3, s[8:11], s35 offen lds
    s_add_u32 m0, s26, 4096
    s_add_u32 s35, s44, 40960
    buffer_load_dwordx4 v2, s[8:11], s35 offen lds
    s_add_u32 m0, s26, 5120
    s_add_u32 s35, s44, 51200
    buffer_load_dwordx4 v3, s[8:11], s35 offen lds
    s_add_u32 m0, s26, 6144
    s_add_u32 s35, s44, 61440
    buffer_load_dwordx4 v2, s[8:11], s35 offen lds
    s_mov_b32 s32, 0x98654310
    s_mov_b32 s33, 0x72
    s_mul_i32 s23, s21, 160
    s_add_u32 s23, s23, 1280
    s_lshl_b32 s25, s24, 4
    v_add_u32 v12, 0, v1
    v_mul_u32_u24 v13, 3277, v12
    v_lshrrev_b32 v13, 16, v13
    v_mul_u32_u24 v14, 20, v13
    v_sub_u32 v14, v12, v14
    v_lshrrev_b32 v15, 3, v13
    v_lshlrev_b32 v15, 1, v15
    v_xor_b32 v14, v14, v15
    v_cmp_le_u32 s[36:37], 10, v14
    s_nop 1
    v_cndmask_b32 v15, 0, 10, s[36:37]
    v_sub_u32 v14, v14, v15
    v_lshlrev_b32 v14, 2, v14
    v_lshrrev_b64 v[16:17], v14, s[32:33]
    v_and_b32 v16, 15, v16
    v_lshlrev_b32 v15, 3, v15
    v_lshl_add_u32 v15, v16, 4, v15
    v_cmp_le_u32 s[36:37], 5, v16
    v_mov_b32 v17, 1200
    s_nop 0
    v_cndmask_b32 v17, 0, v17, s[36:37]
    v_add_u32 v13, s25, v13
    v_mul_u32_u24 v13, 3840, v13
    v_add3_u32 v13, v13, v15, v17
    v_add_u32 v4, s23, v13
    v_add_u32 v12, 64, v1
    v_mul_u32_u24 v13, 3277, v12
    v_lshrrev_b32 v13, 16, v13
    v_mul_u32_u24 v14, 20, v13
    v_sub_u32 v14, v12, v14
    v_lshrrev_b32 v15, 3, v13
    v_lshlrev_b32 v15, 1, v15
    v_xor_b32 v14, v14, v15
    v_cmp_le_u32 s[36:37], 10, v14
    s_nop 1
    v_cndmask_b32 v15, 0, 10, s[36:37]
    v_sub_u32 v14, v14, v15
    v_lshlrev_b32 v14, 2, v14
    v_lshrrev_b64 v[16:17], v14, s[32:33]
    v_and_b32 v16, 15, v16
    v_lshlrev_b32 v15, 3, v15
    v_lshl_add_u32 v15, v16, 4, v15
    v_cmp_le_u32 s[36:37], 5, v16
    v_mov_b32 v17, 1200
    s_nop 0
    v_cndmask_b32 v17, 0, v17, s[36:37]
    v_add_u32 v13, s25, v13
    v_mul_u32_u24 v13, 3840, v13
    v_add3_u32 v13, v13, v15, v17
    v_add_u32 v5, s23, v13
    v_add_u32 v12, 128, v1
    v_mul_u32_u24 v13, 3277, v12
    v_lshrrev_b32 v13, 16, v13
    v_mul_u32_u24 v14, 20, v13
    v_sub_u32 v14, v12, v14
    v_lshrrev_b32 v15, 3, v13
    v_lshlrev_b32 v15, 1, v15
    v_xor_b32 v14, v14, v15
    v_cmp_le_u32 s[36:37], 10, v14
    s_nop 1
    v_cndmask_b32 v15, 0, 10, s[36:37]
    v_sub_u32 v14, v14, v15
    v_lshlrev_b32 v14, 2, v14
    v_lshrrev_b64 v[16:17], v14, s[32:33]
    v_and_b32 v16, 15, v16
    v_lshlrev_b32 v15, 3, v15
    v_lshl_add_u32 v15, v16, 4, v15
    v_cmp_le_u32 s[36:37], 5, v16
    v_mov_b32 v17, 1200
    s_nop 0
    v_cndmask_b32 v17, 0, v17, s[36:37]
    v_add_u32 v13, s25, v13
    v_mul_u32_u24 v13, 3840, v13
    v_add3_u32 v13, v13, v15, v17
    v_add_u32 v6, s23, v13
    v_add_u32 v12, 192, v1
    v_mul_u32_u24 v13, 3277, v12
    v_lshrrev_b32 v13, 16, v13
    v_mul_u32_u24 v14, 20, v13
    v_sub_u32 v14, v12, v14
    v_lshrrev_b32 v15, 3, v13
    v_lshlrev_b32 v15, 1, v15
    v_xor_b32 v14, v14, v15
    v_cmp_le_u32 s[36:37], 10, v14
    s_nop 1
    v_cndmask_b32 v15, 0, 10, s[36:37]
    v_sub_u32 v14, v14, v15
    v_lshlrev_b32 v14, 2, v14
    v_lshrrev_b64 v[16:17], v14, s[32:33]
    v_and_b32 v16, 15, v16
    v_lshlrev_b32 v15, 3, v15
    v_lshl_add_u32 v15, v16, 4, v15
    v_cmp_le_u32 s[36:37], 5, v16
    v_mov_b32 v17, 1200
    s_nop 0
    v_cndmask_b32 v17, 0, v17, s[36:37]
    v_add_u32 v13, s25, v13
    v_mul_u32_u24 v13, 3840, v13
    v_add3_u32 v13, v13, v15, v17
    v_add_u32 v7, s23, v13
    v_add_u32 v12, 256, v1
    v_mul_u32_u24 v13, 3277, v12
    v_lshrrev_b32 v13, 16, v13
    v_mul_u32_u24 v14, 20, v13
    v_sub_u32 v14, v12, v14
    v_lshrrev_b32 v15, 3, v13
    v_lshlrev_b32 v15, 1, v15
    v_xor_b32 v14, v14, v15
    v_cmp_le_u32 s[36:37], 10, v14
    s_nop 1
    v_cndmask_b32 v15, 0, 10, s[36:37]
    v_sub_u32 v14, v14, v15
    v_lshlrev_b32 v14, 2, v14
    v_lshrrev_b64 v[16:17], v14, s[32:33]
    v_and_b32 v16, 15, v16
    v_lshlrev_b32 v15, 3, v15
    v_lshl_add_u32 v15, v16, 4, v15
    v_cmp_le_u32 s[36:37], 5, v16
    v_mov_b32 v17, 1200
    s_nop 0
    v_cndmask_b32 v17, 0, v17, s[36:37]
    v_add_u32 v13, s25, v13
    v_mul_u32_u24 v13, 3840, v13
    v_add3_u32 v13, v13, v15, v17
    v_add_u32 v8, s23, v13
    s_mul_i32 s27, s24, 5120
    s_add_u32 m0, s27, 0
    s_nop 0
    buffer_load_dwordx4 v4, s[12:15], s45 offen lds
    s_add_u32 m0, s27, 1024
    s_nop 0
    buffer_load_dwordx4 v5, s[12:15], s45 offen lds
    s_add_u32 m0, s27, 2048
    s_nop 0
    buffer_load_dwordx4 v6, s[12:15], s45 offen lds
    s_add_u32 m0, s27, 3072
    s_nop 0
    buffer_load_dwordx4 v7, s[12:15], s45 offen lds
    s_add_u32 m0, s27, 4096
    s_nop 0
    buffer_load_dwordx4 v8, s[12:15], s45 offen lds
    s_lshl_b32 s44, s42, 7
    s_mul_i32 s45, s42, 245760
    s_add_u32 s42, s42, 1
    s_cmp_eq_u32 s42, 10
    s_cselect_b32 s42, 0, s42
    s_add_u32 m0, s27, 20480
    s_nop 0
    buffer_load_dwordx4 v4, s[12:15], s45 offen lds
    s_add_u32 m0, s26, 32768
    s_add_u32 s35, s44, 0
    buffer_load_dwordx4 v2, s[8:11], s35 offen lds
    s_add_u32 m0, s26, 33792
    s_add_u32 s35, s44, 10240
    buffer_load_dwordx4 v3, s[8:11], s35 offen lds
    s_add_u32 m0, s27, 21504
    s_nop 0
    buffer_load_dwordx4 v5, s[12:15], s45 offen lds
    s_add_u32 m0, s26, 34816
    s_add_u32 s35, s44, 20480
    buffer_load_dwordx4 v2, s[8:11], s35 offen lds
    s_add_u32 m0, s26, 35840
    s_add_u32 s35, s44, 30720
    buffer_load_dwordx4 v3, s[8:11], s35 offen lds
    s_add_u32 m0, s27, 22528
    s_nop 0
    buffer_load_dwordx4 v6, s[12:15], s45 offen lds
    s_add_u32 m0, s26, 36864
    s_add_u32 s35, s44, 40960
    buffer_load_dwordx4 v2, s[8:11], s35 offen lds
    s_add_u32 m0, s26, 37888
    s_add_u32 s35, s44, 51200
    buffer_load_dwordx4 v3, s[8:11], s35 offen lds
    s_add_u32 m0, s27, 23552
    s_nop 0
    buffer_load_dwordx4 v7, s[12:15], s45 offen lds
    s_add_u32 m0, s26, 38912
    s_add_u32 s35, s44, 61440
    buffer_load_dwordx4 v2, s[8:11], s35 offen lds
    s_add_u32 m0, s27, 24576
    s_nop 0
    buffer_load_dwordx4 v8, s[12:15], s45 offen lds
    s_and_b32 s23, s3, 1
    s_lshl_b32 s23, s23, 10
    s_mul_i32 s24, s30, s54
    s_add_u32 s23, s23, s24
    v_add_u32 v13, s23, v1
    v_mul_u32_u24 v13, 1280, v13
    v_mov_b32 v14, 0x7f000000
    v_cmp_gt_u32 s[48:49], s54, v1
    s_nop 1
    v_cndmask_b32 v10, v14, v13, s[48:49]
    v_cmp_gt_u32 s[48:49], 32, v1
    v_and_b32 v15, 15, v1
    v_add_u32 v13, s50, v15
    v_mov_b32 v16, s52
    v_cmp_le_u32 s[36:37], s51, v15
    s_nop 1
    v_cndmask_b32 v16, 0, v16, s[36:37]
    v_cmp_le_u32 s[36:37], s53, v15
    s_nop 1
    v_cndmask_b32 v17, 0, 5, s[36:37]
    v_add3_u32 v13, v13, v16, v17
    v_lshlrev_b32 v13, 7, v13
    v_bfe_u32 v15, v1, 4, 1
    s_lshl_b32 s24, s30, 1
    v_add_u32 v15, s24, v15
    v_mul_u32_u24 v15, 3840, v15
    v_add_u32 v13, v13, v15
    v_cndmask_b32 v11, v13, v14, s[48:49]
    s_bitcmp1_b32 s63, 1
    s_cselect_b32 s60, 1, 0
    s_waitcnt vmcnt(12)
    s_barrier
    s_lshl_b32 s44, s42, 7
    s_mul_i32 s45, s42, 245760
    s_add_u32 s42, s42, 1
    s_cmp_eq_u32 s42, 10
    s_cselect_b32 s42, 0, s42
    s_add_u32 m0, s27, 40960
    s_nop 0
    buffer_load_dwordx4 v4, s[12:15], s45 offen lds
    s_add_u32 m0, s26, 65536
    s_add_u32 s35, s44, 0
    buffer_load_dwordx4 v2, s[8:11], s35 offen lds
    s_add_u32 m0, s26, 66560
    s_add_u32 s35, s44, 10240
    buffer_load_dwordx4 v3, s[8:11], s35 offen lds
    s_add_u32 m0, s27, 41984
    s_nop 0
    buffer_load_dwordx4 v5, s[12:15], s45 offen lds
    s_add_u32 m0, s26, 67584
    s_add_u32 s35, s44, 20480
    buffer_load_dwordx4 v2, s[8:11], s35 offen lds
    s_add_u32 m0, s26, 68608
    s_add_u32 s35, s44, 30720
    buffer_load_dwordx4 v3, s[8:11], s35 offen lds
    s_add_u32 m0, s27, 43008
    s_nop 0
    buffer_load_dwordx4 v6, s[12:15], s45 offen lds
    s_add_u32 m0, s26, 69632
    s_add_u32 s35, s44, 40960
    buffer_load_dwordx4 v2, s[8:11], s35 offen lds
    s_add_u32 m0, s26, 70656
    s_add_u32 s35, s44, 51200
    buffer_load_dwordx4 v3, s[8:11], s35 offen lds
    s_add_u32 m0, s27, 44032
    s_nop 0
    buffer_load_dwordx4 v7, s[12:15], s45 offen lds
    s_add_u32 m0, s26, 71680
    s_add_u32 s35, s44, 61440
    buffer_load_dwordx4 v2, s[8:11], s35 offen lds
    s_add_u32 m0, s27, 45056
    s_nop 0
    buffer_load_dwordx4 v8, s[12:15], s45 offen lds
    s_waitcnt vmcnt(12)
    s_barrier
    s_lshl_b32 s44, s42, 7
    s_mul_i32 s45, s42, 245760
    s_add_u32 s42, s42, 1
    s_cmp_eq_u32 s42, 10
    s_cselect_b32 s42, 0, s42
    s_add_u32 m0, s27, 0
    s_nop 0
    buffer_load_dwordx4 v4, s[12:15], s45 offen lds
    s_add_u32 m0, s26, 0
    s_add_u32 s35, s44, 0
    buffer_load_dwordx4 v2, s[8:11], s35 offen lds
    s_add_u32 m0, s26, 1024
    s_add_u32 s35, s44, 10240
    buffer_load_dwordx4 v3, s[8:11], s35 offen lds
    s_add_u32 m0, s27, 1024
    s_nop 0
    buffer_load_dwordx4 v5, s[12:15], s45 offen lds
    s_add_u32 m0, s26, 2048
    s_add_u32 s35, s44, 20480
    buffer_load_dwordx4 v2, s[8:11], s35 offen lds
    s_add_u32 m0, s26, 3072
    s_add_u32 s35, s44, 30720
    buffer_load_dwordx4 v3, s[8:11], s35 offen lds
    s_add_u32 m0, s27, 2048
    s_nop 0
    buffer_load_dwordx4 v6, s[12:15], s45 offen lds
    s_add_u32 m0, s26, 4096
    s_add_u32 s35, s44, 40960
    buffer_load_dwordx4 v2, s[8:11], s35 offen lds
    s_add_u32 m0, s26, 5120
    s_add_u32 s35, s44, 51200
    buffer_load_dwordx4 v3, s[8:11], s35 offen lds
    s_add_u32 m0, s27, 3072
    s_nop 0
    buffer_load_dwordx4 v7, s[12:15], s45 offen lds
    s_add_u32 m0, s26, 6144
    s_add_u32 s35, s44, 61440
    buffer_load_dwordx4 v2, s[8:11], s35 offen lds
    s_add_u32 m0, s27, 4096
    s_nop 0
    buffer_load_dwordx4 v8, s[12:15], s45 offen lds
    s_add_u32 s59, s60, 4
    s_bitcmp1_b32 s63, 0
    s_cbranch_scc1 k1_ltw_21
    s_lshl_b32 s35, s59, 7
    buffer_load_dword v12, v10, s[8:11], s35 offen
    s_branch k1_ltj_22
k1_ltw_21:
    s_mul_i32 s35, s59, 245760
    buffer_load_dword v12, v11, s[12:15], s35 offen
k1_ltj_22:
    s_waitcnt vmcnt(13)
    s_barrier
    s_lshl_b32 s44, s42, 7
    s_mul_i32 s45, s42, 245760
    s_add_u32 s42, s42, 1
    s_cmp_eq_u32 s42, 10
    s_cselect_b32 s42, 0, s42
    s_add_u32 m0, s27, 20480
    s_nop 0
    buffer_load_dwordx4 v4, s[12:15], s45 offen lds
    s_add_u32 m0, s26, 32768
    s_add_u32 s35, s44, 0
    buffer_load_dwordx4 v2, s[8:11], s35 offen lds
    s_add_u32 m0, s26, 33792
    s_add_u32 s35, s44, 10240
    buffer_load_dwordx4 v3, s[8:11], s35 offen lds
    s_add_u32 m0, s27, 21504
    s_nop 0
    buffer_load_dwordx4 v5, s[12:15], s45 offen lds
    s_add_u32 m0, s26, 34816
    s_add_u32 s35, s44, 20480
    buffer_load_dwordx4 v2, s[8:11], s35 offen lds
    s_add_u32 m0, s26, 35840
    s_add_u32 s35, s44, 30720
    buffer_load_dwordx4 v3, s[8:11], s35 offen lds
    s_add_u32 m0, s27, 22528
    s_nop 0
    buffer_load_dwordx4 v6, s[12:15], s45 offen lds
    s_add_u32 m0, s26, 36864
    s_add_u32 s35, s44, 40960
    buffer_load_dwordx4 v2, s[8:11], s35 offen lds
    s_add_u32 m0, s26, 37888
    s_add_u32 s35, s44, 51200
    buffer_load_dwordx4 v3, s[8:11], s35 offen lds
    s_add_u32 m0, s27, 23552
    s_nop 0
    buffer_load_dwordx4 v7, s[12:15], s45 offen lds
    s_add_u32 m0, s26, 38912
    s_add_u32 s35, s44, 61440
    buffer_load_dwordx4 v2, s[8:11], s35 offen lds
    s_add_u32 m0, s27, 24576
    s_nop 0
    buffer_load_dwordx4 v8, s[12:15], s45 offen lds
    s_waitcnt vmcnt(13)
    s_barrier
    s_lshl_b32 s44, s42, 7
    s_mul_i32 s45, s42, 245760
    s_add_u32 s42, s42, 1
    s_cmp_eq_u32 s42, 10
    s_cselect_b32 s42, 0, s42
    s_add_u32 m0, s27, 40960
    s_nop 0
    buffer_load_dwordx4 v4, s[12:15], s45 offen lds
    s_add_u32 m0, s26, 65536
    s_add_u32 s35, s44, 0
    buffer_load_dwordx4 v2, s[8:11], s35 offen lds
    s_add_u32 m0, s26, 66560
    s_add_u32 s35, s44, 10240
    buffer_load_dwordx4 v3, s[8:11], s35 offen lds
    s_add_u32 m0, s27, 41984
    s_nop 0
    buffer_load_dwordx4 v5, s[12:15], s45 offen lds
    s_add_u32 m0, s26, 67584
    s_add_u32 s35, s44, 20480
    buffer_load_dwordx4 v2, s[8:11], s35 offen lds
    s_add_u32 m0, s26, 68608
    s_add_u32 s35, s44, 30720
    buffer_load_dwordx4 v3, s[8:11], s35 offen lds
    s_add_u32 m0, s27, 43008
    s_nop 0
    buffer_load_dwordx4 v6, s[12:15], s45 offen lds
    s_add_u32 m0, s26, 69632
    s_add_u32 s35, s44, 40960
    buffer_load_dwordx4 v2, s[8:11], s35 offen lds
    s_add_u32 m0, s26, 70656
    s_add_u32 s35, s44, 51200
    buffer_load_dwordx4 v3, s[8:11], s35 offen lds
    s_add_u32 m0, s27, 44032
    s_nop 0
    buffer_load_dwordx4 v7, s[12:15], s45 offen lds
    s_add_u32 m0, s26, 71680
    s_add_u32 s35, s44, 61440
    buffer_load_dwordx4 v2, s[8:11], s35 offen lds
    s_add_u32 m0, s27, 45056
    s_nop 0
    buffer_load_dwordx4 v8, s[12:15], s45 offen lds
    s_add_u32 s59, s60, 6
    s_bitcmp1_b32 s63, 0
    s_cbranch_scc1 k1_ltw_23
    s_lshl_b32 s35, s59, 7
    buffer_load_dword v12, v10, s[8:11], s35 offen
    s_branch k1_ltj_24
k1_ltw_23:
    s_mul_i32 s35, s59, 245760
    buffer_load_dword v12, v11, s[12:15], s35 offen
k1_ltj_24:
    s_waitcnt vmcnt(13)
    s_barrier
    s_lshl_b32 s44, s42, 7
    s_mul_i32 s45, s42, 245760
    s_add_u32 s42, s42, 1
    s_cmp_eq_u32 s42, 10
    s_cselect_b32 s42, 0, s42
    s_add_u32 m0, s27, 0
    s_nop 0
    buffer_load_dwordx4 v4, s[12:15], s45 offen lds
    s_add_u32 m0, s26, 0
    s_add_u32 s35, s44, 0
    buffer_load_dwordx4 v2, s[8:11], s35 offen lds
    s_add_u32 m0, s26, 1024
    s_add_u32 s35, s44, 10240
    buffer_load_dwordx4 v3, s[8:11], s35 offen lds
    s_add_u32 m0, s27, 1024
    s_nop 0
    buffer_load_dwordx4 v5, s[12:15], s45 offen lds
    s_add_u32 m0, s26, 2048
    s_add_u32 s35, s44, 20480
    buffer_load_dwordx4 v2, s[8:11], s35 offen lds
    s_add_u32 m0, s26, 3072
    s_add_u32 s35, s44, 30720
    buffer_load_dwordx4 v3, s[8:11], s35 offen lds
    s_add_u32 m0, s27, 2048
    s_nop 0
    buffer_load_dwordx4 v6, s[12:15], s45 offen lds
    s_add_u32 m0, s26, 4096
    s_add_u32 s35, s44, 40960
    buffer_load_dwordx4 v2, s[8:11], s35 offen lds
    s_add_u32 m0, s26, 5120
    s_add_u32 s35, s44, 51200
    buffer_load_dwordx4 v3, s[8:11], s35 offen lds
    s_add_u32 m0, s27, 3072
    s_nop 0
    buffer_load_dwordx4 v7, s[12:15], s45 offen lds
    s_add_u32 m0, s26, 6144
    s_add_u32 s35, s44, 61440
    buffer_load_dwordx4 v2, s[8:11], s35 offen lds
    s_add_u32 m0, s27, 4096
    s_nop 0
    buffer_load_dwordx4 v8, s[12:15], s45 offen lds
    s_waitcnt vmcnt(13)
    s_barrier
    s_lshl_b32 s44, s42, 7
    s_mul_i32 s45, s42, 245760
    s_add_u32 s42, s42, 1
    s_cmp_eq_u32 s42, 10
    s_cselect_b32 s42, 0, s42
    s_add_u32 m0, s27, 20480
    s_nop 0
    buffer_load_dwordx4 v4, s[12:15], s45 offen lds
    s_add_u32 m0, s26, 32768
    s_add_u32 s35, s44, 0
    buffer_load_dwordx4 v2, s[8:11], s35 offen lds
    s_add_u32 m0, s26, 33792
    s_add_u32 s35, s44, 10240
    buffer_load_dwordx4 v3, s[8:11], s35 offen lds
    s_add_u32 m0, s27, 21504
    s_nop 0
    buffer_load_dwordx4 v5, s[12:15], s45 offen lds
    s_add_u32 m0, s26, 34816
    s_add_u32 s35, s44, 20480
    buffer_load_dwordx4 v2, s[8:11], s35 offen lds
    s_add_u32 m0, s26, 35840
    s_add_u32 s35, s44, 30720
    buffer_load_dwordx4 v3, s[8:11], s35 offen lds
    s_add_u32 m0, s27, 22528
    s_nop 0
    buffer_load_dwordx4 v6, s[12:15], s45 offen lds
    s_add_u32 m0, s26, 36864
    s_add_u32 s35, s44, 40960
    buffer_load_dwordx4 v2, s[8:11], s35 offen lds
    s_add_u32 m0, s26, 37888
    s_add_u32 s35, s44, 51200
    buffer_load_dwordx4 v3, s[8:11], s35 offen lds
    s_add_u32 m0, s27, 23552
    s_nop 0
    buffer_load_dwordx4 v7, s[12:15], s45 offen lds
    s_add_u32 m0, s26, 38912
    s_add_u32 s35, s44, 61440
    buffer_load_dwordx4 v2, s[8:11], s35 offen lds
    s_add_u32 m0, s27, 24576
    s_nop 0
    buffer_load_dwordx4 v8, s[12:15], s45 offen lds
    s_add_u32 s59, s60, 8
    s_bitcmp1_b32 s63, 0
    s_cbranch_scc1 k1_ltw_25
    s_lshl_b32 s35, s59, 7
    buffer_load_dword v12, v10, s[8:11], s35 offen
    s_branch k1_ltj_26
k1_ltw_25:
    s_mul_i32 s35, s59, 245760
    buffer_load_dword v12, v11, s[12:15], s35 offen
k1_ltj_26:
    s_waitcnt vmcnt(13)
    s_barrier
    s_lshl_b32 s44, s42, 7
    s_mul_i32 s45, s42, 245760
    s_add_u32 s42, s42, 1
    s_cmp_eq_u32 s42, 10
    s_cselect_b32 s42, 0, s42
    s_add_u32 m0, s27, 40960
    s_nop 0
    buffer_load_dwordx4 v4, s[12:15], s45 offen lds
    s_add_u32 m0, s26, 65536
    s_add_u32 s35, s44, 0
    buffer_load_dwordx4 v2, s[8:11], s35 offen lds
    s_add_u32 m0, s26, 66560
    s_add_u32 s35, s44, 10240
    buffer_load_dwordx4 v3, s[8:11], s35 offen lds
    s_add_u32 m0, s27, 41984
    s_nop 0
    buffer_load_dwordx4 v5, s[12:15], s45 offen lds
    s_add_u32 m0, s26, 67584
    s_add_u32 s35, s44, 20480
    buffer_load_dwordx4 v2, s[8:11], s35 offen lds
    s_add_u32 m0, s26, 68608
    s_add_u32 s35, s44, 30720
    buffer_load_dwordx4 v3, s[8:11], s35 offen lds
    s_add_u32 m0, s27, 43008
    s_nop 0
    buffer_load_dwordx4 v6, s[12:15], s45 offen lds
    s_add_u32 m0, s26, 69632
    s_add_u32 s35, s44, 40960
    buffer_load_dwordx4 v2, s[8:11], s35 offen lds
    s_add_u32 m0, s26, 70656
    s_add_u32 s35, s44, 51200
    buffer_load_dwordx4 v3, s[8:11], s35 offen lds
    s_add_u32 m0, s27, 44032
    s_nop 0
    buffer_load_dwordx4 v7, s[12:15], s45 offen lds
    s_add_u32 m0, s26, 71680
    s_add_u32 s35, s44, 61440
    buffer_load_dwordx4 v2, s[8:11], s35 offen lds
    s_add_u32 m0, s27, 45056
    s_nop 0
    buffer_load_dwordx4 v8, s[12:15], s45 offen lds
    s_waitcnt vmcnt(13)
    s_barrier
    s_lshl_b32 s44, s42, 7
    s_mul_i32 s45, s42, 245760
    s_add_u32 s42, s42, 1
    s_cmp_eq_u32 s42, 10
    s_cselect_b32 s42, 0, s42
    s_add_u32 m0, s27, 0
    s_nop 0
    buffer_load_dwordx4 v4, s[12:15], s45 offen lds
    s_add_u32 m0, s26, 0
    s_add_u32 s35, s44, 0
    buffer_load_dwordx4 v2, s[8:11], s35 offen lds
    s_add_u32 m0, s26, 1024
    s_add_u32 s35, s44, 10240
    buffer_load_dwordx4 v3, s[8:11], s35 offen lds
    s_add_u32 m0, s27, 1024
    s_nop 0
    buffer_load_dwordx4 v5, s[12:15], s45 offen lds
    s_add_u32 m0, s26, 2048
    s_add_u32 s35, s44, 20480
    buffer_load_dwordx4 v2, s[8:11], s35 offen lds
    s_add_u32 m0, s26, 3072
    s_add_u32 s35, s44, 30720
    buffer_load_dwordx4 v3, s[8:11], s35 offen lds
    s_add_u32 m0, s27, 2048
    s_nop 0
    buffer_load_dwordx4 v6, s[12:15], s45 offen lds
    s_add_u32 m0, s26, 4096
    s_add_u32 s35, s44, 40960
    buffer_load_dwordx4 v2, s[8:11], s35 offen lds
    s_add_u32 m0, s26, 5120
    s_add_u32 s35, s44, 51200
    buffer_load_dwordx4 v3, s[8:11], s35 offen lds
    s_add_u32 m0, s27, 3072
    s_nop 0
    buffer_load_dwordx4 v7, s[12:15], s45 offen lds
    s_add_u32 m0, s26, 6144
    s_add_u32 s35, s44, 61440
    buffer_load_dwordx4 v2, s[8:11], s35 offen lds
    s_add_u32 m0, s27, 4096
    s_nop 0
    buffer_load_dwordx4 v8, s[12:15], s45 offen lds
    s_waitcnt vmcnt(12)
    s_barrier
    s_waitcnt vmcnt(0)
    s_barrier
    s_waitcnt vmcnt(0)
    s_cmp_lg_u32 s22, 8
    s_cbranch_scc1 k1_cnt0_27
    v_and_b32 v14, 7, v1
    v_lshlrev_b32 v14, 5, v14
    s_mov_b32 s24, 0
k1_cntp_28:
    buffer_load_dword v15, v14, s[96:99], 0 offen sc1
    s_add_u32 s24, s24, 1
    s_waitcnt vmcnt(0)
    v_cmp_gt_u32 s[46:47], 32, v15
    s_nop 1
    s_cmp_eq_u64 s[46:47], 0
    s_cbranch_scc1 k1_cntok_29
    s_sleep 4
    s_cmp_lt_u32 s24, 0x8000
    s_cbranch_scc1 k1_cntp_28
k1_cntok_29:
k1_cnt0_27:
    s_barrier
    s_load_dwordx4 s[88:91], s[0:1], 40
    s_load_dwordx2 s[86:87], s[0:1], 16
    s_barrier
    s_branch phase2_1
k1_mfma_9:
    s_cmp_lg_u32 s30, 0
    s_cbranch_scc1 k1_nocode_30
    s_cmp_ge_u32 s22, 6
    s_cbranch_scc1 k1_nocode_30
    s_getpc_b64 s[84:85]
k1_pc_31:
    s_sub_u32 s84, s84, k1_pc_31-concat_heads__linear_attn_block__sliding_block__prompt_kernel
    s_subb_u32 s85, s85, 0
    s_lshl_b32 s86, s22, 6
    v_add_u32 v14, s86, v1
    v_lshlrev_b32 v14, 7, v14
    s_mov_b32 s87, code_end_label-concat_heads__linear_attn_block__sliding_block__prompt_kernel
    v_cmp_gt_u32 vcc, s87, v14
    s_nop 1
    s_and_saveexec_b64 s[88:89], vcc
    s_cbranch_execz k1_codez_32
    v_mov_b32 v17, s85
    v_add_co_u32 v16, vcc, s84, v14
    s_nop 1
    v_addc_co_u32 v17, vcc, 0, v17, vcc
    global_load_dword v4, v[16:17], off
k1_codez_32:
    s_mov_b64 exec, -1
k1_nocode_30:
    s_cmp_eq_u32 s61, 1
    s_cbranch_scc1 k1_kv_11
    s_mul_i32 s32, s21, 52
    s_lshr_b32 s32, s32, 8
    s_mul_i32 s23, s32, 5
    s_sub_u32 s33, s21, s23
    s_cmp_eq_u32 s32, 2
    s_cbranch_scc1 k1_col_33
    s_cmp_lg_u32 s22, 0
    s_cbranch_scc1 k1_nt_36
    buffer_load_dword v4, v2, s[8:11], 0 offen offset:0
    s_mov_b32 s35, 0
    buffer_load_dword v4, v3, s[12:15], s35 offen
k1_nt_36:
    s_cmp_lg_u32 s22, 1
    s_cbranch_scc1 k1_nt_37
    buffer_load_dword v4, v2, s[8:11], 0 offen offset:128
    s_mov_b32 s35, 245760
    buffer_load_dword v4, v3, s[12:15], s35 offen
k1_nt_37:
    s_cmp_lg_u32 s22, 2
    s_cbranch_scc1 k1_nt_38
    buffer_load_dword v4, v2, s[8:11], 0 offen offset:256
    s_mov_b32 s35, 491520
    buffer_load_dword v4, v3, s[12:15], s35 offen
k1_nt_38:
    s_cmp_lg_u32 s22, 3
    s_cbranch_scc1 k1_nt_39
    buffer_load_dword v4, v2, s[8:11], 0 offen offset:384
    s_mov_b32 s35, 737280
    buffer_load_dword v4, v3, s[12:15], s35 offen
k1_nt_39:
    s_lshr_b32 s36, s22, 1
    s_and_b32 s37, s22, 1
    v_lshrrev_b32 v13, 4, v1
    v_bfe_u32 v14, v1, 2, 2
    v_lshl_add_u32 v15, v13, 3, v14
    v_lshlrev_b32 v15, 8, v15
    v_and_b32 v16, 3, v1
    v_lshl_add_u32 v15, v16, 3, v15
    v_and_b32 v16, 1, v13
    v_lshl_or_b32 v16, v16, 2, v14
    s_lshl_b32 s40, s37, 2
    s_add_u32 s39, s40, 0
    v_xor_b32 v17, s39, v16
    v_lshl_add_u32 v5, v17, 5, v15
    s_add_u32 s39, s40, 1
    v_xor_b32 v17, s39, v16
    v_lshl_add_u32 v6, v17, 5, v15
    s_add_u32 s39, s40, 2
    v_xor_b32 v17, s39, v16
    v_lshl_add_u32 v7, v17, 5, v15
    s_add_u32 s39, s40, 3
    v_xor_b32 v17, s39, v16
    v_lshl_add_u32 v8, v17, 5, v15
    s_lshl_b32 s63, s36, 6
    v_lshrrev_b32 v13, 4, v1
    v_and_b32 v14, 15, v1
    v_lshrrev_b32 v15, 1, v14
    v_xor_b32 v15, v15, v13
    s_lshl_b32 s39, s63, 7
    s_add_u32 s39, s39, 61440
    v_lshlrev_b32 v16, 7, v14
    v_add_u32 v16, s39, v16
    v_lshl_add_u32 v10, v15, 4, v16
    v_xor_b32 v11, 64, v10
    v_add_u32 v12, 0x10000, v10
    v_add_u32 v13, 0x10000, v11
    s_mul_i32 s40, s32, 2621440
    s_cmp_eq_u32 s31, 0
    s_cselect_b32 s40, 7864320, s40
    s_lshl_b32 s41, s20, 3
    s_lshl_b32 s39, s36, 1
    s_add_u32 s41, s41, s39
    s_mul_i32 s41, s41, 1280
    s_add_u32 s40, s40, s41
    s_lshl_b32 s39, s33, 5
    s_lshl_b32 s41, s37, 4
    s_add_u32 s39, s39, s41
    v_lshrrev_b32 v19, 4, v1
    v_add_u32 v15, s39, v19
    v_lshlrev_b32 v16, 4, v14
    v_add_u32 v16, s40, v16
    v_add_u32 v17, 0, v15
    v_mul_u32_u24 v18, 205, v17
    v_lshrrev_b32 v18, 10, v18
    v_mul_u32_u24 v18, 80640, v18
    v_lshl_add_u32 v17, v17, 8, v16
    v_add_u32 v152, v17, v18
    v_add_u32 v17, 4, v15
    v_mul_u32_u24 v18, 205, v17
    v_lshrrev_b32 v18, 10, v18
    v_mul_u32_u24 v18, 80640, v18
    v_lshl_add_u32 v17, v17, 8, v16
    v_add_u32 v153, v17, v18
    v_add_u32 v17, 8, v15
    v_mul_u32_u24 v18, 205, v17
    v_lshrrev_b32 v18, 10, v18
    v_mul_u32_u24 v18, 80640, v18
    v_lshl_add_u32 v17, v17, 8, v16
    v_add_u32 v154, v17, v18
    v_add_u32 v17, 12, v15
    v_mul_u32_u24 v18, 205, v17
    v_lshrrev_b32 v18, 10, v18
    v_mul_u32_u24 v18, 80640, v18
    v_lshl_add_u32 v17, v17, 8, v16
    v_add_u32 v155, v17, v18
    s_barrier
    ds_read_b64_tr_b16 v[32:33], v5 offset:0
    ds_read_b64_tr_b16 v[34:35], v5 offset:1024
    ds_read_b128 v[16:19], v10 offset:0
    ds_read_b64_tr_b16 v[36:37], v6 offset:0
    ds_read_b64_tr_b16 v[38:39], v6 offset:1024
    ds_read_b128 v[20:23], v10 offset:2048
    ds_read_b64_tr_b16 v[40:41], v7 offset:0
    ds_read_b64_tr_b16 v[42:43], v7 offset:1024
    ds_read_b128 v[24:27], v10 offset:4096
    ds_read_b64_tr_b16 v[44:45], v8 offset:0
    ds_read_b64_tr_b16 v[46:47], v8 offset:1024
    ds_read_b128 v[28:31], v10 offset:6144
    s_waitcnt lgkmcnt(0)
    v_mfma_f32_16x16x32_bf16 v[88:91], v[32:35], v[16:19], 0
    ds_read_b64_tr_b16 v[68:69], v5 offset:8192
    v_mfma_f32_16x16x32_bf16 v[92:95], v[36:39], v[16:19], 0
    ds_read_b64_tr_b16 v[70:71], v5 offset:9216
    v_mfma_f32_16x16x32_bf16 v[96:99], v[40:43], v[16:19], 0
    ds_read_b128 v[52:55], v11 offset:0
    v_mfma_f32_16x16x32_bf16 v[100:103], v[44:47], v[16:19], 0
    ds_read_b64_tr_b16 v[72:73], v6 offset:8192
    v_mfma_f32_16x16x32_bf16 v[104:107], v[32:35], v[20:23], 0
    ds_read_b64_tr_b16 v[74:75], v6 offset:9216
    v_mfma_f32_16x16x32_bf16 v[108:111], v[36:39], v[20:23], 0
    ds_read_b128 v[56:59], v11 offset:2048
    v_mfma_f32_16x16x32_bf16 v[112:115], v[40:43], v[20:23], 0
    ds_read_b64_tr_b16 v[76:77], v7 offset:8192
    v_mfma_f32_16x16x32_bf16 v[116:119], v[44:47], v[20:23], 0
    ds_read_b64_tr_b16 v[78:79], v7 offset:9216
    v_mfma_f32_16x16x32_bf16 v[120:123], v[32:35], v[24:27], 0
    ds_read_b128 v[60:63], v11 offset:4096
    v_mfma_f32_16x16x32_bf16 v[124:127], v[36:39], v[24:27], 0
    ds_read_b64_tr_b16 v[80:81], v8 offset:8192
    v_mfma_f32_16x16x32_bf16 v[128:131], v[40:43], v[24:27], 0
    ds_read_b64_tr_b16 v[82:83], v8 offset:9216
    v_mfma_f32_16x16x32_bf16 v[132:135], v[44:47], v[24:27], 0
    ds_read_b128 v[64:67], v11 offset:6144
    v_mfma_f32_16x16x32_bf16 v[136:139], v[32:35], v[28:31], 0
    v_mfma_f32_16x16x32_bf16 v[140:143], v[36:39], v[28:31], 0
    v_mfma_f32_16x16x32_bf16 v[144:147], v[40:43], v[28:31], 0
    v_mfma_f32_16x16x32_bf16 v[148:151], v[44:47], v[28:31], 0
    s_waitcnt lgkmcnt(0)
    s_barrier
    v_mfma_f32_16x16x32_bf16 v[88:91], v[68:71], v[52:55], v[88:91]
    ds_read_b64_tr_b16 v[32:33], v5 offset:16384
    v_mfma_f32_16x16x32_bf16 v[92:95], v[72:75], v[52:55], v[92:95]
    ds_read_b64_tr_b16 v[34:35], v5 offset:17408
    v_mfma_f32_16x16x32_bf16 v[96:99], v[76:79], v[52:55], v[96:99]
    ds_read_b128 v[16:19], v10 offset:32768
    v_mfma_f32_16x16x32_bf16 v[100:103], v[80:83], v[52:55], v[100:103]
    ds_read_b64_tr_b16 v[36:37], v6 offset:16384
    v_mfma_f32_16x16x32_bf16 v[104:107], v[68:71], v[56:59], v[104:107]
    ds_read_b64_tr_b16 v[38:39], v6 offset:17408
    v_mfma_f32_16x16x32_bf16 v[108:111], v[72:75], v[56:59], v[108:111]
    ds_read_b128 v[20:23], v10 offset:34816
    v_mfma_f32_16x16x32_bf16 v[112:115], v[76:79], v[56:59], v[112:115]
    ds_read_b64_tr_b16 v[40:41], v7 offset:16384
    v_mfma_f32_16x16x32_bf16 v[116:119], v[80:83], v[56:59], v[116:119]
    ds_read_b64_tr_b16 v[42:43], v7 offset:17408
    v_mfma_f32_16x16x32_bf16 v[120:123], v[68:71], v[60:63], v[120:123]
    ds_read_b128 v[24:27], v10 offset:36864
    v_mfma_f32_16x16x32_bf16 v[124:127], v[72:75], v[60:63], v[124:127]
    ds_read_b64_tr_b16 v[44:45], v8 offset:16384
    v_mfma_f32_16x16x32_bf16 v[128:131], v[76:79], v[60:63], v[128:131]
    ds_read_b64_tr_b16 v[46:47], v8 offset:17408
    v_mfma_f32_16x16x32_bf16 v[132:135], v[80:83], v[60:63], v[132:135]
    ds_read_b128 v[28:31], v10 offset:38912
    v_mfma_f32_16x16x32_bf16 v[136:139], v[68:71], v[64:67], v[136:139]
    v_mfma_f32_16x16x32_bf16 v[140:143], v[72:75], v[64:67], v[140:143]
    v_mfma_f32_16x16x32_bf16 v[144:147], v[76:79], v[64:67], v[144:147]
    v_mfma_f32_16x16x32_bf16 v[148:151], v[80:83], v[64:67], v[148:151]
    s_waitcnt lgkmcnt(0)
    v_mfma_f32_16x16x32_bf16 v[88:91], v[32:35], v[16:19], v[88:91]
    ds_read_b64_tr_b16 v[68:69], v5 offset:24576
    v_mfma_f32_16x16x32_bf16 v[92:95], v[36:39], v[16:19], v[92:95]
    ds_read_b64_tr_b16 v[70:71], v5 offset:25600
    v_mfma_f32_16x16x32_bf16 v[96:99], v[40:43], v[16:19], v[96:99]
    ds_read_b128 v[52:55], v11 offset:32768
    v_mfma_f32_16x16x32_bf16 v[100:103], v[44:47], v[16:19], v[100:103]
    ds_read_b64_tr_b16 v[72:73], v6 offset:24576
    v_mfma_f32_16x16x32_bf16 v[104:107], v[32:35], v[20:23], v[104:107]
    ds_read_b64_tr_b16 v[74:75], v6 offset:25600
    v_mfma_f32_16x16x32_bf16 v[108:111], v[36:39], v[20:23], v[108:111]
    ds_read_b128 v[56:59], v11 offset:34816
    v_mfma_f32_16x16x32_bf16 v[112:115], v[40:43], v[20:23], v[112:115]
    ds_read_b64_tr_b16 v[76:77], v7 offset:24576
    v_mfma_f32_16x16x32_bf16 v[116:119], v[44:47], v[20:23], v[116:119]
    ds_read_b64_tr_b16 v[78:79], v7 offset:25600
    v_mfma_f32_16x16x32_bf16 v[120:123], v[32:35], v[24:27], v[120:123]
    ds_read_b128 v[60:63], v11 offset:36864
    v_mfma_f32_16x16x32_bf16 v[124:127], v[36:39], v[24:27], v[124:127]
    ds_read_b64_tr_b16 v[80:81], v8 offset:24576
    v_mfma_f32_16x16x32_bf16 v[128:131], v[40:43], v[24:27], v[128:131]
    ds_read_b64_tr_b16 v[82:83], v8 offset:25600
    v_mfma_f32_16x16x32_bf16 v[132:135], v[44:47], v[24:27], v[132:135]
    ds_read_b128 v[64:67], v11 offset:38912
    v_mfma_f32_16x16x32_bf16 v[136:139], v[32:35], v[28:31], v[136:139]
    v_mfma_f32_16x16x32_bf16 v[140:143], v[36:39], v[28:31], v[140:143]
    v_mfma_f32_16x16x32_bf16 v[144:147], v[40:43], v[28:31], v[144:147]
    v_mfma_f32_16x16x32_bf16 v[148:151], v[44:47], v[28:31], v[148:151]
    s_waitcnt lgkmcnt(0)
    s_barrier
    v_mfma_f32_16x16x32_bf16 v[88:91], v[68:71], v[52:55], v[88:91]
    ds_read_b64_tr_b16 v[32:33], v5 offset:32768
    v_mfma_f32_16x16x32_bf16 v[92:95], v[72:75], v[52:55], v[92:95]
    ds_read_b64_tr_b16 v[34:35], v5 offset:33792
    v_mfma_f32_16x16x32_bf16 v[96:99], v[76:79], v[52:55], v[96:99]
    ds_read_b128 v[16:19], v12 offset:0
    v_mfma_f32_16x16x32_bf16 v[100:103], v[80:83], v[52:55], v[100:103]
    ds_read_b64_tr_b16 v[36:37], v6 offset:32768
    v_mfma_f32_16x16x32_bf16 v[104:107], v[68:71], v[56:59], v[104:107]
    ds_read_b64_tr_b16 v[38:39], v6 offset:33792
    v_mfma_f32_16x16x32_bf16 v[108:111], v[72:75], v[56:59], v[108:111]
    ds_read_b128 v[20:23], v12 offset:2048
    v_mfma_f32_16x16x32_bf16 v[112:115], v[76:79], v[56:59], v[112:115]
    ds_read_b64_tr_b16 v[40:41], v7 offset:32768
    v_mfma_f32_16x16x32_bf16 v[116:119], v[80:83], v[56:59], v[116:119]
    ds_read_b64_tr_b16 v[42:43], v7 offset:33792
    v_mfma_f32_16x16x32_bf16 v[120:123], v[68:71], v[60:63], v[120:123]
    ds_read_b128 v[24:27], v12 offset:4096
    v_mfma_f32_16x16x32_bf16 v[124:127], v[72:75], v[60:63], v[124:127]
    ds_read_b64_tr_b16 v[44:45], v8 offset:32768
    v_mfma_f32_16x16x32_bf16 v[128:131], v[76:79], v[60:63], v[128:131]
    ds_read_b64_tr_b16 v[46:47], v8 offset:33792
    v_mfma_f32_16x16x32_bf16 v[132:135], v[80:83], v[60:63], v[132:135]
    ds_read_b128 v[28:31], v12 offset:6144
    v_mfma_f32_16x16x32_bf16 v[136:139], v[68:71], v[64:67], v[136:139]
    v_mfma_f32_16x16x32_bf16 v[140:143], v[72:75], v[64:67], v[140:143]
    v_mfma_f32_16x16x32_bf16 v[144:147], v[76:79], v[64:67], v[144:147]
    v_mfma_f32_16x16x32_bf16 v[148:151], v[80:83], v[64:67], v[148:151]
    s_waitcnt lgkmcnt(0)
    v_mfma_f32_16x16x32_bf16 v[88:91], v[32:35], v[16:19], v[88:91]
    ds_read_b64_tr_b16 v[68:69], v5 offset:40960
    v_mfma_f32_16x16x32_bf16 v[92:95], v[36:39], v[16:19], v[92:95]
    ds_read_b64_tr_b16 v[70:71], v5 offset:41984
    v_mfma_f32_16x16x32_bf16 v[96:99], v[40:43], v[16:19], v[96:99]
    ds_read_b128 v[52:55], v13 offset:0
    v_mfma_f32_16x16x32_bf16 v[100:103], v[44:47], v[16:19], v[100:103]
    ds_read_b64_tr_b16 v[72:73], v6 offset:40960
    v_mfma_f32_16x16x32_bf16 v[104:107], v[32:35], v[20:23], v[104:107]
    ds_read_b64_tr_b16 v[74:75], v6 offset:41984
    v_mfma_f32_16x16x32_bf16 v[108:111], v[36:39], v[20:23], v[108:111]
    ds_read_b128 v[56:59], v13 offset:2048
    v_mfma_f32_16x16x32_bf16 v[112:115], v[40:43], v[20:23], v[112:115]
    ds_read_b64_tr_b16 v[76:77], v7 offset:40960
    v_mfma_f32_16x16x32_bf16 v[116:119], v[44:47], v[20:23], v[116:119]
    ds_read_b64_tr_b16 v[78:79], v7 offset:41984
    v_mfma_f32_16x16x32_bf16 v[120:123], v[32:35], v[24:27], v[120:123]
    ds_read_b128 v[60:63], v13 offset:4096
    v_mfma_f32_16x16x32_bf16 v[124:127], v[36:39], v[24:27], v[124:127]
    ds_read_b64_tr_b16 v[80:81], v8 offset:40960
    v_mfma_f32_16x16x32_bf16 v[128:131], v[40:43], v[24:27], v[128:131]
    ds_read_b64_tr_b16 v[82:83], v8 offset:41984
    v_mfma_f32_16x16x32_bf16 v[132:135], v[44:47], v[24:27], v[132:135]
    ds_read_b128 v[64:67], v13 offset:6144
    v_mfma_f32_16x16x32_bf16 v[136:139], v[32:35], v[28:31], v[136:139]
    v_mfma_f32_16x16x32_bf16 v[140:143], v[36:39], v[28:31], v[140:143]
    v_mfma_f32_16x16x32_bf16 v[144:147], v[40:43], v[28:31], v[144:147]
    v_mfma_f32_16x16x32_bf16 v[148:151], v[44:47], v[28:31], v[148:151]
    s_waitcnt lgkmcnt(0)
    s_barrier
    v_mfma_f32_16x16x32_bf16 v[88:91], v[68:71], v[52:55], v[88:91]
    ds_read_b64_tr_b16 v[32:33], v5 offset:0
    v_mfma_f32_16x16x32_bf16 v[92:95], v[72:75], v[52:55], v[92:95]
    ds_read_b64_tr_b16 v[34:35], v5 offset:1024
    v_mfma_f32_16x16x32_bf16 v[96:99], v[76:79], v[52:55], v[96:99]
    ds_read_b128 v[16:19], v10 offset:0
    v_mfma_f32_16x16x32_bf16 v[100:103], v[80:83], v[52:55], v[100:103]
    ds_read_b64_tr_b16 v[36:37], v6 offset:0
    v_mfma_f32_16x16x32_bf16 v[104:107], v[68:71], v[56:59], v[104:107]
    ds_read_b64_tr_b16 v[38:39], v6 offset:1024
    v_mfma_f32_16x16x32_bf16 v[108:111], v[72:75], v[56:59], v[108:111]
    ds_read_b128 v[20:23], v10 offset:2048
    v_mfma_f32_16x16x32_bf16 v[112:115], v[76:79], v[56:59], v[112:115]
    ds_read_b64_tr_b16 v[40:41], v7 offset:0
    v_mfma_f32_16x16x32_bf16 v[116:119], v[80:83], v[56:59], v[116:119]
    ds_read_b64_tr_b16 v[42:43], v7 offset:1024
    v_mfma_f32_16x16x32_bf16 v[120:123], v[68:71], v[60:63], v[120:123]
    ds_read_b128 v[24:27], v10 offset:4096
    v_mfma_f32_16x16x32_bf16 v[124:127], v[72:75], v[60:63], v[124:127]
    ds_read_b64_tr_b16 v[44:45], v8 offset:0
    v_mfma_f32_16x16x32_bf16 v[128:131], v[76:79], v[60:63], v[128:131]
    ds_read_b64_tr_b16 v[46:47], v8 offset:1024
    v_mfma_f32_16x16x32_bf16 v[132:135], v[80:83], v[60:63], v[132:135]
    ds_read_b128 v[28:31], v10 offset:6144
    v_mfma_f32_16x16x32_bf16 v[136:139], v[68:71], v[64:67], v[136:139]
    v_mfma_f32_16x16x32_bf16 v[140:143], v[72:75], v[64:67], v[140:143]
    v_mfma_f32_16x16x32_bf16 v[144:147], v[76:79], v[64:67], v[144:147]
    v_mfma_f32_16x16x32_bf16 v[148:151], v[80:83], v[64:67], v[148:151]
    s_waitcnt lgkmcnt(0)
    v_mfma_f32_16x16x32_bf16 v[88:91], v[32:35], v[16:19], v[88:91]
    ds_read_b64_tr_b16 v[68:69], v5 offset:8192
    v_mfma_f32_16x16x32_bf16 v[92:95], v[36:39], v[16:19], v[92:95]
    ds_read_b64_tr_b16 v[70:71], v5 offset:9216
    v_mfma_f32_16x16x32_bf16 v[96:99], v[40:43], v[16:19], v[96:99]
    ds_read_b128 v[52:55], v11 offset:0
    v_mfma_f32_16x16x32_bf16 v[100:103], v[44:47], v[16:19], v[100:103]
    ds_read_b64_tr_b16 v[72:73], v6 offset:8192
    v_mfma_f32_16x16x32_bf16 v[104:107], v[32:35], v[20:23], v[104:107]
    ds_read_b64_tr_b16 v[74:75], v6 offset:9216
    v_mfma_f32_16x16x32_bf16 v[108:111], v[36:39], v[20:23], v[108:111]
    ds_read_b128 v[56:59], v11 offset:2048
    v_mfma_f32_16x16x32_bf16 v[112:115], v[40:43], v[20:23], v[112:115]
    ds_read_b64_tr_b16 v[76:77], v7 offset:8192
    v_mfma_f32_16x16x32_bf16 v[116:119], v[44:47], v[20:23], v[116:119]
    ds_read_b64_tr_b16 v[78:79], v7 offset:9216
    v_mfma_f32_16x16x32_bf16 v[120:123], v[32:35], v[24:27], v[120:123]
    ds_read_b128 v[60:63], v11 offset:4096
    v_mfma_f32_16x16x32_bf16 v[124:127], v[36:39], v[24:27], v[124:127]
    ds_read_b64_tr_b16 v[80:81], v8 offset:8192
    v_mfma_f32_16x16x32_bf16 v[128:131], v[40:43], v[24:27], v[128:131]
    ds_read_b64_tr_b16 v[82:83], v8 offset:9216
    v_mfma_f32_16x16x32_bf16 v[132:135], v[44:47], v[24:27], v[132:135]
    ds_read_b128 v[64:67], v11 offset:6144
    v_mfma_f32_16x16x32_bf16 v[136:139], v[32:35], v[28:31], v[136:139]
    v_mfma_f32_16x16x32_bf16 v[140:143], v[36:39], v[28:31], v[140:143]
    v_mfma_f32_16x16x32_bf16 v[144:147], v[40:43], v[28:31], v[144:147]
    v_mfma_f32_16x16x32_bf16 v[148:151], v[44:47], v[28:31], v[148:151]
    s_waitcnt lgkmcnt(0)
    s_barrier
    v_mfma_f32_16x16x32_bf16 v[88:91], v[68:71], v[52:55], v[88:91]
    ds_read_b64_tr_b16 v[32:33], v5 offset:16384
    v_mfma_f32_16x16x32_bf16 v[92:95], v[72:75], v[52:55], v[92:95]
    ds_read_b64_tr_b16 v[34:35], v5 offset:17408
    v_mfma_f32_16x16x32_bf16 v[96:99], v[76:79], v[52:55], v[96:99]
    ds_read_b128 v[16:19], v10 offset:32768
    v_mfma_f32_16x16x32_bf16 v[100:103], v[80:83], v[52:55], v[100:103]
    ds_read_b64_tr_b16 v[36:37], v6 offset:16384
    v_mfma_f32_16x16x32_bf16 v[104:107], v[68:71], v[56:59], v[104:107]
    ds_read_b64_tr_b16 v[38:39], v6 offset:17408
    v_mfma_f32_16x16x32_bf16 v[108:111], v[72:75], v[56:59], v[108:111]
    ds_read_b128 v[20:23], v10 offset:34816
    v_mfma_f32_16x16x32_bf16 v[112:115], v[76:79], v[56:59], v[112:115]
    ds_read_b64_tr_b16 v[40:41], v7 offset:16384
    v_mfma_f32_16x16x32_bf16 v[116:119], v[80:83], v[56:59], v[116:119]
    ds_read_b64_tr_b16 v[42:43], v7 offset:17408
    v_mfma_f32_16x16x32_bf16 v[120:123], v[68:71], v[60:63], v[120:123]
    ds_read_b128 v[24:27], v10 offset:36864
    v_mfma_f32_16x16x32_bf16 v[124:127], v[72:75], v[60:63], v[124:127]
    ds_read_b64_tr_b16 v[44:45], v8 offset:16384
    v_mfma_f32_16x16x32_bf16 v[128:131], v[76:79], v[60:63], v[128:131]
    ds_read_b64_tr_b16 v[46:47], v8 offset:17408
    v_mfma_f32_16x16x32_bf16 v[132:135], v[80:83], v[60:63], v[132:135]
    ds_read_b128 v[28:31], v10 offset:38912
    v_mfma_f32_16x16x32_bf16 v[136:139], v[68:71], v[64:67], v[136:139]
    v_mfma_f32_16x16x32_bf16 v[140:143], v[72:75], v[64:67], v[140:143]
    v_mfma_f32_16x16x32_bf16 v[144:147], v[76:79], v[64:67], v[144:147]
    v_mfma_f32_16x16x32_bf16 v[148:151], v[80:83], v[64:67], v[148:151]
    s_waitcnt lgkmcnt(0)
    v_mfma_f32_16x16x32_bf16 v[88:91], v[32:35], v[16:19], v[88:91]
    ds_read_b64_tr_b16 v[68:69], v5 offset:24576
    v_mfma_f32_16x16x32_bf16 v[92:95], v[36:39], v[16:19], v[92:95]
    ds_read_b64_tr_b16 v[70:71], v5 offset:25600
    v_mfma_f32_16x16x32_bf16 v[96:99], v[40:43], v[16:19], v[96:99]
    ds_read_b128 v[52:55], v11 offset:32768
    v_mfma_f32_16x16x32_bf16 v[100:103], v[44:47], v[16:19], v[100:103]
    ds_read_b64_tr_b16 v[72:73], v6 offset:24576
    v_mfma_f32_16x16x32_bf16 v[104:107], v[32:35], v[20:23], v[104:107]
    ds_read_b64_tr_b16 v[74:75], v6 offset:25600
    v_mfma_f32_16x16x32_bf16 v[108:111], v[36:39], v[20:23], v[108:111]
    ds_read_b128 v[56:59], v11 offset:34816
    v_mfma_f32_16x16x32_bf16 v[112:115], v[40:43], v[20:23], v[112:115]
    ds_read_b64_tr_b16 v[76:77], v7 offset:24576
    v_mfma_f32_16x16x32_bf16 v[116:119], v[44:47], v[20:23], v[116:119]
    ds_read_b64_tr_b16 v[78:79], v7 offset:25600
    v_mfma_f32_16x16x32_bf16 v[120:123], v[32:35], v[24:27], v[120:123]
    ds_read_b128 v[60:63], v11 offset:36864
    v_mfma_f32_16x16x32_bf16 v[124:127], v[36:39], v[24:27], v[124:127]
    ds_read_b64_tr_b16 v[80:81], v8 offset:24576
    v_mfma_f32_16x16x32_bf16 v[128:131], v[40:43], v[24:27], v[128:131]
    ds_read_b64_tr_b16 v[82:83], v8 offset:25600
    v_mfma_f32_16x16x32_bf16 v[132:135], v[44:47], v[24:27], v[132:135]
    ds_read_b128 v[64:67], v11 offset:38912
    v_mfma_f32_16x16x32_bf16 v[136:139], v[32:35], v[28:31], v[136:139]
    v_mfma_f32_16x16x32_bf16 v[140:143], v[36:39], v[28:31], v[140:143]
    v_mfma_f32_16x16x32_bf16 v[144:147], v[40:43], v[28:31], v[144:147]
    v_mfma_f32_16x16x32_bf16 v[148:151], v[44:47], v[28:31], v[148:151]
    s_waitcnt lgkmcnt(0)
    s_barrier
    v_mfma_f32_16x16x32_bf16 v[88:91], v[68:71], v[52:55], v[88:91]
    ds_read_b64_tr_b16 v[32:33], v5 offset:32768
    v_mfma_f32_16x16x32_bf16 v[92:95], v[72:75], v[52:55], v[92:95]
    ds_read_b64_tr_b16 v[34:35], v5 offset:33792
    v_mfma_f32_16x16x32_bf16 v[96:99], v[76:79], v[52:55], v[96:99]
    ds_read_b128 v[16:19], v12 offset:0
    v_mfma_f32_16x16x32_bf16 v[100:103], v[80:83], v[52:55], v[100:103]
    ds_read_b64_tr_b16 v[36:37], v6 offset:32768
    v_mfma_f32_16x16x32_bf16 v[104:107], v[68:71], v[56:59], v[104:107]
    ds_read_b64_tr_b16 v[38:39], v6 offset:33792
    v_mfma_f32_16x16x32_bf16 v[108:111], v[72:75], v[56:59], v[108:111]
    ds_read_b128 v[20:23], v12 offset:2048
    v_mfma_f32_16x16x32_bf16 v[112:115], v[76:79], v[56:59], v[112:115]
    ds_read_b64_tr_b16 v[40:41], v7 offset:32768
    v_mfma_f32_16x16x32_bf16 v[116:119], v[80:83], v[56:59], v[116:119]
    ds_read_b64_tr_b16 v[42:43], v7 offset:33792
    v_mfma_f32_16x16x32_bf16 v[120:123], v[68:71], v[60:63], v[120:123]
    ds_read_b128 v[24:27], v12 offset:4096
    v_mfma_f32_16x16x32_bf16 v[124:127], v[72:75], v[60:63], v[124:127]
    ds_read_b64_tr_b16 v[44:45], v8 offset:32768
    v_mfma_f32_16x16x32_bf16 v[128:131], v[76:79], v[60:63], v[128:131]
    ds_read_b64_tr_b16 v[46:47], v8 offset:33792
    v_mfma_f32_16x16x32_bf16 v[132:135], v[80:83], v[60:63], v[132:135]
    ds_read_b128 v[28:31], v12 offset:6144
    v_mfma_f32_16x16x32_bf16 v[136:139], v[68:71], v[64:67], v[136:139]
    v_mfma_f32_16x16x32_bf16 v[140:143], v[72:75], v[64:67], v[140:143]
    v_mfma_f32_16x16x32_bf16 v[144:147], v[76:79], v[64:67], v[144:147]
    v_mfma_f32_16x16x32_bf16 v[148:151], v[80:83], v[64:67], v[148:151]
    s_waitcnt lgkmcnt(0)
    v_mfma_f32_16x16x32_bf16 v[88:91], v[32:35], v[16:19], v[88:91]
    ds_read_b64_tr_b16 v[68:69], v5 offset:40960
    v_mfma_f32_16x16x32_bf16 v[92:95], v[36:39], v[16:19], v[92:95]
    ds_read_b64_tr_b16 v[70:71], v5 offset:41984
    v_mfma_f32_16x16x32_bf16 v[96:99], v[40:43], v[16:19], v[96:99]
    ds_read_b128 v[52:55], v13 offset:0
    v_mfma_f32_16x16x32_bf16 v[100:103], v[44:47], v[16:19], v[100:103]
    ds_read_b64_tr_b16 v[72:73], v6 offset:40960
    v_mfma_f32_16x16x32_bf16 v[104:107], v[32:35], v[20:23], v[104:107]
    ds_read_b64_tr_b16 v[74:75], v6 offset:41984
    v_mfma_f32_16x16x32_bf16 v[108:111], v[36:39], v[20:23], v[108:111]
    ds_read_b128 v[56:59], v13 offset:2048
    v_mfma_f32_16x16x32_bf16 v[112:115], v[40:43], v[20:23], v[112:115]
    ds_read_b64_tr_b16 v[76:77], v7 offset:40960
    v_mfma_f32_16x16x32_bf16 v[116:119], v[44:47], v[20:23], v[116:119]
    ds_read_b64_tr_b16 v[78:79], v7 offset:41984
    v_mfma_f32_16x16x32_bf16 v[120:123], v[32:35], v[24:27], v[120:123]
    ds_read_b128 v[60:63], v13 offset:4096
    v_mfma_f32_16x16x32_bf16 v[124:127], v[36:39], v[24:27], v[124:127]
    ds_read_b64_tr_b16 v[80:81], v8 offset:40960
    v_mfma_f32_16x16x32_bf16 v[128:131], v[40:43], v[24:27], v[128:131]
    ds_read_b64_tr_b16 v[82:83], v8 offset:41984
    v_mfma_f32_16x16x32_bf16 v[132:135], v[44:47], v[24:27], v[132:135]
    ds_read_b128 v[64:67], v13 offset:6144
    v_mfma_f32_16x16x32_bf16 v[136:139], v[32:35], v[28:31], v[136:139]
    v_mfma_f32_16x16x32_bf16 v[140:143], v[36:39], v[28:31], v[140:143]
    v_mfma_f32_16x16x32_bf16 v[144:147], v[40:43], v[28:31], v[144:147]
    v_mfma_f32_16x16x32_bf16 v[148:151], v[44:47], v[28:31], v[148:151]
    s_waitcnt lgkmcnt(0)
    s_barrier
    v_mfma_f32_16x16x32_bf16 v[88:91], v[68:71], v[52:55], v[88:91]
    ds_read_b64_tr_b16 v[32:33], v5 offset:0
    v_mfma_f32_16x16x32_bf16 v[92:95], v[72:75], v[52:55], v[92:95]
    ds_read_b64_tr_b16 v[34:35], v5 offset:1024
    v_mfma_f32_16x16x32_bf16 v[96:99], v[76:79], v[52:55], v[96:99]
    ds_read_b128 v[16:19], v10 offset:0
    v_mfma_f32_16x16x32_bf16 v[100:103], v[80:83], v[52:55], v[100:103]
    ds_read_b64_tr_b16 v[36:37], v6 offset:0
    v_mfma_f32_16x16x32_bf16 v[104:107], v[68:71], v[56:59], v[104:107]
    ds_read_b64_tr_b16 v[38:39], v6 offset:1024
    v_mfma_f32_16x16x32_bf16 v[108:111], v[72:75], v[56:59], v[108:111]
    ds_read_b128 v[20:23], v10 offset:2048
    v_mfma_f32_16x16x32_bf16 v[112:115], v[76:79], v[56:59], v[112:115]
    ds_read_b64_tr_b16 v[40:41], v7 offset:0
    v_mfma_f32_16x16x32_bf16 v[116:119], v[80:83], v[56:59], v[116:119]
    ds_read_b64_tr_b16 v[42:43], v7 offset:1024
    v_mfma_f32_16x16x32_bf16 v[120:123], v[68:71], v[60:63], v[120:123]
    ds_read_b128 v[24:27], v10 offset:4096
    v_mfma_f32_16x16x32_bf16 v[124:127], v[72:75], v[60:63], v[124:127]
    ds_read_b64_tr_b16 v[44:45], v8 offset:0
    v_mfma_f32_16x16x32_bf16 v[128:131], v[76:79], v[60:63], v[128:131]
    ds_read_b64_tr_b16 v[46:47], v8 offset:1024
    v_mfma_f32_16x16x32_bf16 v[132:135], v[80:83], v[60:63], v[132:135]
    ds_read_b128 v[28:31], v10 offset:6144
    v_mfma_f32_16x16x32_bf16 v[136:139], v[68:71], v[64:67], v[136:139]
    v_mfma_f32_16x16x32_bf16 v[140:143], v[72:75], v[64:67], v[140:143]
    v_mfma_f32_16x16x32_bf16 v[144:147], v[76:79], v[64:67], v[144:147]
    v_mfma_f32_16x16x32_bf16 v[148:151], v[80:83], v[64:67], v[148:151]
    s_waitcnt lgkmcnt(0)
    v_mfma_f32_16x16x32_bf16 v[88:91], v[32:35], v[16:19], v[88:91]
    ds_read_b64_tr_b16 v[68:69], v5 offset:8192
    v_mfma_f32_16x16x32_bf16 v[92:95], v[36:39], v[16:19], v[92:95]
    ds_read_b64_tr_b16 v[70:71], v5 offset:9216
    v_mfma_f32_16x16x32_bf16 v[96:99], v[40:43], v[16:19], v[96:99]
    ds_read_b128 v[52:55], v11 offset:0
    v_mfma_f32_16x16x32_bf16 v[100:103], v[44:47], v[16:19], v[100:103]
    ds_read_b64_tr_b16 v[72:73], v6 offset:8192
    v_mfma_f32_16x16x32_bf16 v[104:107], v[32:35], v[20:23], v[104:107]
    ds_read_b64_tr_b16 v[74:75], v6 offset:9216
    v_mfma_f32_16x16x32_bf16 v[108:111], v[36:39], v[20:23], v[108:111]
    ds_read_b128 v[56:59], v11 offset:2048
    v_mfma_f32_16x16x32_bf16 v[112:115], v[40:43], v[20:23], v[112:115]
    ds_read_b64_tr_b16 v[76:77], v7 offset:8192
    v_mfma_f32_16x16x32_bf16 v[116:119], v[44:47], v[20:23], v[116:119]
    ds_read_b64_tr_b16 v[78:79], v7 offset:9216
    v_mfma_f32_16x16x32_bf16 v[120:123], v[32:35], v[24:27], v[120:123]
    ds_read_b128 v[60:63], v11 offset:4096
    v_mfma_f32_16x16x32_bf16 v[124:127], v[36:39], v[24:27], v[124:127]
    ds_read_b64_tr_b16 v[80:81], v8 offset:8192
    v_mfma_f32_16x16x32_bf16 v[128:131], v[40:43], v[24:27], v[128:131]
    ds_read_b64_tr_b16 v[82:83], v8 offset:9216
    v_mfma_f32_16x16x32_bf16 v[132:135], v[44:47], v[24:27], v[132:135]
    ds_read_b128 v[64:67], v11 offset:6144
    v_mfma_f32_16x16x32_bf16 v[136:139], v[32:35], v[28:31], v[136:139]
    v_mfma_f32_16x16x32_bf16 v[140:143], v[36:39], v[28:31], v[140:143]
    v_mfma_f32_16x16x32_bf16 v[144:147], v[40:43], v[28:31], v[144:147]
    v_mfma_f32_16x16x32_bf16 v[148:151], v[44:47], v[28:31], v[148:151]
    s_waitcnt lgkmcnt(0)
    s_barrier
    v_mfma_f32_16x16x32_bf16 v[88:91], v[68:71], v[52:55], v[88:91]
    ds_read_b64_tr_b16 v[32:33], v5 offset:16384
    v_mfma_f32_16x16x32_bf16 v[92:95], v[72:75], v[52:55], v[92:95]
    ds_read_b64_tr_b16 v[34:35], v5 offset:17408
    v_mfma_f32_16x16x32_bf16 v[96:99], v[76:79], v[52:55], v[96:99]
    ds_read_b128 v[16:19], v10 offset:32768
    v_mfma_f32_16x16x32_bf16 v[100:103], v[80:83], v[52:55], v[100:103]
    ds_read_b64_tr_b16 v[36:37], v6 offset:16384
    v_mfma_f32_16x16x32_bf16 v[104:107], v[68:71], v[56:59], v[104:107]
    ds_read_b64_tr_b16 v[38:39], v6 offset:17408
    v_mfma_f32_16x16x32_bf16 v[108:111], v[72:75], v[56:59], v[108:111]
    ds_read_b128 v[20:23], v10 offset:34816
    v_mfma_f32_16x16x32_bf16 v[112:115], v[76:79], v[56:59], v[112:115]
    ds_read_b64_tr_b16 v[40:41], v7 offset:16384
    v_mfma_f32_16x16x32_bf16 v[116:119], v[80:83], v[56:59], v[116:119]
    ds_read_b64_tr_b16 v[42:43], v7 offset:17408
    v_mfma_f32_16x16x32_bf16 v[120:123], v[68:71], v[60:63], v[120:123]
    ds_read_b128 v[24:27], v10 offset:36864
    v_mfma_f32_16x16x32_bf16 v[124:127], v[72:75], v[60:63], v[124:127]
    ds_read_b64_tr_b16 v[44:45], v8 offset:16384
    v_mfma_f32_16x16x32_bf16 v[128:131], v[76:79], v[60:63], v[128:131]
    ds_read_b64_tr_b16 v[46:47], v8 offset:17408
    v_mfma_f32_16x16x32_bf16 v[132:135], v[80:83], v[60:63], v[132:135]
    ds_read_b128 v[28:31], v10 offset:38912
    v_mfma_f32_16x16x32_bf16 v[136:139], v[68:71], v[64:67], v[136:139]
    v_mfma_f32_16x16x32_bf16 v[140:143], v[72:75], v[64:67], v[140:143]
    v_mfma_f32_16x16x32_bf16 v[144:147], v[76:79], v[64:67], v[144:147]
    v_mfma_f32_16x16x32_bf16 v[148:151], v[80:83], v[64:67], v[148:151]
    s_waitcnt lgkmcnt(0)
    v_mfma_f32_16x16x32_bf16 v[88:91], v[32:35], v[16:19], v[88:91]
    ds_read_b64_tr_b16 v[68:69], v5 offset:24576
    v_mfma_f32_16x16x32_bf16 v[92:95], v[36:39], v[16:19], v[92:95]
    ds_read_b64_tr_b16 v[70:71], v5 offset:25600
    v_mfma_f32_16x16x32_bf16 v[96:99], v[40:43], v[16:19], v[96:99]
    ds_read_b128 v[52:55], v11 offset:32768
    v_mfma_f32_16x16x32_bf16 v[100:103], v[44:47], v[16:19], v[100:103]
    ds_read_b64_tr_b16 v[72:73], v6 offset:24576
    v_mfma_f32_16x16x32_bf16 v[104:107], v[32:35], v[20:23], v[104:107]
    ds_read_b64_tr_b16 v[74:75], v6 offset:25600
    v_mfma_f32_16x16x32_bf16 v[108:111], v[36:39], v[20:23], v[108:111]
    ds_read_b128 v[56:59], v11 offset:34816
    v_mfma_f32_16x16x32_bf16 v[112:115], v[40:43], v[20:23], v[112:115]
    ds_read_b64_tr_b16 v[76:77], v7 offset:24576
    v_mfma_f32_16x16x32_bf16 v[116:119], v[44:47], v[20:23], v[116:119]
    ds_read_b64_tr_b16 v[78:79], v7 offset:25600
    v_mfma_f32_16x16x32_bf16 v[120:123], v[32:35], v[24:27], v[120:123]
    ds_read_b128 v[60:63], v11 offset:36864
    v_mfma_f32_16x16x32_bf16 v[124:127], v[36:39], v[24:27], v[124:127]
    ds_read_b64_tr_b16 v[80:81], v8 offset:24576
    v_mfma_f32_16x16x32_bf16 v[128:131], v[40:43], v[24:27], v[128:131]
    ds_read_b64_tr_b16 v[82:83], v8 offset:25600
    v_mfma_f32_16x16x32_bf16 v[132:135], v[44:47], v[24:27], v[132:135]
    ds_read_b128 v[64:67], v11 offset:38912
    v_mfma_f32_16x16x32_bf16 v[136:139], v[32:35], v[28:31], v[136:139]
    v_mfma_f32_16x16x32_bf16 v[140:143], v[36:39], v[28:31], v[140:143]
    v_mfma_f32_16x16x32_bf16 v[144:147], v[40:43], v[28:31], v[144:147]
    v_mfma_f32_16x16x32_bf16 v[148:151], v[44:47], v[28:31], v[148:151]
    s_waitcnt lgkmcnt(0)
    s_barrier
    v_mfma_f32_16x16x32_bf16 v[88:91], v[68:71], v[52:55], v[88:91]
    ds_read_b64_tr_b16 v[32:33], v5 offset:32768
    v_mfma_f32_16x16x32_bf16 v[92:95], v[72:75], v[52:55], v[92:95]
    ds_read_b64_tr_b16 v[34:35], v5 offset:33792
    v_mfma_f32_16x16x32_bf16 v[96:99], v[76:79], v[52:55], v[96:99]
    ds_read_b128 v[16:19], v12 offset:0
    v_mfma_f32_16x16x32_bf16 v[100:103], v[80:83], v[52:55], v[100:103]
    ds_read_b64_tr_b16 v[36:37], v6 offset:32768
    v_mfma_f32_16x16x32_bf16 v[104:107], v[68:71], v[56:59], v[104:107]
    ds_read_b64_tr_b16 v[38:39], v6 offset:33792
    v_mfma_f32_16x16x32_bf16 v[108:111], v[72:75], v[56:59], v[108:111]
    ds_read_b128 v[20:23], v12 offset:2048
    v_mfma_f32_16x16x32_bf16 v[112:115], v[76:79], v[56:59], v[112:115]
    ds_read_b64_tr_b16 v[40:41], v7 offset:32768
    v_mfma_f32_16x16x32_bf16 v[116:119], v[80:83], v[56:59], v[116:119]
    ds_read_b64_tr_b16 v[42:43], v7 offset:33792
    v_mfma_f32_16x16x32_bf16 v[120:123], v[68:71], v[60:63], v[120:123]
    ds_read_b128 v[24:27], v12 offset:4096
    v_mfma_f32_16x16x32_bf16 v[124:127], v[72:75], v[60:63], v[124:127]
    ds_read_b64_tr_b16 v[44:45], v8 offset:32768
    v_mfma_f32_16x16x32_bf16 v[128:131], v[76:79], v[60:63], v[128:131]
    ds_read_b64_tr_b16 v[46:47], v8 offset:33792
    v_mfma_f32_16x16x32_bf16 v[132:135], v[80:83], v[60:63], v[132:135]
    ds_read_b128 v[28:31], v12 offset:6144
    v_mfma_f32_16x16x32_bf16 v[136:139], v[68:71], v[64:67], v[136:139]
    v_mfma_f32_16x16x32_bf16 v[140:143], v[72:75], v[64:67], v[140:143]
    v_mfma_f32_16x16x32_bf16 v[144:147], v[76:79], v[64:67], v[144:147]
    v_mfma_f32_16x16x32_bf16 v[148:151], v[80:83], v[64:67], v[148:151]
    s_waitcnt lgkmcnt(0)
    v_mfma_f32_16x16x32_bf16 v[88:91], v[32:35], v[16:19], v[88:91]
    ds_read_b64_tr_b16 v[68:69], v5 offset:40960
    v_mfma_f32_16x16x32_bf16 v[92:95], v[36:39], v[16:19], v[92:95]
    ds_read_b64_tr_b16 v[70:71], v5 offset:41984
    v_mfma_f32_16x16x32_bf16 v[96:99], v[40:43], v[16:19], v[96:99]
    ds_read_b128 v[52:55], v13 offset:0
    v_mfma_f32_16x16x32_bf16 v[100:103], v[44:47], v[16:19], v[100:103]
    ds_read_b64_tr_b16 v[72:73], v6 offset:40960
    v_mfma_f32_16x16x32_bf16 v[104:107], v[32:35], v[20:23], v[104:107]
    ds_read_b64_tr_b16 v[74:75], v6 offset:41984
    v_mfma_f32_16x16x32_bf16 v[108:111], v[36:39], v[20:23], v[108:111]
    ds_read_b128 v[56:59], v13 offset:2048
    v_mfma_f32_16x16x32_bf16 v[112:115], v[40:43], v[20:23], v[112:115]
    ds_read_b64_tr_b16 v[76:77], v7 offset:40960
    v_mfma_f32_16x16x32_bf16 v[116:119], v[44:47], v[20:23], v[116:119]
    ds_read_b64_tr_b16 v[78:79], v7 offset:41984
    v_mfma_f32_16x16x32_bf16 v[120:123], v[32:35], v[24:27], v[120:123]
    ds_read_b128 v[60:63], v13 offset:4096
    v_mfma_f32_16x16x32_bf16 v[124:127], v[36:39], v[24:27], v[124:127]
    ds_read_b64_tr_b16 v[80:81], v8 offset:40960
    v_mfma_f32_16x16x32_bf16 v[128:131], v[40:43], v[24:27], v[128:131]
    ds_read_b64_tr_b16 v[82:83], v8 offset:41984
    v_mfma_f32_16x16x32_bf16 v[132:135], v[44:47], v[24:27], v[132:135]
    ds_read_b128 v[64:67], v13 offset:6144
    v_mfma_f32_16x16x32_bf16 v[136:139], v[32:35], v[28:31], v[136:139]
    v_mfma_f32_16x16x32_bf16 v[140:143], v[36:39], v[28:31], v[140:143]
    v_mfma_f32_16x16x32_bf16 v[144:147], v[40:43], v[28:31], v[144:147]
    v_mfma_f32_16x16x32_bf16 v[148:151], v[44:47], v[28:31], v[148:151]
    s_waitcnt lgkmcnt(0)
    s_barrier
    v_mfma_f32_16x16x32_bf16 v[88:91], v[68:71], v[52:55], v[88:91]
    ds_read_b64_tr_b16 v[32:33], v5 offset:0
    v_mfma_f32_16x16x32_bf16 v[92:95], v[72:75], v[52:55], v[92:95]
    ds_read_b64_tr_b16 v[34:35], v5 offset:1024
    v_mfma_f32_16x16x32_bf16 v[96:99], v[76:79], v[52:55], v[96:99]
    ds_read_b128 v[16:19], v10 offset:0
    v_mfma_f32_16x16x32_bf16 v[100:103], v[80:83], v[52:55], v[100:103]
    ds_read_b64_tr_b16 v[36:37], v6 offset:0
    v_mfma_f32_16x16x32_bf16 v[104:107], v[68:71], v[56:59], v[104:107]
    ds_read_b64_tr_b16 v[38:39], v6 offset:1024
    v_mfma_f32_16x16x32_bf16 v[108:111], v[72:75], v[56:59], v[108:111]
    ds_read_b128 v[20:23], v10 offset:2048
    v_mfma_f32_16x16x32_bf16 v[112:115], v[76:79], v[56:59], v[112:115]
    ds_read_b64_tr_b16 v[40:41], v7 offset:0
    v_mfma_f32_16x16x32_bf16 v[116:119], v[80:83], v[56:59], v[116:119]
    ds_read_b64_tr_b16 v[42:43], v7 offset:1024
    v_mfma_f32_16x16x32_bf16 v[120:123], v[68:71], v[60:63], v[120:123]
    ds_read_b128 v[24:27], v10 offset:4096
    v_mfma_f32_16x16x32_bf16 v[124:127], v[72:75], v[60:63], v[124:127]
    ds_read_b64_tr_b16 v[44:45], v8 offset:0
    v_mfma_f32_16x16x32_bf16 v[128:131], v[76:79], v[60:63], v[128:131]
    ds_read_b64_tr_b16 v[46:47], v8 offset:1024
    v_mfma_f32_16x16x32_bf16 v[132:135], v[80:83], v[60:63], v[132:135]
    ds_read_b128 v[28:31], v10 offset:6144
    v_mfma_f32_16x16x32_bf16 v[136:139], v[68:71], v[64:67], v[136:139]
    v_mfma_f32_16x16x32_bf16 v[140:143], v[72:75], v[64:67], v[140:143]
    v_mfma_f32_16x16x32_bf16 v[144:147], v[76:79], v[64:67], v[144:147]
    v_mfma_f32_16x16x32_bf16 v[148:151], v[80:83], v[64:67], v[148:151]
    s_waitcnt lgkmcnt(0)
    v_mfma_f32_16x16x32_bf16 v[88:91], v[32:35], v[16:19], v[88:91]
    ds_read_b64_tr_b16 v[68:69], v5 offset:8192
    v_mfma_f32_16x16x32_bf16 v[92:95], v[36:39], v[16:19], v[92:95]
    ds_read_b64_tr_b16 v[70:71], v5 offset:9216
    v_mfma_f32_16x16x32_bf16 v[96:99], v[40:43], v[16:19], v[96:99]
    ds_read_b128 v[52:55], v11 offset:0
    v_mfma_f32_16x16x32_bf16 v[100:103], v[44:47], v[16:19], v[100:103]
    ds_read_b64_tr_b16 v[72:73], v6 offset:8192
    v_mfma_f32_16x16x32_bf16 v[104:107], v[32:35], v[20:23], v[104:107]
    ds_read_b64_tr_b16 v[74:75], v6 offset:9216
    v_mfma_f32_16x16x32_bf16 v[108:111], v[36:39], v[20:23], v[108:111]
    ds_read_b128 v[56:59], v11 offset:2048
    v_mfma_f32_16x16x32_bf16 v[112:115], v[40:43], v[20:23], v[112:115]
    ds_read_b64_tr_b16 v[76:77], v7 offset:8192
    v_mfma_f32_16x16x32_bf16 v[116:119], v[44:47], v[20:23], v[116:119]
    ds_read_b64_tr_b16 v[78:79], v7 offset:9216
    v_mfma_f32_16x16x32_bf16 v[120:123], v[32:35], v[24:27], v[120:123]
    ds_read_b128 v[60:63], v11 offset:4096
    v_mfma_f32_16x16x32_bf16 v[124:127], v[36:39], v[24:27], v[124:127]
    ds_read_b64_tr_b16 v[80:81], v8 offset:8192
    v_mfma_f32_16x16x32_bf16 v[128:131], v[40:43], v[24:27], v[128:131]
    ds_read_b64_tr_b16 v[82:83], v8 offset:9216
    v_mfma_f32_16x16x32_bf16 v[132:135], v[44:47], v[24:27], v[132:135]
    ds_read_b128 v[64:67], v11 offset:6144
    v_mfma_f32_16x16x32_bf16 v[136:139], v[32:35], v[28:31], v[136:139]
    v_mfma_f32_16x16x32_bf16 v[140:143], v[36:39], v[28:31], v[140:143]
    v_mfma_f32_16x16x32_bf16 v[144:147], v[40:43], v[28:31], v[144:147]
    v_mfma_f32_16x16x32_bf16 v[148:151], v[44:47], v[28:31], v[148:151]
    s_waitcnt lgkmcnt(0)
    v_mfma_f32_16x16x32_bf16 v[88:91], v[68:71], v[52:55], v[88:91]
    v_mfma_f32_16x16x32_bf16 v[92:95], v[72:75], v[52:55], v[92:95]
    v_mfma_f32_16x16x32_bf16 v[96:99], v[76:79], v[52:55], v[96:99]
    v_mfma_f32_16x16x32_bf16 v[100:103], v[80:83], v[52:55], v[100:103]
    v_mfma_f32_16x16x32_bf16 v[104:107], v[68:71], v[56:59], v[104:107]
    v_mfma_f32_16x16x32_bf16 v[108:111], v[72:75], v[56:59], v[108:111]
    v_mfma_f32_16x16x32_bf16 v[112:115], v[76:79], v[56:59], v[112:115]
    v_mfma_f32_16x16x32_bf16 v[116:119], v[80:83], v[56:59], v[116:119]
    v_mfma_f32_16x16x32_bf16 v[120:123], v[68:71], v[60:63], v[120:123]
    v_mfma_f32_16x16x32_bf16 v[124:127], v[72:75], v[60:63], v[124:127]
    v_mfma_f32_16x16x32_bf16 v[128:131], v[76:79], v[60:63], v[128:131]
    v_mfma_f32_16x16x32_bf16 v[132:135], v[80:83], v[60:63], v[132:135]
    v_mfma_f32_16x16x32_bf16 v[136:139], v[68:71], v[64:67], v[136:139]
    v_mfma_f32_16x16x32_bf16 v[140:143], v[72:75], v[64:67], v[140:143]
    v_mfma_f32_16x16x32_bf16 v[144:147], v[76:79], v[64:67], v[144:147]
    v_mfma_f32_16x16x32_bf16 v[148:151], v[80:83], v[64:67], v[148:151]
    s_waitcnt vmcnt(0)
    s_cmp_lg_u32 s31, 0
    s_cbranch_scc1 k1_nophi_40
    s_mov_b32 s42, 0x3fb8aa3b
    s_mov_b32 s43, 0x3fb8aa3b
    s_mov_b32 s44, 0x358637bd
    v_pk_mul_f32 v[16:17], v[88:89], s[42:43]
    v_pk_mul_f32 v[18:19], v[90:91], s[42:43]
    v_pk_mul_f32 v[20:21], v[104:105], s[42:43]
    v_pk_mul_f32 v[22:23], v[106:107], s[42:43]
    v_exp_f32 v16, v16 clamp
    v_exp_f32 v17, v17 clamp
    v_exp_f32 v18, v18 clamp
    v_exp_f32 v19, v19 clamp
    v_exp_f32 v20, v20 clamp
    v_exp_f32 v21, v21 clamp
    v_exp_f32 v22, v22 clamp
    v_exp_f32 v23, v23 clamp
    v_max_f32 v88, s44, v88
    v_max_f32 v89, s44, v89
    v_max_f32 v90, s44, v90
    v_max_f32 v91, s44, v91
    v_max_f32 v104, s44, v104
    v_max_f32 v105, s44, v105
    v_max_f32 v106, s44, v106
    v_max_f32 v107, s44, v107
    v_pk_add_f32 v[88:89], v[88:89], v[16:17]
    v_pk_add_f32 v[90:91], v[90:91], v[18:19]
    v_pk_add_f32 v[104:105], v[104:105], v[20:21]
    v_pk_add_f32 v[106:107], v[106:107], v[22:23]
    v_cvt_pk_bf16_f32 v32, v88, v89
    v_cvt_pk_bf16_f32 v33, v90, v91
    v_cvt_pk_bf16_f32 v34, v104, v105
    v_cvt_pk_bf16_f32 v35, v106, v107
    buffer_store_dwordx4 v[32:35], v152, s[16:19], 0 offen offset:0 sc1
    v_pk_mul_f32 v[24:25], v[92:93], s[42:43]
    v_pk_mul_f32 v[26:27], v[94:95], s[42:43]
    v_pk_mul_f32 v[28:29], v[108:109], s[42:43]
    v_pk_mul_f32 v[30:31], v[110:111], s[42:43]
    v_exp_f32 v24, v24 clamp
    v_exp_f32 v25, v25 clamp
    v_exp_f32 v26, v26 clamp
    v_exp_f32 v27, v27 clamp
    v_exp_f32 v28, v28 clamp
    v_exp_f32 v29, v29 clamp
    v_exp_f32 v30, v30 clamp
    v_exp_f32 v31, v31 clamp
    v_max_f32 v92, s44, v92
    v_max_f32 v93, s44, v93
    v_max_f32 v94, s44, v94
    v_max_f32 v95, s44, v95
    v_max_f32 v108, s44, v108
    v_max_f32 v109, s44, v109
    v_max_f32 v110, s44, v110
    v_max_f32 v111, s44, v111
    v_pk_add_f32 v[92:93], v[92:93], v[24:25]
    v_pk_add_f32 v[94:95], v[94:95], v[26:27]
    v_pk_add_f32 v[108:109], v[108:109], v[28:29]
    v_pk_add_f32 v[110:111], v[110:111], v[30:31]
    v_cvt_pk_bf16_f32 v36, v92, v93
    v_cvt_pk_bf16_f32 v37, v94, v95
    v_cvt_pk_bf16_f32 v38, v108, v109
    v_cvt_pk_bf16_f32 v39, v110, v111
    buffer_store_dwordx4 v[36:39], v153, s[16:19], 0 offen offset:0 sc1
    v_pk_mul_f32 v[16:17], v[96:97], s[42:43]
    v_pk_mul_f32 v[18:19], v[98:99], s[42:43]
    v_pk_mul_f32 v[20:21], v[112:113], s[42:43]
    v_pk_mul_f32 v[22:23], v[114:115], s[42:43]
    v_exp_f32 v16, v16 clamp
    v_exp_f32 v17, v17 clamp
    v_exp_f32 v18, v18 clamp
    v_exp_f32 v19, v19 clamp
    v_exp_f32 v20, v20 clamp
    v_exp_f32 v21, v21 clamp
    v_exp_f32 v22, v22 clamp
    v_exp_f32 v23, v23 clamp
    v_max_f32 v96, s44, v96
    v_max_f32 v97, s44, v97
    v_max_f32 v98, s44, v98
    v_max_f32 v99, s44, v99
    v_max_f32 v112, s44, v112
    v_max_f32 v113, s44, v113
    v_max_f32 v114, s44, v114
    v_max_f32 v115, s44, v115
    v_pk_add_f32 v[96:97], v[96:97], v[16:17]
    v_pk_add_f32 v[98:99], v[98:99], v[18:19]
    v_pk_add_f32 v[112:113], v[112:113], v[20:21]
    v_pk_add_f32 v[114:115], v[114:115], v[22:23]
    v_cvt_pk_bf16_f32 v40, v96, v97
    v_cvt_pk_bf16_f32 v41, v98, v99
    v_cvt_pk_bf16_f32 v42, v112, v113
    v_cvt_pk_bf16_f32 v43, v114, v115
    buffer_store_dwordx4 v[40:43], v154, s[16:19], 0 offen offset:0 sc1
    v_pk_mul_f32 v[24:25], v[100:101], s[42:43]
    v_pk_mul_f32 v[26:27], v[102:103], s[42:43]
    v_pk_mul_f32 v[28:29], v[116:117], s[42:43]
    v_pk_mul_f32 v[30:31], v[118:119], s[42:43]
    v_exp_f32 v24, v24 clamp
    v_exp_f32 v25, v25 clamp
    v_exp_f32 v26, v26 clamp
    v_exp_f32 v27, v27 clamp
    v_exp_f32 v28, v28 clamp
    v_exp_f32 v29, v29 clamp
    v_exp_f32 v30, v30 clamp
    v_exp_f32 v31, v31 clamp
    v_max_f32 v100, s44, v100
    v_max_f32 v101, s44, v101
    v_max_f32 v102, s44, v102
    v_max_f32 v103, s44, v103
    v_max_f32 v116, s44, v116
    v_max_f32 v117, s44, v117
    v_max_f32 v118, s44, v118
    v_max_f32 v119, s44, v119
    v_pk_add_f32 v[100:101], v[100:101], v[24:25]
    v_pk_add_f32 v[102:103], v[102:103], v[26:27]
    v_pk_add_f32 v[116:117], v[116:117], v[28:29]
    v_pk_add_f32 v[118:119], v[118:119], v[30:31]
    v_cvt_pk_bf16_f32 v44, v100, v101
    v_cvt_pk_bf16_f32 v45, v102, v103
    v_cvt_pk_bf16_f32 v46, v116, v117
    v_cvt_pk_bf16_f32 v47, v118, v119
    buffer_store_dwordx4 v[44:47], v155, s[16:19], 0 offen offset:0 sc1
    v_pk_mul_f32 v[16:17], v[120:121], s[42:43]
    v_pk_mul_f32 v[18:19], v[122:123], s[42:43]
    v_pk_mul_f32 v[20:21], v[136:137], s[42:43]
    v_pk_mul_f32 v[22:23], v[138:139], s[42:43]
    v_exp_f32 v16, v16 clamp
    v_exp_f32 v17, v17 clamp
    v_exp_f32 v18, v18 clamp
    v_exp_f32 v19, v19 clamp
    v_exp_f32 v20, v20 clamp
    v_exp_f32 v21, v21 clamp
    v_exp_f32 v22, v22 clamp
    v_exp_f32 v23, v23 clamp
    v_max_f32 v120, s44, v120
    v_max_f32 v121, s44, v121
    v_max_f32 v122, s44, v122
    v_max_f32 v123, s44, v123
    v_max_f32 v136, s44, v136
    v_max_f32 v137, s44, v137
    v_max_f32 v138, s44, v138
    v_max_f32 v139, s44, v139
    v_pk_add_f32 v[120:121], v[120:121], v[16:17]
    v_pk_add_f32 v[122:123], v[122:123], v[18:19]
    v_pk_add_f32 v[136:137], v[136:137], v[20:21]
    v_pk_add_f32 v[138:139], v[138:139], v[22:23]
    v_cvt_pk_bf16_f32 v48, v120, v121
    v_cvt_pk_bf16_f32 v49, v122, v123
    v_cvt_pk_bf16_f32 v50, v136, v137
    v_cvt_pk_bf16_f32 v51, v138, v139
    buffer_store_dwordx4 v[48:51], v152, s[16:19], 0 offen offset:1280 sc1
    v_pk_mul_f32 v[24:25], v[124:125], s[42:43]
    v_pk_mul_f32 v[26:27], v[126:127], s[42:43]
    v_pk_mul_f32 v[28:29], v[140:141], s[42:43]
    v_pk_mul_f32 v[30:31], v[142:143], s[42:43]
    v_exp_f32 v24, v24 clamp
    v_exp_f32 v25, v25 clamp
    v_exp_f32 v26, v26 clamp
    v_exp_f32 v27, v27 clamp
    v_exp_f32 v28, v28 clamp
    v_exp_f32 v29, v29 clamp
    v_exp_f32 v30, v30 clamp
    v_exp_f32 v31, v31 clamp
    v_max_f32 v124, s44, v124
    v_max_f32 v125, s44, v125
    v_max_f32 v126, s44, v126
    v_max_f32 v127, s44, v127
    v_max_f32 v140, s44, v140
    v_max_f32 v141, s44, v141
    v_max_f32 v142, s44, v142
    v_max_f32 v143, s44, v143
    v_pk_add_f32 v[124:125], v[124:125], v[24:25]
    v_pk_add_f32 v[126:127], v[126:127], v[26:27]
    v_pk_add_f32 v[140:141], v[140:141], v[28:29]
    v_pk_add_f32 v[142:143], v[142:143], v[30:31]
    v_cvt_pk_bf16_f32 v52, v124, v125
    v_cvt_pk_bf16_f32 v53, v126, v127
    v_cvt_pk_bf16_f32 v54, v140, v141
    v_cvt_pk_bf16_f32 v55, v142, v143
    buffer_store_dwordx4 v[52:55], v153, s[16:19], 0 offen offset:1280 sc1
    v_pk_mul_f32 v[16:17], v[128:129], s[42:43]
    v_pk_mul_f32 v[18:19], v[130:131], s[42:43]
    v_pk_mul_f32 v[20:21], v[144:145], s[42:43]
    v_pk_mul_f32 v[22:23], v[146:147], s[42:43]
    v_exp_f32 v16, v16 clamp
    v_exp_f32 v17, v17 clamp
    v_exp_f32 v18, v18 clamp
    v_exp_f32 v19, v19 clamp
    v_exp_f32 v20, v20 clamp
    v_exp_f32 v21, v21 clamp
    v_exp_f32 v22, v22 clamp
    v_exp_f32 v23, v23 clamp
    v_max_f32 v128, s44, v128
    v_max_f32 v129, s44, v129
    v_max_f32 v130, s44, v130
    v_max_f32 v131, s44, v131
    v_max_f32 v144, s44, v144
    v_max_f32 v145, s44, v145
    v_max_f32 v146, s44, v146
    v_max_f32 v147, s44, v147
    v_pk_add_f32 v[128:129], v[128:129], v[16:17]
    v_pk_add_f32 v[130:131], v[130:131], v[18:19]
    v_pk_add_f32 v[144:145], v[144:145], v[20:21]
    v_pk_add_f32 v[146:147], v[146:147], v[22:23]
    v_cvt_pk_bf16_f32 v56, v128, v129
    v_cvt_pk_bf16_f32 v57, v130, v131
    v_cvt_pk_bf16_f32 v58, v144, v145
    v_cvt_pk_bf16_f32 v59, v146, v147
    buffer_store_dwordx4 v[56:59], v154, s[16:19], 0 offen offset:1280 sc1
    v_pk_mul_f32 v[24:25], v[132:133], s[42:43]
    v_pk_mul_f32 v[26:27], v[134:135], s[42:43]
    v_pk_mul_f32 v[28:29], v[148:149], s[42:43]
    v_pk_mul_f32 v[30:31], v[150:151], s[42:43]
    v_exp_f32 v24, v24 clamp
    v_exp_f32 v25, v25 clamp
    v_exp_f32 v26, v26 clamp
    v_exp_f32 v27, v27 clamp
    v_exp_f32 v28, v28 clamp
    v_exp_f32 v29, v29 clamp
    v_exp_f32 v30, v30 clamp
    v_exp_f32 v31, v31 clamp
    v_max_f32 v132, s44, v132
    v_max_f32 v133, s44, v133
    v_max_f32 v134, s44, v134
    v_max_f32 v135, s44, v135
    v_max_f32 v148, s44, v148
    v_max_f32 v149, s44, v149
    v_max_f32 v150, s44, v150
    v_max_f32 v151, s44, v151
    v_pk_add_f32 v[132:133], v[132:133], v[24:25]
    v_pk_add_f32 v[134:135], v[134:135], v[26:27]
    v_pk_add_f32 v[148:149], v[148:149], v[28:29]
    v_pk_add_f32 v[150:151], v[150:151], v[30:31]
    v_cvt_pk_bf16_f32 v60, v132, v133
    v_cvt_pk_bf16_f32 v61, v134, v135
    v_cvt_pk_bf16_f32 v62, v148, v149
    v_cvt_pk_bf16_f32 v63, v150, v151
    buffer_store_dwordx4 v[60:63], v155, s[16:19], 0 offen offset:1280 sc1
    s_branch k1_done_35
k1_nophi_40:
    s_cmp_lg_u32 s32, 0
    s_cbranch_scc1 k1_plain_41
    s_mov_b32 s42, 0x3ea52b5c
    s_mov_b32 s43, 0x3ea52b5c
    v_pk_mul_f32 v[88:89], v[88:89], s[42:43]
    v_pk_mul_f32 v[90:91], v[90:91], s[42:43]
    v_pk_mul_f32 v[104:105], v[104:105], s[42:43]
    v_pk_mul_f32 v[106:107], v[106:107], s[42:43]
    v_cvt_pk_bf16_f32 v32, v88, v89
    v_cvt_pk_bf16_f32 v33, v90, v91
    v_cvt_pk_bf16_f32 v34, v104, v105
    v_cvt_pk_bf16_f32 v35, v106, v107
    buffer_store_dwordx4 v[32:35], v152, s[16:19], 0 offen offset:0 sc1
    v_pk_mul_f32 v[92:93], v[92:93], s[42:43]
    v_pk_mul_f32 v[94:95], v[94:95], s[42:43]
    v_pk_mul_f32 v[108:109], v[108:109], s[42:43]
    v_pk_mul_f32 v[110:111], v[110:111], s[42:43]
    v_cvt_pk_bf16_f32 v36, v92, v93
    v_cvt_pk_bf16_f32 v37, v94, v95
    v_cvt_pk_bf16_f32 v38, v108, v109
    v_cvt_pk_bf16_f32 v39, v110, v111
    buffer_store_dwordx4 v[36:39], v153, s[16:19], 0 offen offset:0 sc1
    v_pk_mul_f32 v[96:97], v[96:97], s[42:43]
    v_pk_mul_f32 v[98:99], v[98:99], s[42:43]
    v_pk_mul_f32 v[112:113], v[112:113], s[42:43]
    v_pk_mul_f32 v[114:115], v[114:115], s[42:43]
    v_cvt_pk_bf16_f32 v40, v96, v97
    v_cvt_pk_bf16_f32 v41, v98, v99
    v_cvt_pk_bf16_f32 v42, v112, v113
    v_cvt_pk_bf16_f32 v43, v114, v115
    buffer_store_dwordx4 v[40:43], v154, s[16:19], 0 offen offset:0 sc1
    v_pk_mul_f32 v[100:101], v[100:101], s[42:43]
    v_pk_mul_f32 v[102:103], v[102:103], s[42:43]
    v_pk_mul_f32 v[116:117], v[116:117], s[42:43]
    v_pk_mul_f32 v[118:119], v[118:119], s[42:43]
    v_cvt_pk_bf16_f32 v44, v100, v101
    v_cvt_pk_bf16_f32 v45, v102, v103
    v_cvt_pk_bf16_f32 v46, v116, v117
    v_cvt_pk_bf16_f32 v47, v118, v119
    buffer_store_dwordx4 v[44:47], v155, s[16:19], 0 offen offset:0 sc1
    v_pk_mul_f32 v[120:121], v[120:121], s[42:43]
    v_pk_mul_f32 v[122:123], v[122:123], s[42:43]
    v_pk_mul_f32 v[136:137], v[136:137], s[42:43]
    v_pk_mul_f32 v[138:139], v[138:139], s[42:43]
    v_cvt_pk_bf16_f32 v48, v120, v121
    v_cvt_pk_bf16_f32 v49, v122, v123
    v_cvt_pk_bf16_f32 v50, v136, v137
    v_cvt_pk_bf16_f32 v51, v138, v139
    buffer_store_dwordx4 v[48:51], v152, s[16:19], 0 offen offset:1280 sc1
    v_pk_mul_f32 v[124:125], v[124:125], s[42:43]
    v_pk_mul_f32 v[126:127], v[126:127], s[42:43]
    v_pk_mul_f32 v[140:141], v[140:141], s[42:43]
    v_pk_mul_f32 v[142:143], v[142:143], s[42:43]
    v_cvt_pk_bf16_f32 v52, v124, v125
    v_cvt_pk_bf16_f32 v53, v126, v127
    v_cvt_pk_bf16_f32 v54, v140, v141
    v_cvt_pk_bf16_f32 v55, v142, v143
    buffer_store_dwordx4 v[52:55], v153, s[16:19], 0 offen offset:1280 sc1
    v_pk_mul_f32 v[128:129], v[128:129], s[42:43]
    v_pk_mul_f32 v[130:131], v[130:131], s[42:43]
    v_pk_mul_f32 v[144:145], v[144:145], s[42:43]
    v_pk_mul_f32 v[146:147], v[146:147], s[42:43]
    v_cvt_pk_bf16_f32 v56, v128, v129
    v_cvt_pk_bf16_f32 v57, v130, v131
    v_cvt_pk_bf16_f32 v58, v144, v145
    v_cvt_pk_bf16_f32 v59, v146, v147
    buffer_store_dwordx4 v[56:59], v154, s[16:19], 0 offen offset:1280 sc1
    v_pk_mul_f32 v[132:133], v[132:133], s[42:43]
    v_pk_mul_f32 v[134:135], v[134:135], s[42:43]
    v_pk_mul_f32 v[148:149], v[148:149], s[42:43]
    v_pk_mul_f32 v[150:151], v[150:151], s[42:43]
    v_cvt_pk_bf16_f32 v60, v132, v133
    v_cvt_pk_bf16_f32 v61, v134, v135
    v_cvt_pk_bf16_f32 v62, v148, v149
    v_cvt_pk_bf16_f32 v63, v150, v151
    buffer_store_dwordx4 v[60:63], v155, s[16:19], 0 offen offset:1280 sc1
    s_branch k1_done_35
k1_plain_41:
    v_cvt_pk_bf16_f32 v32, v88, v89
    v_cvt_pk_bf16_f32 v33, v90, v91
    v_cvt_pk_bf16_f32 v34, v104, v105
    v_cvt_pk_bf16_f32 v35, v106, v107
    buffer_store_dwordx4 v[32:35], v152, s[16:19], 0 offen offset:0 sc1
    v_cvt_pk_bf16_f32 v36, v92, v93
    v_cvt_pk_bf16_f32 v37, v94, v95
    v_cvt_pk_bf16_f32 v38, v108, v109
    v_cvt_pk_bf16_f32 v39, v110, v111
    buffer_store_dwordx4 v[36:39], v153, s[16:19], 0 offen offset:0 sc1
    v_cvt_pk_bf16_f32 v40, v96, v97
    v_cvt_pk_bf16_f32 v41, v98, v99
    v_cvt_pk_bf16_f32 v42, v112, v113
    v_cvt_pk_bf16_f32 v43, v114, v115
    buffer_store_dwordx4 v[40:43], v154, s[16:19], 0 offen offset:0 sc1
    v_cvt_pk_bf16_f32 v44, v100, v101
    v_cvt_pk_bf16_f32 v45, v102, v103
    v_cvt_pk_bf16_f32 v46, v116, v117
    v_cvt_pk_bf16_f32 v47, v118, v119
    buffer_store_dwordx4 v[44:47], v155, s[16:19], 0 offen offset:0 sc1
    v_cvt_pk_bf16_f32 v48, v120, v121
    v_cvt_pk_bf16_f32 v49, v122, v123
    v_cvt_pk_bf16_f32 v50, v136, v137
    v_cvt_pk_bf16_f32 v51, v138, v139
    buffer_store_dwordx4 v[48:51], v152, s[16:19], 0 offen offset:1280 sc1
    v_cvt_pk_bf16_f32 v52, v124, v125
    v_cvt_pk_bf16_f32 v53, v126, v127
    v_cvt_pk_bf16_f32 v54, v140, v141
    v_cvt_pk_bf16_f32 v55, v142, v143
    buffer_store_dwordx4 v[52:55], v153, s[16:19], 0 offen offset:1280 sc1
    v_cvt_pk_bf16_f32 v56, v128, v129
    v_cvt_pk_bf16_f32 v57, v130, v131
    v_cvt_pk_bf16_f32 v58, v144, v145
    v_cvt_pk_bf16_f32 v59, v146, v147
    buffer_store_dwordx4 v[56:59], v154, s[16:19], 0 offen offset:1280 sc1
    v_cvt_pk_bf16_f32 v60, v132, v133
    v_cvt_pk_bf16_f32 v61, v134, v135
    v_cvt_pk_bf16_f32 v62, v148, v149
    v_cvt_pk_bf16_f32 v63, v150, v151
    buffer_store_dwordx4 v[60:63], v155, s[16:19], 0 offen offset:1280 sc1
    s_branch k1_done_35
k1_col_33:
    s_cmp_lg_u32 s22, 0
    s_cbranch_scc1 k1_nt_42
    buffer_load_dword v4, v2, s[8:11], 0 offen offset:0
    s_mov_b32 s35, 0
    buffer_load_dword v4, v3, s[12:15], s35 offen
k1_nt_42:
    s_cmp_lg_u32 s22, 1
    s_cbranch_scc1 k1_nt_43
    buffer_load_dword v4, v2, s[8:11], 0 offen offset:128
    s_mov_b32 s35, 245760
    buffer_load_dword v4, v3, s[12:15], s35 offen
k1_nt_43:
    s_cmp_lg_u32 s22, 2
    s_cbranch_scc1 k1_nt_44
    buffer_load_dword v4, v2, s[8:11], 0 offen offset:256
    s_mov_b32 s35, 491520
    buffer_load_dword v4, v3, s[12:15], s35 offen
k1_nt_44:
    s_cmp_lg_u32 s22, 3
    s_cbranch_scc1 k1_nt_45
    buffer_load_dword v4, v2, s[8:11], 0 offen offset:384
    s_mov_b32 s35, 737280
    buffer_load_dword v4, v3, s[12:15], s35 offen
k1_nt_45:
    s_lshr_b32 s36, s22, 1
    s_and_b32 s37, s22, 1
    v_lshrrev_b32 v13, 4, v1
    v_bfe_u32 v14, v1, 2, 2
    v_lshl_add_u32 v15, v13, 3, v14
    v_lshlrev_b32 v15, 8, v15
    v_and_b32 v16, 3, v1
    v_lshl_add_u32 v15, v16, 3, v15
    v_and_b32 v16, 1, v13
    v_lshl_or_b32 v16, v16, 2, v14
    s_lshl_b32 s40, s37, 2
    s_add_u32 s39, s40, 0
    v_xor_b32 v17, s39, v16
    v_lshl_add_u32 v5, v17, 5, v15
    s_add_u32 s39, s40, 1
    v_xor_b32 v17, s39, v16
    v_lshl_add_u32 v6, v17, 5, v15
    s_add_u32 s39, s40, 2
    v_xor_b32 v17, s39, v16
    v_lshl_add_u32 v7, v17, 5, v15
    s_add_u32 s39, s40, 3
    v_xor_b32 v17, s39, v16
    v_lshl_add_u32 v8, v17, 5, v15
    s_lshl_b32 s63, s36, 6
    v_lshrrev_b32 v13, 4, v1
    v_and_b32 v14, 15, v1
    v_lshrrev_b32 v15, 1, v14
    v_xor_b32 v15, v15, v13
    s_lshl_b32 s39, s63, 7
    s_add_u32 s39, s39, 61440
    v_lshlrev_b32 v16, 7, v14
    v_add_u32 v16, s39, v16
    v_lshl_add_u32 v10, v15, 4, v16
    v_xor_b32 v11, 64, v10
    v_add_u32 v12, 0x10000, v10
    v_add_u32 v13, 0x10000, v11
    s_mul_i32 s40, s32, 2621440
    s_cmp_eq_u32 s31, 0
    s_cselect_b32 s40, 7864320, s40
    s_lshl_b32 s41, s20, 3
    s_lshl_b32 s39, s36, 1
    s_add_u32 s41, s41, s39
    s_mul_i32 s41, s41, 1280
    s_add_u32 s40, s40, s41
    s_lshl_b32 s39, s33, 7
    s_lshl_b32 s41, s37, 6
    s_add_u32 s39, s39, s41
    v_add_u32 v15, s39, v14
    v_lshrrev_b32 v19, 4, v1
    v_mul_u32_u24 v16, 320, v19
    v_add_u32 v16, s40, v16
    v_add_u32 v17, 0, v15
    v_mul_u32_u24 v18, 3277, v17
    v_lshrrev_b32 v18, 16, v18
    v_mul_u32_u24 v18, 81600, v18
    v_lshl_add_u32 v17, v17, 4, v16
    v_add_u32 v152, v17, v18
    v_add_u32 v17, 16, v15
    v_mul_u32_u24 v18, 3277, v17
    v_lshrrev_b32 v18, 16, v18
    v_mul_u32_u24 v18, 81600, v18
    v_lshl_add_u32 v17, v17, 4, v16
    v_add_u32 v153, v17, v18
    v_add_u32 v17, 32, v15
    v_mul_u32_u24 v18, 3277, v17
    v_lshrrev_b32 v18, 16, v18
    v_mul_u32_u24 v18, 81600, v18
    v_lshl_add_u32 v17, v17, 4, v16
    v_add_u32 v154, v17, v18
    v_add_u32 v17, 48, v15
    v_mul_u32_u24 v18, 3277, v17
    v_lshrrev_b32 v18, 16, v18
    v_mul_u32_u24 v18, 81600, v18
    v_lshl_add_u32 v17, v17, 4, v16
    v_add_u32 v155, v17, v18
    s_barrier
    ds_read_b64_tr_b16 v[32:33], v5 offset:0
    ds_read_b64_tr_b16 v[34:35], v5 offset:1024
    ds_read_b128 v[16:19], v10 offset:0
    ds_read_b64_tr_b16 v[36:37], v6 offset:0
    ds_read_b64_tr_b16 v[38:39], v6 offset:1024
    ds_read_b128 v[20:23], v10 offset:2048
    ds_read_b64_tr_b16 v[40:41], v7 offset:0
    ds_read_b64_tr_b16 v[42:43], v7 offset:1024
    ds_read_b128 v[24:27], v10 offset:4096
    ds_read_b64_tr_b16 v[44:45], v8 offset:0
    ds_read_b64_tr_b16 v[46:47], v8 offset:1024
    ds_read_b128 v[28:31], v10 offset:6144
    s_waitcnt lgkmcnt(0)
    v_mfma_f32_16x16x32_bf16 v[88:91], v[16:19], v[32:35], 0
    ds_read_b64_tr_b16 v[68:69], v5 offset:8192
    v_mfma_f32_16x16x32_bf16 v[92:95], v[16:19], v[36:39], 0
    ds_read_b64_tr_b16 v[70:71], v5 offset:9216
    v_mfma_f32_16x16x32_bf16 v[96:99], v[16:19], v[40:43], 0
    ds_read_b128 v[52:55], v11 offset:0
    v_mfma_f32_16x16x32_bf16 v[100:103], v[16:19], v[44:47], 0
    ds_read_b64_tr_b16 v[72:73], v6 offset:8192
    v_mfma_f32_16x16x32_bf16 v[104:107], v[20:23], v[32:35], 0
    ds_read_b64_tr_b16 v[74:75], v6 offset:9216
    v_mfma_f32_16x16x32_bf16 v[108:111], v[20:23], v[36:39], 0
    ds_read_b128 v[56:59], v11 offset:2048
    v_mfma_f32_16x16x32_bf16 v[112:115], v[20:23], v[40:43], 0
    ds_read_b64_tr_b16 v[76:77], v7 offset:8192
    v_mfma_f32_16x16x32_bf16 v[116:119], v[20:23], v[44:47], 0
    ds_read_b64_tr_b16 v[78:79], v7 offset:9216
    v_mfma_f32_16x16x32_bf16 v[120:123], v[24:27], v[32:35], 0
    ds_read_b128 v[60:63], v11 offset:4096
    v_mfma_f32_16x16x32_bf16 v[124:127], v[24:27], v[36:39], 0
    ds_read_b64_tr_b16 v[80:81], v8 offset:8192
    v_mfma_f32_16x16x32_bf16 v[128:131], v[24:27], v[40:43], 0
    ds_read_b64_tr_b16 v[82:83], v8 offset:9216
    v_mfma_f32_16x16x32_bf16 v[132:135], v[24:27], v[44:47], 0
    ds_read_b128 v[64:67], v11 offset:6144
    v_mfma_f32_16x16x32_bf16 v[136:139], v[28:31], v[32:35], 0
    v_mfma_f32_16x16x32_bf16 v[140:143], v[28:31], v[36:39], 0
    v_mfma_f32_16x16x32_bf16 v[144:147], v[28:31], v[40:43], 0
    v_mfma_f32_16x16x32_bf16 v[148:151], v[28:31], v[44:47], 0
    s_waitcnt lgkmcnt(0)
    s_barrier
    v_mfma_f32_16x16x32_bf16 v[88:91], v[52:55], v[68:71], v[88:91]
    ds_read_b64_tr_b16 v[32:33], v5 offset:16384
    v_mfma_f32_16x16x32_bf16 v[92:95], v[52:55], v[72:75], v[92:95]
    ds_read_b64_tr_b16 v[34:35], v5 offset:17408
    v_mfma_f32_16x16x32_bf16 v[96:99], v[52:55], v[76:79], v[96:99]
    ds_read_b128 v[16:19], v10 offset:32768
    v_mfma_f32_16x16x32_bf16 v[100:103], v[52:55], v[80:83], v[100:103]
    ds_read_b64_tr_b16 v[36:37], v6 offset:16384
    v_mfma_f32_16x16x32_bf16 v[104:107], v[56:59], v[68:71], v[104:107]
    ds_read_b64_tr_b16 v[38:39], v6 offset:17408
    v_mfma_f32_16x16x32_bf16 v[108:111], v[56:59], v[72:75], v[108:111]
    ds_read_b128 v[20:23], v10 offset:34816
    v_mfma_f32_16x16x32_bf16 v[112:115], v[56:59], v[76:79], v[112:115]
    ds_read_b64_tr_b16 v[40:41], v7 offset:16384
    v_mfma_f32_16x16x32_bf16 v[116:119], v[56:59], v[80:83], v[116:119]
    ds_read_b64_tr_b16 v[42:43], v7 offset:17408
    v_mfma_f32_16x16x32_bf16 v[120:123], v[60:63], v[68:71], v[120:123]
    ds_read_b128 v[24:27], v10 offset:36864
    v_mfma_f32_16x16x32_bf16 v[124:127], v[60:63], v[72:75], v[124:127]
    ds_read_b64_tr_b16 v[44:45], v8 offset:16384
    v_mfma_f32_16x16x32_bf16 v[128:131], v[60:63], v[76:79], v[128:131]
    ds_read_b64_tr_b16 v[46:47], v8 offset:17408
    v_mfma_f32_16x16x32_bf16 v[132:135], v[60:63], v[80:83], v[132:135]
    ds_read_b128 v[28:31], v10 offset:38912
    v_mfma_f32_16x16x32_bf16 v[136:139], v[64:67], v[68:71], v[136:139]
    v_mfma_f32_16x16x32_bf16 v[140:143], v[64:67], v[72:75], v[140:143]
    v_mfma_f32_16x16x32_bf16 v[144:147], v[64:67], v[76:79], v[144:147]
    v_mfma_f32_16x16x32_bf16 v[148:151], v[64:67], v[80:83], v[148:151]
    s_waitcnt lgkmcnt(0)
    v_mfma_f32_16x16x32_bf16 v[88:91], v[16:19], v[32:35], v[88:91]
    ds_read_b64_tr_b16 v[68:69], v5 offset:24576
    v_mfma_f32_16x16x32_bf16 v[92:95], v[16:19], v[36:39], v[92:95]
    ds_read_b64_tr_b16 v[70:71], v5 offset:25600
    v_mfma_f32_16x16x32_bf16 v[96:99], v[16:19], v[40:43], v[96:99]
    ds_read_b128 v[52:55], v11 offset:32768
    v_mfma_f32_16x16x32_bf16 v[100:103], v[16:19], v[44:47], v[100:103]
    ds_read_b64_tr_b16 v[72:73], v6 offset:24576
    v_mfma_f32_16x16x32_bf16 v[104:107], v[20:23], v[32:35], v[104:107]
    ds_read_b64_tr_b16 v[74:75], v6 offset:25600
    v_mfma_f32_16x16x32_bf16 v[108:111], v[20:23], v[36:39], v[108:111]
    ds_read_b128 v[56:59], v11 offset:34816
    v_mfma_f32_16x16x32_bf16 v[112:115], v[20:23], v[40:43], v[112:115]
    ds_read_b64_tr_b16 v[76:77], v7 offset:24576
    v_mfma_f32_16x16x32_bf16 v[116:119], v[20:23], v[44:47], v[116:119]
    ds_read_b64_tr_b16 v[78:79], v7 offset:25600
    v_mfma_f32_16x16x32_bf16 v[120:123], v[24:27], v[32:35], v[120:123]
    ds_read_b128 v[60:63], v11 offset:36864
    v_mfma_f32_16x16x32_bf16 v[124:127], v[24:27], v[36:39], v[124:127]
    ds_read_b64_tr_b16 v[80:81], v8 offset:24576
    v_mfma_f32_16x16x32_bf16 v[128:131], v[24:27], v[40:43], v[128:131]
    ds_read_b64_tr_b16 v[82:83], v8 offset:25600
    v_mfma_f32_16x16x32_bf16 v[132:135], v[24:27], v[44:47], v[132:135]
    ds_read_b128 v[64:67], v11 offset:38912
    v_mfma_f32_16x16x32_bf16 v[136:139], v[28:31], v[32:35], v[136:139]
    v_mfma_f32_16x16x32_bf16 v[140:143], v[28:31], v[36:39], v[140:143]
    v_mfma_f32_16x16x32_bf16 v[144:147], v[28:31], v[40:43], v[144:147]
    v_mfma_f32_16x16x32_bf16 v[148:151], v[28:31], v[44:47], v[148:151]
    s_waitcnt lgkmcnt(0)
    s_barrier
    v_mfma_f32_16x16x32_bf16 v[88:91], v[52:55], v[68:71], v[88:91]
    ds_read_b64_tr_b16 v[32:33], v5 offset:32768
    v_mfma_f32_16x16x32_bf16 v[92:95], v[52:55], v[72:75], v[92:95]
    ds_read_b64_tr_b16 v[34:35], v5 offset:33792
    v_mfma_f32_16x16x32_bf16 v[96:99], v[52:55], v[76:79], v[96:99]
    ds_read_b128 v[16:19], v12 offset:0
    v_mfma_f32_16x16x32_bf16 v[100:103], v[52:55], v[80:83], v[100:103]
    ds_read_b64_tr_b16 v[36:37], v6 offset:32768
    v_mfma_f32_16x16x32_bf16 v[104:107], v[56:59], v[68:71], v[104:107]
    ds_read_b64_tr_b16 v[38:39], v6 offset:33792
    v_mfma_f32_16x16x32_bf16 v[108:111], v[56:59], v[72:75], v[108:111]
    ds_read_b128 v[20:23], v12 offset:2048
    v_mfma_f32_16x16x32_bf16 v[112:115], v[56:59], v[76:79], v[112:115]
    ds_read_b64_tr_b16 v[40:41], v7 offset:32768
    v_mfma_f32_16x16x32_bf16 v[116:119], v[56:59], v[80:83], v[116:119]
    ds_read_b64_tr_b16 v[42:43], v7 offset:33792
    v_mfma_f32_16x16x32_bf16 v[120:123], v[60:63], v[68:71], v[120:123]
    ds_read_b128 v[24:27], v12 offset:4096
    v_mfma_f32_16x16x32_bf16 v[124:127], v[60:63], v[72:75], v[124:127]
    ds_read_b64_tr_b16 v[44:45], v8 offset:32768
    v_mfma_f32_16x16x32_bf16 v[128:131], v[60:63], v[76:79], v[128:131]
    ds_read_b64_tr_b16 v[46:47], v8 offset:33792
    v_mfma_f32_16x16x32_bf16 v[132:135], v[60:63], v[80:83], v[132:135]
    ds_read_b128 v[28:31], v12 offset:6144
    v_mfma_f32_16x16x32_bf16 v[136:139], v[64:67], v[68:71], v[136:139]
    v_mfma_f32_16x16x32_bf16 v[140:143], v[64:67], v[72:75], v[140:143]
    v_mfma_f32_16x16x32_bf16 v[144:147], v[64:67], v[76:79], v[144:147]
    v_mfma_f32_16x16x32_bf16 v[148:151], v[64:67], v[80:83], v[148:151]
    s_waitcnt lgkmcnt(0)
    v_mfma_f32_16x16x32_bf16 v[88:91], v[16:19], v[32:35], v[88:91]
    ds_read_b64_tr_b16 v[68:69], v5 offset:40960
    v_mfma_f32_16x16x32_bf16 v[92:95], v[16:19], v[36:39], v[92:95]
    ds_read_b64_tr_b16 v[70:71], v5 offset:41984
    v_mfma_f32_16x16x32_bf16 v[96:99], v[16:19], v[40:43], v[96:99]
    ds_read_b128 v[52:55], v13 offset:0
    v_mfma_f32_16x16x32_bf16 v[100:103], v[16:19], v[44:47], v[100:103]
    ds_read_b64_tr_b16 v[72:73], v6 offset:40960
    v_mfma_f32_16x16x32_bf16 v[104:107], v[20:23], v[32:35], v[104:107]
    ds_read_b64_tr_b16 v[74:75], v6 offset:41984
    v_mfma_f32_16x16x32_bf16 v[108:111], v[20:23], v[36:39], v[108:111]
    ds_read_b128 v[56:59], v13 offset:2048
    v_mfma_f32_16x16x32_bf16 v[112:115], v[20:23], v[40:43], v[112:115]
    ds_read_b64_tr_b16 v[76:77], v7 offset:40960
    v_mfma_f32_16x16x32_bf16 v[116:119], v[20:23], v[44:47], v[116:119]
    ds_read_b64_tr_b16 v[78:79], v7 offset:41984
    v_mfma_f32_16x16x32_bf16 v[120:123], v[24:27], v[32:35], v[120:123]
    ds_read_b128 v[60:63], v13 offset:4096
    v_mfma_f32_16x16x32_bf16 v[124:127], v[24:27], v[36:39], v[124:127]
    ds_read_b64_tr_b16 v[80:81], v8 offset:40960
    v_mfma_f32_16x16x32_bf16 v[128:131], v[24:27], v[40:43], v[128:131]
    ds_read_b64_tr_b16 v[82:83], v8 offset:41984
    v_mfma_f32_16x16x32_bf16 v[132:135], v[24:27], v[44:47], v[132:135]
    ds_read_b128 v[64:67], v13 offset:6144
    v_mfma_f32_16x16x32_bf16 v[136:139], v[28:31], v[32:35], v[136:139]
    v_mfma_f32_16x16x32_bf16 v[140:143], v[28:31], v[36:39], v[140:143]
    v_mfma_f32_16x16x32_bf16 v[144:147], v[28:31], v[40:43], v[144:147]
    v_mfma_f32_16x16x32_bf16 v[148:151], v[28:31], v[44:47], v[148:151]
    s_waitcnt lgkmcnt(0)
    s_barrier
    v_mfma_f32_16x16x32_bf16 v[88:91], v[52:55], v[68:71], v[88:91]
    ds_read_b64_tr_b16 v[32:33], v5 offset:0
    v_mfma_f32_16x16x32_bf16 v[92:95], v[52:55], v[72:75], v[92:95]
    ds_read_b64_tr_b16 v[34:35], v5 offset:1024
    v_mfma_f32_16x16x32_bf16 v[96:99], v[52:55], v[76:79], v[96:99]
    ds_read_b128 v[16:19], v10 offset:0
    v_mfma_f32_16x16x32_bf16 v[100:103], v[52:55], v[80:83], v[100:103]
    ds_read_b64_tr_b16 v[36:37], v6 offset:0
    v_mfma_f32_16x16x32_bf16 v[104:107], v[56:59], v[68:71], v[104:107]
    ds_read_b64_tr_b16 v[38:39], v6 offset:1024
    v_mfma_f32_16x16x32_bf16 v[108:111], v[56:59], v[72:75], v[108:111]
    ds_read_b128 v[20:23], v10 offset:2048
    v_mfma_f32_16x16x32_bf16 v[112:115], v[56:59], v[76:79], v[112:115]
    ds_read_b64_tr_b16 v[40:41], v7 offset:0
    v_mfma_f32_16x16x32_bf16 v[116:119], v[56:59], v[80:83], v[116:119]
    ds_read_b64_tr_b16 v[42:43], v7 offset:1024
    v_mfma_f32_16x16x32_bf16 v[120:123], v[60:63], v[68:71], v[120:123]
    ds_read_b128 v[24:27], v10 offset:4096
    v_mfma_f32_16x16x32_bf16 v[124:127], v[60:63], v[72:75], v[124:127]
    ds_read_b64_tr_b16 v[44:45], v8 offset:0
    v_mfma_f32_16x16x32_bf16 v[128:131], v[60:63], v[76:79], v[128:131]
    ds_read_b64_tr_b16 v[46:47], v8 offset:1024
    v_mfma_f32_16x16x32_bf16 v[132:135], v[60:63], v[80:83], v[132:135]
    ds_read_b128 v[28:31], v10 offset:6144
    v_mfma_f32_16x16x32_bf16 v[136:139], v[64:67], v[68:71], v[136:139]
    v_mfma_f32_16x16x32_bf16 v[140:143], v[64:67], v[72:75], v[140:143]
    v_mfma_f32_16x16x32_bf16 v[144:147], v[64:67], v[76:79], v[144:147]
    v_mfma_f32_16x16x32_bf16 v[148:151], v[64:67], v[80:83], v[148:151]
    s_waitcnt lgkmcnt(0)
    v_mfma_f32_16x16x32_bf16 v[88:91], v[16:19], v[32:35], v[88:91]
    ds_read_b64_tr_b16 v[68:69], v5 offset:8192
    v_mfma_f32_16x16x32_bf16 v[92:95], v[16:19], v[36:39], v[92:95]
    ds_read_b64_tr_b16 v[70:71], v5 offset:9216
    v_mfma_f32_16x16x32_bf16 v[96:99], v[16:19], v[40:43], v[96:99]
    ds_read_b128 v[52:55], v11 offset:0
    v_mfma_f32_16x16x32_bf16 v[100:103], v[16:19], v[44:47], v[100:103]
    ds_read_b64_tr_b16 v[72:73], v6 offset:8192
    v_mfma_f32_16x16x32_bf16 v[104:107], v[20:23], v[32:35], v[104:107]
    ds_read_b64_tr_b16 v[74:75], v6 offset:9216
    v_mfma_f32_16x16x32_bf16 v[108:111], v[20:23], v[36:39], v[108:111]
    ds_read_b128 v[56:59], v11 offset:2048
    v_mfma_f32_16x16x32_bf16 v[112:115], v[20:23], v[40:43], v[112:115]
    ds_read_b64_tr_b16 v[76:77], v7 offset:8192
    v_mfma_f32_16x16x32_bf16 v[116:119], v[20:23], v[44:47], v[116:119]
    ds_read_b64_tr_b16 v[78:79], v7 offset:9216
    v_mfma_f32_16x16x32_bf16 v[120:123], v[24:27], v[32:35], v[120:123]
    ds_read_b128 v[60:63], v11 offset:4096
    v_mfma_f32_16x16x32_bf16 v[124:127], v[24:27], v[36:39], v[124:127]
    ds_read_b64_tr_b16 v[80:81], v8 offset:8192
    v_mfma_f32_16x16x32_bf16 v[128:131], v[24:27], v[40:43], v[128:131]
    ds_read_b64_tr_b16 v[82:83], v8 offset:9216
    v_mfma_f32_16x16x32_bf16 v[132:135], v[24:27], v[44:47], v[132:135]
    ds_read_b128 v[64:67], v11 offset:6144
    v_mfma_f32_16x16x32_bf16 v[136:139], v[28:31], v[32:35], v[136:139]
    v_mfma_f32_16x16x32_bf16 v[140:143], v[28:31], v[36:39], v[140:143]
    v_mfma_f32_16x16x32_bf16 v[144:147], v[28:31], v[40:43], v[144:147]
    v_mfma_f32_16x16x32_bf16 v[148:151], v[28:31], v[44:47], v[148:151]
    s_waitcnt lgkmcnt(0)
    s_barrier
    v_mfma_f32_16x16x32_bf16 v[88:91], v[52:55], v[68:71], v[88:91]
    ds_read_b64_tr_b16 v[32:33], v5 offset:16384
    v_mfma_f32_16x16x32_bf16 v[92:95], v[52:55], v[72:75], v[92:95]
    ds_read_b64_tr_b16 v[34:35], v5 offset:17408
    v_mfma_f32_16x16x32_bf16 v[96:99], v[52:55], v[76:79], v[96:99]
    ds_read_b128 v[16:19], v10 offset:32768
    v_mfma_f32_16x16x32_bf16 v[100:103], v[52:55], v[80:83], v[100:103]
    ds_read_b64_tr_b16 v[36:37], v6 offset:16384
    v_mfma_f32_16x16x32_bf16 v[104:107], v[56:59], v[68:71], v[104:107]
    ds_read_b64_tr_b16 v[38:39], v6 offset:17408
    v_mfma_f32_16x16x32_bf16 v[108:111], v[56:59], v[72:75], v[108:111]
    ds_read_b128 v[20:23], v10 offset:34816
    v_mfma_f32_16x16x32_bf16 v[112:115], v[56:59], v[76:79], v[112:115]
    ds_read_b64_tr_b16 v[40:41], v7 offset:16384
    v_mfma_f32_16x16x32_bf16 v[116:119], v[56:59], v[80:83], v[116:119]
    ds_read_b64_tr_b16 v[42:43], v7 offset:17408
    v_mfma_f32_16x16x32_bf16 v[120:123], v[60:63], v[68:71], v[120:123]
    ds_read_b128 v[24:27], v10 offset:36864
    v_mfma_f32_16x16x32_bf16 v[124:127], v[60:63], v[72:75], v[124:127]
    ds_read_b64_tr_b16 v[44:45], v8 offset:16384
    v_mfma_f32_16x16x32_bf16 v[128:131], v[60:63], v[76:79], v[128:131]
    ds_read_b64_tr_b16 v[46:47], v8 offset:17408
    v_mfma_f32_16x16x32_bf16 v[132:135], v[60:63], v[80:83], v[132:135]
    ds_read_b128 v[28:31], v10 offset:38912
    v_mfma_f32_16x16x32_bf16 v[136:139], v[64:67], v[68:71], v[136:139]
    v_mfma_f32_16x16x32_bf16 v[140:143], v[64:67], v[72:75], v[140:143]
    v_mfma_f32_16x16x32_bf16 v[144:147], v[64:67], v[76:79], v[144:147]
    v_mfma_f32_16x16x32_bf16 v[148:151], v[64:67], v[80:83], v[148:151]
    s_waitcnt lgkmcnt(0)
    v_mfma_f32_16x16x32_bf16 v[88:91], v[16:19], v[32:35], v[88:91]
    ds_read_b64_tr_b16 v[68:69], v5 offset:24576
    v_mfma_f32_16x16x32_bf16 v[92:95], v[16:19], v[36:39], v[92:95]
    ds_read_b64_tr_b16 v[70:71], v5 offset:25600
    v_mfma_f32_16x16x32_bf16 v[96:99], v[16:19], v[40:43], v[96:99]
    ds_read_b128 v[52:55], v11 offset:32768
    v_mfma_f32_16x16x32_bf16 v[100:103], v[16:19], v[44:47], v[100:103]
    ds_read_b64_tr_b16 v[72:73], v6 offset:24576
    v_mfma_f32_16x16x32_bf16 v[104:107], v[20:23], v[32:35], v[104:107]
    ds_read_b64_tr_b16 v[74:75], v6 offset:25600
    v_mfma_f32_16x16x32_bf16 v[108:111], v[20:23], v[36:39], v[108:111]
    ds_read_b128 v[56:59], v11 offset:34816
    v_mfma_f32_16x16x32_bf16 v[112:115], v[20:23], v[40:43], v[112:115]
    ds_read_b64_tr_b16 v[76:77], v7 offset:24576
    v_mfma_f32_16x16x32_bf16 v[116:119], v[20:23], v[44:47], v[116:119]
    ds_read_b64_tr_b16 v[78:79], v7 offset:25600
    v_mfma_f32_16x16x32_bf16 v[120:123], v[24:27], v[32:35], v[120:123]
    ds_read_b128 v[60:63], v11 offset:36864
    v_mfma_f32_16x16x32_bf16 v[124:127], v[24:27], v[36:39], v[124:127]
    ds_read_b64_tr_b16 v[80:81], v8 offset:24576
    v_mfma_f32_16x16x32_bf16 v[128:131], v[24:27], v[40:43], v[128:131]
    ds_read_b64_tr_b16 v[82:83], v8 offset:25600
    v_mfma_f32_16x16x32_bf16 v[132:135], v[24:27], v[44:47], v[132:135]
    ds_read_b128 v[64:67], v11 offset:38912
    v_mfma_f32_16x16x32_bf16 v[136:139], v[28:31], v[32:35], v[136:139]
    v_mfma_f32_16x16x32_bf16 v[140:143], v[28:31], v[36:39], v[140:143]
    v_mfma_f32_16x16x32_bf16 v[144:147], v[28:31], v[40:43], v[144:147]
    v_mfma_f32_16x16x32_bf16 v[148:151], v[28:31], v[44:47], v[148:151]
    s_waitcnt lgkmcnt(0)
    s_barrier
    v_mfma_f32_16x16x32_bf16 v[88:91], v[52:55], v[68:71], v[88:91]
    ds_read_b64_tr_b16 v[32:33], v5 offset:32768
    v_mfma_f32_16x16x32_bf16 v[92:95], v[52:55], v[72:75], v[92:95]
    ds_read_b64_tr_b16 v[34:35], v5 offset:33792
    v_mfma_f32_16x16x32_bf16 v[96:99], v[52:55], v[76:79], v[96:99]
    ds_read_b128 v[16:19], v12 offset:0
    v_mfma_f32_16x16x32_bf16 v[100:103], v[52:55], v[80:83], v[100:103]
    ds_read_b64_tr_b16 v[36:37], v6 offset:32768
    v_mfma_f32_16x16x32_bf16 v[104:107], v[56:59], v[68:71], v[104:107]
    ds_read_b64_tr_b16 v[38:39], v6 offset:33792
    v_mfma_f32_16x16x32_bf16 v[108:111], v[56:59], v[72:75], v[108:111]
    ds_read_b128 v[20:23], v12 offset:2048
    v_mfma_f32_16x16x32_bf16 v[112:115], v[56:59], v[76:79], v[112:115]
    ds_read_b64_tr_b16 v[40:41], v7 offset:32768
    v_mfma_f32_16x16x32_bf16 v[116:119], v[56:59], v[80:83], v[116:119]
    ds_read_b64_tr_b16 v[42:43], v7 offset:33792
    v_mfma_f32_16x16x32_bf16 v[120:123], v[60:63], v[68:71], v[120:123]
    ds_read_b128 v[24:27], v12 offset:4096
    v_mfma_f32_16x16x32_bf16 v[124:127], v[60:63], v[72:75], v[124:127]
    ds_read_b64_tr_b16 v[44:45], v8 offset:32768
    v_mfma_f32_16x16x32_bf16 v[128:131], v[60:63], v[76:79], v[128:131]
    ds_read_b64_tr_b16 v[46:47], v8 offset:33792
    v_mfma_f32_16x16x32_bf16 v[132:135], v[60:63], v[80:83], v[132:135]
    ds_read_b128 v[28:31], v12 offset:6144
    v_mfma_f32_16x16x32_bf16 v[136:139], v[64:67], v[68:71], v[136:139]
    v_mfma_f32_16x16x32_bf16 v[140:143], v[64:67], v[72:75], v[140:143]
    v_mfma_f32_16x16x32_bf16 v[144:147], v[64:67], v[76:79], v[144:147]
    v_mfma_f32_16x16x32_bf16 v[148:151], v[64:67], v[80:83], v[148:151]
    s_waitcnt lgkmcnt(0)
    v_mfma_f32_16x16x32_bf16 v[88:91], v[16:19], v[32:35], v[88:91]
    ds_read_b64_tr_b16 v[68:69], v5 offset:40960
    v_mfma_f32_16x16x32_bf16 v[92:95], v[16:19], v[36:39], v[92:95]
    ds_read_b64_tr_b16 v[70:71], v5 offset:41984
    v_mfma_f32_16x16x32_bf16 v[96:99], v[16:19], v[40:43], v[96:99]
    ds_read_b128 v[52:55], v13 offset:0
    v_mfma_f32_16x16x32_bf16 v[100:103], v[16:19], v[44:47], v[100:103]
    ds_read_b64_tr_b16 v[72:73], v6 offset:40960
    v_mfma_f32_16x16x32_bf16 v[104:107], v[20:23], v[32:35], v[104:107]
    ds_read_b64_tr_b16 v[74:75], v6 offset:41984
    v_mfma_f32_16x16x32_bf16 v[108:111], v[20:23], v[36:39], v[108:111]
    ds_read_b128 v[56:59], v13 offset:2048
    v_mfma_f32_16x16x32_bf16 v[112:115], v[20:23], v[40:43], v[112:115]
    ds_read_b64_tr_b16 v[76:77], v7 offset:40960
    v_mfma_f32_16x16x32_bf16 v[116:119], v[20:23], v[44:47], v[116:119]
    ds_read_b64_tr_b16 v[78:79], v7 offset:41984
    v_mfma_f32_16x16x32_bf16 v[120:123], v[24:27], v[32:35], v[120:123]
    ds_read_b128 v[60:63], v13 offset:4096
    v_mfma_f32_16x16x32_bf16 v[124:127], v[24:27], v[36:39], v[124:127]
    ds_read_b64_tr_b16 v[80:81], v8 offset:40960
    v_mfma_f32_16x16x32_bf16 v[128:131], v[24:27], v[40:43], v[128:131]
    ds_read_b64_tr_b16 v[82:83], v8 offset:41984
    v_mfma_f32_16x16x32_bf16 v[132:135], v[24:27], v[44:47], v[132:135]
    ds_read_b128 v[64:67], v13 offset:6144
    v_mfma_f32_16x16x32_bf16 v[136:139], v[28:31], v[32:35], v[136:139]
    v_mfma_f32_16x16x32_bf16 v[140:143], v[28:31], v[36:39], v[140:143]
    v_mfma_f32_16x16x32_bf16 v[144:147], v[28:31], v[40:43], v[144:147]
    v_mfma_f32_16x16x32_bf16 v[148:151], v[28:31], v[44:47], v[148:151]
    s_waitcnt lgkmcnt(0)
    s_barrier
    v_mfma_f32_16x16x32_bf16 v[88:91], v[52:55], v[68:71], v[88:91]
    ds_read_b64_tr_b16 v[32:33], v5 offset:0
    v_mfma_f32_16x16x32_bf16 v[92:95], v[52:55], v[72:75], v[92:95]
    ds_read_b64_tr_b16 v[34:35], v5 offset:1024
    v_mfma_f32_16x16x32_bf16 v[96:99], v[52:55], v[76:79], v[96:99]
    ds_read_b128 v[16:19], v10 offset:0
    v_mfma_f32_16x16x32_bf16 v[100:103], v[52:55], v[80:83], v[100:103]
    ds_read_b64_tr_b16 v[36:37], v6 offset:0
    v_mfma_f32_16x16x32_bf16 v[104:107], v[56:59], v[68:71], v[104:107]
    ds_read_b64_tr_b16 v[38:39], v6 offset:1024
    v_mfma_f32_16x16x32_bf16 v[108:111], v[56:59], v[72:75], v[108:111]
    ds_read_b128 v[20:23], v10 offset:2048
    v_mfma_f32_16x16x32_bf16 v[112:115], v[56:59], v[76:79], v[112:115]
    ds_read_b64_tr_b16 v[40:41], v7 offset:0
    v_mfma_f32_16x16x32_bf16 v[116:119], v[56:59], v[80:83], v[116:119]
    ds_read_b64_tr_b16 v[42:43], v7 offset:1024
    v_mfma_f32_16x16x32_bf16 v[120:123], v[60:63], v[68:71], v[120:123]
    ds_read_b128 v[24:27], v10 offset:4096
    v_mfma_f32_16x16x32_bf16 v[124:127], v[60:63], v[72:75], v[124:127]
    ds_read_b64_tr_b16 v[44:45], v8 offset:0
    v_mfma_f32_16x16x32_bf16 v[128:131], v[60:63], v[76:79], v[128:131]
    ds_read_b64_tr_b16 v[46:47], v8 offset:1024
    v_mfma_f32_16x16x32_bf16 v[132:135], v[60:63], v[80:83], v[132:135]
    ds_read_b128 v[28:31], v10 offset:6144
    v_mfma_f32_16x16x32_bf16 v[136:139], v[64:67], v[68:71], v[136:139]
    v_mfma_f32_16x16x32_bf16 v[140:143], v[64:67], v[72:75], v[140:143]
    v_mfma_f32_16x16x32_bf16 v[144:147], v[64:67], v[76:79], v[144:147]
    v_mfma_f32_16x16x32_bf16 v[148:151], v[64:67], v[80:83], v[148:151]
    s_waitcnt lgkmcnt(0)
    v_mfma_f32_16x16x32_bf16 v[88:91], v[16:19], v[32:35], v[88:91]
    ds_read_b64_tr_b16 v[68:69], v5 offset:8192
    v_mfma_f32_16x16x32_bf16 v[92:95], v[16:19], v[36:39], v[92:95]
    ds_read_b64_tr_b16 v[70:71], v5 offset:9216
    v_mfma_f32_16x16x32_bf16 v[96:99], v[16:19], v[40:43], v[96:99]
    ds_read_b128 v[52:55], v11 offset:0
    v_mfma_f32_16x16x32_bf16 v[100:103], v[16:19], v[44:47], v[100:103]
    ds_read_b64_tr_b16 v[72:73], v6 offset:8192
    v_mfma_f32_16x16x32_bf16 v[104:107], v[20:23], v[32:35], v[104:107]
    ds_read_b64_tr_b16 v[74:75], v6 offset:9216
    v_mfma_f32_16x16x32_bf16 v[108:111], v[20:23], v[36:39], v[108:111]
    ds_read_b128 v[56:59], v11 offset:2048
    v_mfma_f32_16x16x32_bf16 v[112:115], v[20:23], v[40:43], v[112:115]
    ds_read_b64_tr_b16 v[76:77], v7 offset:8192
    v_mfma_f32_16x16x32_bf16 v[116:119], v[20:23], v[44:47], v[116:119]
    ds_read_b64_tr_b16 v[78:79], v7 offset:9216
    v_mfma_f32_16x16x32_bf16 v[120:123], v[24:27], v[32:35], v[120:123]
    ds_read_b128 v[60:63], v11 offset:4096
    v_mfma_f32_16x16x32_bf16 v[124:127], v[24:27], v[36:39], v[124:127]
    ds_read_b64_tr_b16 v[80:81], v8 offset:8192
    v_mfma_f32_16x16x32_bf16 v[128:131], v[24:27], v[40:43], v[128:131]
    ds_read_b64_tr_b16 v[82:83], v8 offset:9216
    v_mfma_f32_16x16x32_bf16 v[132:135], v[24:27], v[44:47], v[132:135]
    ds_read_b128 v[64:67], v11 offset:6144
    v_mfma_f32_16x16x32_bf16 v[136:139], v[28:31], v[32:35], v[136:139]
    v_mfma_f32_16x16x32_bf16 v[140:143], v[28:31], v[36:39], v[140:143]
    v_mfma_f32_16x16x32_bf16 v[144:147], v[28:31], v[40:43], v[144:147]
    v_mfma_f32_16x16x32_bf16 v[148:151], v[28:31], v[44:47], v[148:151]
    s_waitcnt lgkmcnt(0)
    s_barrier
    v_mfma_f32_16x16x32_bf16 v[88:91], v[52:55], v[68:71], v[88:91]
    ds_read_b64_tr_b16 v[32:33], v5 offset:16384
    v_mfma_f32_16x16x32_bf16 v[92:95], v[52:55], v[72:75], v[92:95]
    ds_read_b64_tr_b16 v[34:35], v5 offset:17408
    v_mfma_f32_16x16x32_bf16 v[96:99], v[52:55], v[76:79], v[96:99]
    ds_read_b128 v[16:19], v10 offset:32768
    v_mfma_f32_16x16x32_bf16 v[100:103], v[52:55], v[80:83], v[100:103]
    ds_read_b64_tr_b16 v[36:37], v6 offset:16384
    v_mfma_f32_16x16x32_bf16 v[104:107], v[56:59], v[68:71], v[104:107]
    ds_read_b64_tr_b16 v[38:39], v6 offset:17408
    v_mfma_f32_16x16x32_bf16 v[108:111], v[56:59], v[72:75], v[108:111]
    ds_read_b128 v[20:23], v10 offset:34816
    v_mfma_f32_16x16x32_bf16 v[112:115], v[56:59], v[76:79], v[112:115]
    ds_read_b64_tr_b16 v[40:41], v7 offset:16384
    v_mfma_f32_16x16x32_bf16 v[116:119], v[56:59], v[80:83], v[116:119]
    ds_read_b64_tr_b16 v[42:43], v7 offset:17408
    v_mfma_f32_16x16x32_bf16 v[120:123], v[60:63], v[68:71], v[120:123]
    ds_read_b128 v[24:27], v10 offset:36864
    v_mfma_f32_16x16x32_bf16 v[124:127], v[60:63], v[72:75], v[124:127]
    ds_read_b64_tr_b16 v[44:45], v8 offset:16384
    v_mfma_f32_16x16x32_bf16 v[128:131], v[60:63], v[76:79], v[128:131]
    ds_read_b64_tr_b16 v[46:47], v8 offset:17408
    v_mfma_f32_16x16x32_bf16 v[132:135], v[60:63], v[80:83], v[132:135]
    ds_read_b128 v[28:31], v10 offset:38912
    v_mfma_f32_16x16x32_bf16 v[136:139], v[64:67], v[68:71], v[136:139]
    v_mfma_f32_16x16x32_bf16 v[140:143], v[64:67], v[72:75], v[140:143]
    v_mfma_f32_16x16x32_bf16 v[144:147], v[64:67], v[76:79], v[144:147]
    v_mfma_f32_16x16x32_bf16 v[148:151], v[64:67], v[80:83], v[148:151]
    s_waitcnt lgkmcnt(0)
    v_mfma_f32_16x16x32_bf16 v[88:91], v[16:19], v[32:35], v[88:91]
    ds_read_b64_tr_b16 v[68:69], v5 offset:24576
    v_mfma_f32_16x16x32_bf16 v[92:95], v[16:19], v[36:39], v[92:95]
    ds_read_b64_tr_b16 v[70:71], v5 offset:25600
    v_mfma_f32_16x16x32_bf16 v[96:99], v[16:19], v[40:43], v[96:99]
    ds_read_b128 v[52:55], v11 offset:32768
    v_mfma_f32_16x16x32_bf16 v[100:103], v[16:19], v[44:47], v[100:103]
    ds_read_b64_tr_b16 v[72:73], v6 offset:24576
    v_mfma_f32_16x16x32_bf16 v[104:107], v[20:23], v[32:35], v[104:107]
    ds_read_b64_tr_b16 v[74:75], v6 offset:25600
    v_mfma_f32_16x16x32_bf16 v[108:111], v[20:23], v[36:39], v[108:111]
    ds_read_b128 v[56:59], v11 offset:34816
    v_mfma_f32_16x16x32_bf16 v[112:115], v[20:23], v[40:43], v[112:115]
    ds_read_b64_tr_b16 v[76:77], v7 offset:24576
    v_mfma_f32_16x16x32_bf16 v[116:119], v[20:23], v[44:47], v[116:119]
    ds_read_b64_tr_b16 v[78:79], v7 offset:25600
    v_mfma_f32_16x16x32_bf16 v[120:123], v[24:27], v[32:35], v[120:123]
    ds_read_b128 v[60:63], v11 offset:36864
    v_mfma_f32_16x16x32_bf16 v[124:127], v[24:27], v[36:39], v[124:127]
    ds_read_b64_tr_b16 v[80:81], v8 offset:24576
    v_mfma_f32_16x16x32_bf16 v[128:131], v[24:27], v[40:43], v[128:131]
    ds_read_b64_tr_b16 v[82:83], v8 offset:25600
    v_mfma_f32_16x16x32_bf16 v[132:135], v[24:27], v[44:47], v[132:135]
    ds_read_b128 v[64:67], v11 offset:38912
    v_mfma_f32_16x16x32_bf16 v[136:139], v[28:31], v[32:35], v[136:139]
    v_mfma_f32_16x16x32_bf16 v[140:143], v[28:31], v[36:39], v[140:143]
    v_mfma_f32_16x16x32_bf16 v[144:147], v[28:31], v[40:43], v[144:147]
    v_mfma_f32_16x16x32_bf16 v[148:151], v[28:31], v[44:47], v[148:151]
    s_waitcnt lgkmcnt(0)
    s_barrier
    v_mfma_f32_16x16x32_bf16 v[88:91], v[52:55], v[68:71], v[88:91]
    ds_read_b64_tr_b16 v[32:33], v5 offset:32768
    v_mfma_f32_16x16x32_bf16 v[92:95], v[52:55], v[72:75], v[92:95]
    ds_read_b64_tr_b16 v[34:35], v5 offset:33792
    v_mfma_f32_16x16x32_bf16 v[96:99], v[52:55], v[76:79], v[96:99]
    ds_read_b128 v[16:19], v12 offset:0
    v_mfma_f32_16x16x32_bf16 v[100:103], v[52:55], v[80:83], v[100:103]
    ds_read_b64_tr_b16 v[36:37], v6 offset:32768
    v_mfma_f32_16x16x32_bf16 v[104:107], v[56:59], v[68:71], v[104:107]
    ds_read_b64_tr_b16 v[38:39], v6 offset:33792
    v_mfma_f32_16x16x32_bf16 v[108:111], v[56:59], v[72:75], v[108:111]
    ds_read_b128 v[20:23], v12 offset:2048
    v_mfma_f32_16x16x32_bf16 v[112:115], v[56:59], v[76:79], v[112:115]
    ds_read_b64_tr_b16 v[40:41], v7 offset:32768
    v_mfma_f32_16x16x32_bf16 v[116:119], v[56:59], v[80:83], v[116:119]
    ds_read_b64_tr_b16 v[42:43], v7 offset:33792
    v_mfma_f32_16x16x32_bf16 v[120:123], v[60:63], v[68:71], v[120:123]
    ds_read_b128 v[24:27], v12 offset:4096
    v_mfma_f32_16x16x32_bf16 v[124:127], v[60:63], v[72:75], v[124:127]
    ds_read_b64_tr_b16 v[44:45], v8 offset:32768
    v_mfma_f32_16x16x32_bf16 v[128:131], v[60:63], v[76:79], v[128:131]
    ds_read_b64_tr_b16 v[46:47], v8 offset:33792
    v_mfma_f32_16x16x32_bf16 v[132:135], v[60:63], v[80:83], v[132:135]
    ds_read_b128 v[28:31], v12 offset:6144
    v_mfma_f32_16x16x32_bf16 v[136:139], v[64:67], v[68:71], v[136:139]
    v_mfma_f32_16x16x32_bf16 v[140:143], v[64:67], v[72:75], v[140:143]
    v_mfma_f32_16x16x32_bf16 v[144:147], v[64:67], v[76:79], v[144:147]
    v_mfma_f32_16x16x32_bf16 v[148:151], v[64:67], v[80:83], v[148:151]
    s_waitcnt lgkmcnt(0)
    v_mfma_f32_16x16x32_bf16 v[88:91], v[16:19], v[32:35], v[88:91]
    ds_read_b64_tr_b16 v[68:69], v5 offset:40960
    v_mfma_f32_16x16x32_bf16 v[92:95], v[16:19], v[36:39], v[92:95]
    ds_read_b64_tr_b16 v[70:71], v5 offset:41984
    v_mfma_f32_16x16x32_bf16 v[96:99], v[16:19], v[40:43], v[96:99]
    ds_read_b128 v[52:55], v13 offset:0
    v_mfma_f32_16x16x32_bf16 v[100:103], v[16:19], v[44:47], v[100:103]
    ds_read_b64_tr_b16 v[72:73], v6 offset:40960
    v_mfma_f32_16x16x32_bf16 v[104:107], v[20:23], v[32:35], v[104:107]
    ds_read_b64_tr_b16 v[74:75], v6 offset:41984
    v_mfma_f32_16x16x32_bf16 v[108:111], v[20:23], v[36:39], v[108:111]
    ds_read_b128 v[56:59], v13 offset:2048
    v_mfma_f32_16x16x32_bf16 v[112:115], v[20:23], v[40:43], v[112:115]
    ds_read_b64_tr_b16 v[76:77], v7 offset:40960
    v_mfma_f32_16x16x32_bf16 v[116:119], v[20:23], v[44:47], v[116:119]
    ds_read_b64_tr_b16 v[78:79], v7 offset:41984
    v_mfma_f32_16x16x32_bf16 v[120:123], v[24:27], v[32:35], v[120:123]
    ds_read_b128 v[60:63], v13 offset:4096
    v_mfma_f32_16x16x32_bf16 v[124:127], v[24:27], v[36:39], v[124:127]
    ds_read_b64_tr_b16 v[80:81], v8 offset:40960
    v_mfma_f32_16x16x32_bf16 v[128:131], v[24:27], v[40:43], v[128:131]
    ds_read_b64_tr_b16 v[82:83], v8 offset:41984
    v_mfma_f32_16x16x32_bf16 v[132:135], v[24:27], v[44:47], v[132:135]
    ds_read_b128 v[64:67], v13 offset:6144
    v_mfma_f32_16x16x32_bf16 v[136:139], v[28:31], v[32:35], v[136:139]
    v_mfma_f32_16x16x32_bf16 v[140:143], v[28:31], v[36:39], v[140:143]
    v_mfma_f32_16x16x32_bf16 v[144:147], v[28:31], v[40:43], v[144:147]
    v_mfma_f32_16x16x32_bf16 v[148:151], v[28:31], v[44:47], v[148:151]
    s_waitcnt lgkmcnt(0)
    s_barrier
    v_mfma_f32_16x16x32_bf16 v[88:91], v[52:55], v[68:71], v[88:91]
    ds_read_b64_tr_b16 v[32:33], v5 offset:0
    v_mfma_f32_16x16x32_bf16 v[92:95], v[52:55], v[72:75], v[92:95]
    ds_read_b64_tr_b16 v[34:35], v5 offset:1024
    v_mfma_f32_16x16x32_bf16 v[96:99], v[52:55], v[76:79], v[96:99]
    ds_read_b128 v[16:19], v10 offset:0
    v_mfma_f32_16x16x32_bf16 v[100:103], v[52:55], v[80:83], v[100:103]
    ds_read_b64_tr_b16 v[36:37], v6 offset:0
    v_mfma_f32_16x16x32_bf16 v[104:107], v[56:59], v[68:71], v[104:107]
    ds_read_b64_tr_b16 v[38:39], v6 offset:1024
    v_mfma_f32_16x16x32_bf16 v[108:111], v[56:59], v[72:75], v[108:111]
    ds_read_b128 v[20:23], v10 offset:2048
    v_mfma_f32_16x16x32_bf16 v[112:115], v[56:59], v[76:79], v[112:115]
    ds_read_b64_tr_b16 v[40:41], v7 offset:0
    v_mfma_f32_16x16x32_bf16 v[116:119], v[56:59], v[80:83], v[116:119]
    ds_read_b64_tr_b16 v[42:43], v7 offset:1024
    v_mfma_f32_16x16x32_bf16 v[120:123], v[60:63], v[68:71], v[120:123]
    ds_read_b128 v[24:27], v10 offset:4096
    v_mfma_f32_16x16x32_bf16 v[124:127], v[60:63], v[72:75], v[124:127]
    ds_read_b64_tr_b16 v[44:45], v8 offset:0
    v_mfma_f32_16x16x32_bf16 v[128:131], v[60:63], v[76:79], v[128:131]
    ds_read_b64_tr_b16 v[46:47], v8 offset:1024
    v_mfma_f32_16x16x32_bf16 v[132:135], v[60:63], v[80:83], v[132:135]
    ds_read_b128 v[28:31], v10 offset:6144
    v_mfma_f32_16x16x32_bf16 v[136:139], v[64:67], v[68:71], v[136:139]
    v_mfma_f32_16x16x32_bf16 v[140:143], v[64:67], v[72:75], v[140:143]
    v_mfma_f32_16x16x32_bf16 v[144:147], v[64:67], v[76:79], v[144:147]
    v_mfma_f32_16x16x32_bf16 v[148:151], v[64:67], v[80:83], v[148:151]
    s_waitcnt lgkmcnt(0)
    v_mfma_f32_16x16x32_bf16 v[88:91], v[16:19], v[32:35], v[88:91]
    ds_read_b64_tr_b16 v[68:69], v5 offset:8192
    v_mfma_f32_16x16x32_bf16 v[92:95], v[16:19], v[36:39], v[92:95]
    ds_read_b64_tr_b16 v[70:71], v5 offset:9216
    v_mfma_f32_16x16x32_bf16 v[96:99], v[16:19], v[40:43], v[96:99]
    ds_read_b128 v[52:55], v11 offset:0
    v_mfma_f32_16x16x32_bf16 v[100:103], v[16:19], v[44:47], v[100:103]
    ds_read_b64_tr_b16 v[72:73], v6 offset:8192
    v_mfma_f32_16x16x32_bf16 v[104:107], v[20:23], v[32:35], v[104:107]
    ds_read_b64_tr_b16 v[74:75], v6 offset:9216
    v_mfma_f32_16x16x32_bf16 v[108:111], v[20:23], v[36:39], v[108:111]
    ds_read_b128 v[56:59], v11 offset:2048
    v_mfma_f32_16x16x32_bf16 v[112:115], v[20:23], v[40:43], v[112:115]
    ds_read_b64_tr_b16 v[76:77], v7 offset:8192
    v_mfma_f32_16x16x32_bf16 v[116:119], v[20:23], v[44:47], v[116:119]
    ds_read_b64_tr_b16 v[78:79], v7 offset:9216
    v_mfma_f32_16x16x32_bf16 v[120:123], v[24:27], v[32:35], v[120:123]
    ds_read_b128 v[60:63], v11 offset:4096
    v_mfma_f32_16x16x32_bf16 v[124:127], v[24:27], v[36:39], v[124:127]
    ds_read_b64_tr_b16 v[80:81], v8 offset:8192
    v_mfma_f32_16x16x32_bf16 v[128:131], v[24:27], v[40:43], v[128:131]
    ds_read_b64_tr_b16 v[82:83], v8 offset:9216
    v_mfma_f32_16x16x32_bf16 v[132:135], v[24:27], v[44:47], v[132:135]
    ds_read_b128 v[64:67], v11 offset:6144
    v_mfma_f32_16x16x32_bf16 v[136:139], v[28:31], v[32:35], v[136:139]
    v_mfma_f32_16x16x32_bf16 v[140:143], v[28:31], v[36:39], v[140:143]
    v_mfma_f32_16x16x32_bf16 v[144:147], v[28:31], v[40:43], v[144:147]
    v_mfma_f32_16x16x32_bf16 v[148:151], v[28:31], v[44:47], v[148:151]
    s_waitcnt lgkmcnt(0)
    v_mfma_f32_16x16x32_bf16 v[88:91], v[52:55], v[68:71], v[88:91]
    v_mfma_f32_16x16x32_bf16 v[92:95], v[52:55], v[72:75], v[92:95]
    v_mfma_f32_16x16x32_bf16 v[96:99], v[52:55], v[76:79], v[96:99]
    v_mfma_f32_16x16x32_bf16 v[100:103], v[52:55], v[80:83], v[100:103]
    v_mfma_f32_16x16x32_bf16 v[104:107], v[56:59], v[68:71], v[104:107]
    v_mfma_f32_16x16x32_bf16 v[108:111], v[56:59], v[72:75], v[108:111]
    v_mfma_f32_16x16x32_bf16 v[112:115], v[56:59], v[76:79], v[112:115]
    v_mfma_f32_16x16x32_bf16 v[116:119], v[56:59], v[80:83], v[116:119]
    v_mfma_f32_16x16x32_bf16 v[120:123], v[60:63], v[68:71], v[120:123]
    v_mfma_f32_16x16x32_bf16 v[124:127], v[60:63], v[72:75], v[124:127]
    v_mfma_f32_16x16x32_bf16 v[128:131], v[60:63], v[76:79], v[128:131]
    v_mfma_f32_16x16x32_bf16 v[132:135], v[60:63], v[80:83], v[132:135]
    v_mfma_f32_16x16x32_bf16 v[136:139], v[64:67], v[68:71], v[136:139]
    v_mfma_f32_16x16x32_bf16 v[140:143], v[64:67], v[72:75], v[140:143]
    v_mfma_f32_16x16x32_bf16 v[144:147], v[64:67], v[76:79], v[144:147]
    v_mfma_f32_16x16x32_bf16 v[148:151], v[64:67], v[80:83], v[148:151]
    s_waitcnt vmcnt(0)
    v_cvt_pk_bf16_f32 v32, v88, v89
    v_cvt_pk_bf16_f32 v33, v90, v91
    v_cvt_pk_bf16_f32 v34, v104, v105
    v_cvt_pk_bf16_f32 v35, v106, v107
    buffer_store_dwordx4 v[32:35], v152, s[16:19], 0 offen offset:0 sc1
    v_cvt_pk_bf16_f32 v36, v92, v93
    v_cvt_pk_bf16_f32 v37, v94, v95
    v_cvt_pk_bf16_f32 v38, v108, v109
    v_cvt_pk_bf16_f32 v39, v110, v111
    buffer_store_dwordx4 v[36:39], v153, s[16:19], 0 offen offset:0 sc1
    v_cvt_pk_bf16_f32 v40, v96, v97
    v_cvt_pk_bf16_f32 v41, v98, v99
    v_cvt_pk_bf16_f32 v42, v112, v113
    v_cvt_pk_bf16_f32 v43, v114, v115
    buffer_store_dwordx4 v[40:43], v154, s[16:19], 0 offen offset:0 sc1
    v_cvt_pk_bf16_f32 v44, v100, v101
    v_cvt_pk_bf16_f32 v45, v102, v103
    v_cvt_pk_bf16_f32 v46, v116, v117
    v_cvt_pk_bf16_f32 v47, v118, v119
    buffer_store_dwordx4 v[44:47], v155, s[16:19], 0 offen offset:0 sc1
    v_cvt_pk_bf16_f32 v48, v120, v121
    v_cvt_pk_bf16_f32 v49, v122, v123
    v_cvt_pk_bf16_f32 v50, v136, v137
    v_cvt_pk_bf16_f32 v51, v138, v139
    buffer_store_dwordx4 v[48:51], v152, s[16:19], 0 offen offset:1280 sc1
    v_cvt_pk_bf16_f32 v52, v124, v125
    v_cvt_pk_bf16_f32 v53, v126, v127
    v_cvt_pk_bf16_f32 v54, v140, v141
    v_cvt_pk_bf16_f32 v55, v142, v143
    buffer_store_dwordx4 v[52:55], v153, s[16:19], 0 offen offset:1280 sc1
    v_cvt_pk_bf16_f32 v56, v128, v129
    v_cvt_pk_bf16_f32 v57, v130, v131
    v_cvt_pk_bf16_f32 v58, v144, v145
    v_cvt_pk_bf16_f32 v59, v146, v147
    buffer_store_dwordx4 v[56:59], v154, s[16:19], 0 offen offset:1280 sc1
    v_cvt_pk_bf16_f32 v60, v132, v133
    v_cvt_pk_bf16_f32 v61, v134, v135
    v_cvt_pk_bf16_f32 v62, v148, v149
    v_cvt_pk_bf16_f32 v63, v150, v151
    buffer_store_dwordx4 v[60:63], v155, s[16:19], 0 offen offset:1280 sc1
    s_branch k1_done_35
k1_kv_11:
    s_cmp_lg_u32 s22, 0
    s_cbranch_scc1 k1_nt_46
    buffer_load_dword v4, v2, s[8:11], 0 offen offset:0
    s_mov_b32 s35, 0
    buffer_load_dword v4, v3, s[12:15], s35 offen
k1_nt_46:
    s_cmp_lg_u32 s22, 1
    s_cbranch_scc1 k1_nt_47
    buffer_load_dword v4, v2, s[8:11], 0 offen offset:128
    s_mov_b32 s35, 245760
    buffer_load_dword v4, v3, s[12:15], s35 offen
k1_nt_47:
    s_cmp_lg_u32 s22, 2
    s_cbranch_scc1 k1_nt_48
    buffer_load_dword v4, v2, s[8:11], 0 offen offset:256
    s_mov_b32 s35, 491520
    buffer_load_dword v4, v3, s[12:15], s35 offen
k1_nt_48:
    s_cmp_lg_u32 s22, 3
    s_cbranch_scc1 k1_nt_49
    buffer_load_dword v4, v2, s[8:11], 0 offen offset:384
    s_mov_b32 s35, 737280
    buffer_load_dword v4, v3, s[12:15], s35 offen
k1_nt_49:
    s_lshr_b32 s36, s22, 1
    s_and_b32 s37, s22, 1
    v_lshrrev_b32 v13, 4, v1
    v_bfe_u32 v14, v1, 2, 2
    v_lshl_add_u32 v15, v13, 3, v14
    v_mul_u32_u24 v15, 320, v15
    v_and_b32 v16, 3, v1
    v_lshl_add_u32 v15, v16, 3, v15
    v_and_b32 v16, 1, v13
    s_mul_i32 s40, s37, 5
    s_add_u32 s39, s40, 0
    v_xor_b32 v17, s39, v16
    v_lshl_add_u32 v5, v17, 5, v15
    s_add_u32 s39, s40, 1
    v_xor_b32 v17, s39, v16
    v_lshl_add_u32 v6, v17, 5, v15
    s_add_u32 s39, s40, 2
    v_xor_b32 v17, s39, v16
    v_lshl_add_u32 v7, v17, 5, v15
    s_add_u32 s39, s40, 3
    v_xor_b32 v17, s39, v16
    v_lshl_add_u32 v8, v17, 5, v15
    s_add_u32 s39, s40, 4
    v_xor_b32 v17, s39, v16
    v_lshl_add_u32 v9, v17, 5, v15
    s_lshl_b32 s63, s36, 6
    s_cmp_eq_u32 s36, 3
    s_cselect_b32 s63, 176, s63
    v_lshrrev_b32 v13, 4, v1
    v_and_b32 v14, 15, v1
    v_lshrrev_b32 v15, 1, v14
    v_xor_b32 v15, v15, v13
    s_lshl_b32 s39, s63, 7
    s_add_u32 s39, s39, 61440
    v_lshlrev_b32 v16, 7, v14
    v_add_u32 v16, s39, v16
    v_lshl_add_u32 v10, v15, 4, v16
    v_xor_b32 v11, 64, v10
    v_add_u32 v12, 0x10000, v10
    v_add_u32 v13, 0x10000, v11
    s_barrier
    ds_read_b64_tr_b16 v[32:33], v5 offset:0
    ds_read_b64_tr_b16 v[34:35], v5 offset:1280
    ds_read_b128 v[16:19], v10 offset:0
    ds_read_b64_tr_b16 v[36:37], v6 offset:0
    ds_read_b64_tr_b16 v[38:39], v6 offset:1280
    ds_read_b128 v[20:23], v10 offset:2048
    ds_read_b64_tr_b16 v[40:41], v7 offset:0
    ds_read_b64_tr_b16 v[42:43], v7 offset:1280
    ds_read_b128 v[24:27], v10 offset:4096
    ds_read_b64_tr_b16 v[44:45], v8 offset:0
    ds_read_b64_tr_b16 v[46:47], v8 offset:1280
    ds_read_b128 v[28:31], v10 offset:6144
    ds_read_b64_tr_b16 v[48:49], v9 offset:0
    ds_read_b64_tr_b16 v[50:51], v9 offset:1280
    s_waitcnt lgkmcnt(0)
    v_mfma_f32_16x16x32_bf16 v[88:91], v[16:19], v[32:35], 0
    ds_read_b64_tr_b16 v[68:69], v5 offset:10240
    v_mfma_f32_16x16x32_bf16 v[92:95], v[16:19], v[36:39], 0
    ds_read_b64_tr_b16 v[70:71], v5 offset:11520
    v_mfma_f32_16x16x32_bf16 v[96:99], v[16:19], v[40:43], 0
    ds_read_b128 v[52:55], v11 offset:0
    v_mfma_f32_16x16x32_bf16 v[100:103], v[16:19], v[44:47], 0
    ds_read_b64_tr_b16 v[72:73], v6 offset:10240
    v_mfma_f32_16x16x32_bf16 v[104:107], v[16:19], v[48:51], 0
    ds_read_b64_tr_b16 v[74:75], v6 offset:11520
    v_mfma_f32_16x16x32_bf16 v[108:111], v[20:23], v[32:35], 0
    ds_read_b128 v[56:59], v11 offset:2048
    v_mfma_f32_16x16x32_bf16 v[112:115], v[20:23], v[36:39], 0
    ds_read_b64_tr_b16 v[76:77], v7 offset:10240
    v_mfma_f32_16x16x32_bf16 v[116:119], v[20:23], v[40:43], 0
    ds_read_b64_tr_b16 v[78:79], v7 offset:11520
    v_mfma_f32_16x16x32_bf16 v[120:123], v[20:23], v[44:47], 0
    ds_read_b128 v[60:63], v11 offset:4096
    v_mfma_f32_16x16x32_bf16 v[124:127], v[20:23], v[48:51], 0
    ds_read_b64_tr_b16 v[80:81], v8 offset:10240
    v_mfma_f32_16x16x32_bf16 v[128:131], v[24:27], v[32:35], 0
    ds_read_b64_tr_b16 v[82:83], v8 offset:11520
    v_mfma_f32_16x16x32_bf16 v[132:135], v[24:27], v[36:39], 0
    ds_read_b128 v[64:67], v11 offset:6144
    v_mfma_f32_16x16x32_bf16 v[136:139], v[24:27], v[40:43], 0
    ds_read_b64_tr_b16 v[84:85], v9 offset:10240
    v_mfma_f32_16x16x32_bf16 v[140:143], v[24:27], v[44:47], 0
    ds_read_b64_tr_b16 v[86:87], v9 offset:11520
    v_mfma_f32_16x16x32_bf16 v[144:147], v[24:27], v[48:51], 0
    s_cmp_ge_u32 s36, 2
    s_cbranch_scc1 k1_kv3_50
    v_mfma_f32_16x16x32_bf16 v[148:151], v[28:31], v[32:35], 0
    v_mfma_f32_16x16x32_bf16 v[152:155], v[28:31], v[36:39], 0
    v_mfma_f32_16x16x32_bf16 v[156:159], v[28:31], v[40:43], 0
    v_mfma_f32_16x16x32_bf16 v[160:163], v[28:31], v[44:47], 0
    v_mfma_f32_16x16x32_bf16 v[164:167], v[28:31], v[48:51], 0
k1_kv3_50:
    s_waitcnt lgkmcnt(0)
    s_barrier
    v_mfma_f32_16x16x32_bf16 v[88:91], v[52:55], v[68:71], v[88:91]
    ds_read_b64_tr_b16 v[32:33], v5 offset:20480
    v_mfma_f32_16x16x32_bf16 v[92:95], v[52:55], v[72:75], v[92:95]
    ds_read_b64_tr_b16 v[34:35], v5 offset:21760
    v_mfma_f32_16x16x32_bf16 v[96:99], v[52:55], v[76:79], v[96:99]
    ds_read_b128 v[16:19], v10 offset:32768
    v_mfma_f32_16x16x32_bf16 v[100:103], v[52:55], v[80:83], v[100:103]
    ds_read_b64_tr_b16 v[36:37], v6 offset:20480
    v_mfma_f32_16x16x32_bf16 v[104:107], v[52:55], v[84:87], v[104:107]
    ds_read_b64_tr_b16 v[38:39], v6 offset:21760
    v_mfma_f32_16x16x32_bf16 v[108:111], v[56:59], v[68:71], v[108:111]
    ds_read_b128 v[20:23], v10 offset:34816
    v_mfma_f32_16x16x32_bf16 v[112:115], v[56:59], v[72:75], v[112:115]
    ds_read_b64_tr_b16 v[40:41], v7 offset:20480
    v_mfma_f32_16x16x32_bf16 v[116:119], v[56:59], v[76:79], v[116:119]
    ds_read_b64_tr_b16 v[42:43], v7 offset:21760
    v_mfma_f32_16x16x32_bf16 v[120:123], v[56:59], v[80:83], v[120:123]
    ds_read_b128 v[24:27], v10 offset:36864
    v_mfma_f32_16x16x32_bf16 v[124:127], v[56:59], v[84:87], v[124:127]
    ds_read_b64_tr_b16 v[44:45], v8 offset:20480
    v_mfma_f32_16x16x32_bf16 v[128:131], v[60:63], v[68:71], v[128:131]
    ds_read_b64_tr_b16 v[46:47], v8 offset:21760
    v_mfma_f32_16x16x32_bf16 v[132:135], v[60:63], v[72:75], v[132:135]
    ds_read_b128 v[28:31], v10 offset:38912
    v_mfma_f32_16x16x32_bf16 v[136:139], v[60:63], v[76:79], v[136:139]
    ds_read_b64_tr_b16 v[48:49], v9 offset:20480
    v_mfma_f32_16x16x32_bf16 v[140:143], v[60:63], v[80:83], v[140:143]
    ds_read_b64_tr_b16 v[50:51], v9 offset:21760
    v_mfma_f32_16x16x32_bf16 v[144:147], v[60:63], v[84:87], v[144:147]
    s_cmp_ge_u32 s36, 2
    s_cbranch_scc1 k1_kv3_51
    v_mfma_f32_16x16x32_bf16 v[148:151], v[64:67], v[68:71], v[148:151]
    v_mfma_f32_16x16x32_bf16 v[152:155], v[64:67], v[72:75], v[152:155]
    v_mfma_f32_16x16x32_bf16 v[156:159], v[64:67], v[76:79], v[156:159]
    v_mfma_f32_16x16x32_bf16 v[160:163], v[64:67], v[80:83], v[160:163]
    v_mfma_f32_16x16x32_bf16 v[164:167], v[64:67], v[84:87], v[164:167]
k1_kv3_51:
    s_waitcnt lgkmcnt(0)
    v_mfma_f32_16x16x32_bf16 v[88:91], v[16:19], v[32:35], v[88:91]
    ds_read_b64_tr_b16 v[68:69], v5 offset:30720
    v_mfma_f32_16x16x32_bf16 v[92:95], v[16:19], v[36:39], v[92:95]
    ds_read_b64_tr_b16 v[70:71], v5 offset:32000
    v_mfma_f32_16x16x32_bf16 v[96:99], v[16:19], v[40:43], v[96:99]
    ds_read_b128 v[52:55], v11 offset:32768
    v_mfma_f32_16x16x32_bf16 v[100:103], v[16:19], v[44:47], v[100:103]
    ds_read_b64_tr_b16 v[72:73], v6 offset:30720
    v_mfma_f32_16x16x32_bf16 v[104:107], v[16:19], v[48:51], v[104:107]
    ds_read_b64_tr_b16 v[74:75], v6 offset:32000
    v_mfma_f32_16x16x32_bf16 v[108:111], v[20:23], v[32:35], v[108:111]
    ds_read_b128 v[56:59], v11 offset:34816
    v_mfma_f32_16x16x32_bf16 v[112:115], v[20:23], v[36:39], v[112:115]
    ds_read_b64_tr_b16 v[76:77], v7 offset:30720
    v_mfma_f32_16x16x32_bf16 v[116:119], v[20:23], v[40:43], v[116:119]
    ds_read_b64_tr_b16 v[78:79], v7 offset:32000
    v_mfma_f32_16x16x32_bf16 v[120:123], v[20:23], v[44:47], v[120:123]
    ds_read_b128 v[60:63], v11 offset:36864
    v_mfma_f32_16x16x32_bf16 v[124:127], v[20:23], v[48:51], v[124:127]
    ds_read_b64_tr_b16 v[80:81], v8 offset:30720
    v_mfma_f32_16x16x32_bf16 v[128:131], v[24:27], v[32:35], v[128:131]
    ds_read_b64_tr_b16 v[82:83], v8 offset:32000
    v_mfma_f32_16x16x32_bf16 v[132:135], v[24:27], v[36:39], v[132:135]
    ds_read_b128 v[64:67], v11 offset:38912
    v_mfma_f32_16x16x32_bf16 v[136:139], v[24:27], v[40:43], v[136:139]
    ds_read_b64_tr_b16 v[84:85], v9 offset:30720
    v_mfma_f32_16x16x32_bf16 v[140:143], v[24:27], v[44:47], v[140:143]
    ds_read_b64_tr_b16 v[86:87], v9 offset:32000
    v_mfma_f32_16x16x32_bf16 v[144:147], v[24:27], v[48:51], v[144:147]
    s_cmp_ge_u32 s36, 2
    s_cbranch_scc1 k1_kv3_52
    v_mfma_f32_16x16x32_bf16 v[148:151], v[28:31], v[32:35], v[148:151]
    v_mfma_f32_16x16x32_bf16 v[152:155], v[28:31], v[36:39], v[152:155]
    v_mfma_f32_16x16x32_bf16 v[156:159], v[28:31], v[40:43], v[156:159]
    v_mfma_f32_16x16x32_bf16 v[160:163], v[28:31], v[44:47], v[160:163]
    v_mfma_f32_16x16x32_bf16 v[164:167], v[28:31], v[48:51], v[164:167]
k1_kv3_52:
    s_waitcnt lgkmcnt(0)
    s_barrier
    v_mfma_f32_16x16x32_bf16 v[88:91], v[52:55], v[68:71], v[88:91]
    ds_read_b64_tr_b16 v[32:33], v5 offset:40960
    v_mfma_f32_16x16x32_bf16 v[92:95], v[52:55], v[72:75], v[92:95]
    ds_read_b64_tr_b16 v[34:35], v5 offset:42240
    v_mfma_f32_16x16x32_bf16 v[96:99], v[52:55], v[76:79], v[96:99]
    ds_read_b128 v[16:19], v12 offset:0
    v_mfma_f32_16x16x32_bf16 v[100:103], v[52:55], v[80:83], v[100:103]
    ds_read_b64_tr_b16 v[36:37], v6 offset:40960
    v_mfma_f32_16x16x32_bf16 v[104:107], v[52:55], v[84:87], v[104:107]
    ds_read_b64_tr_b16 v[38:39], v6 offset:42240
    v_mfma_f32_16x16x32_bf16 v[108:111], v[56:59], v[68:71], v[108:111]
    ds_read_b128 v[20:23], v12 offset:2048
    v_mfma_f32_16x16x32_bf16 v[112:115], v[56:59], v[72:75], v[112:115]
    ds_read_b64_tr_b16 v[40:41], v7 offset:40960
    v_mfma_f32_16x16x32_bf16 v[116:119], v[56:59], v[76:79], v[116:119]
    ds_read_b64_tr_b16 v[42:43], v7 offset:42240
    v_mfma_f32_16x16x32_bf16 v[120:123], v[56:59], v[80:83], v[120:123]
    ds_read_b128 v[24:27], v12 offset:4096
    v_mfma_f32_16x16x32_bf16 v[124:127], v[56:59], v[84:87], v[124:127]
    ds_read_b64_tr_b16 v[44:45], v8 offset:40960
    v_mfma_f32_16x16x32_bf16 v[128:131], v[60:63], v[68:71], v[128:131]
    ds_read_b64_tr_b16 v[46:47], v8 offset:42240
    v_mfma_f32_16x16x32_bf16 v[132:135], v[60:63], v[72:75], v[132:135]
    ds_read_b128 v[28:31], v12 offset:6144
    v_mfma_f32_16x16x32_bf16 v[136:139], v[60:63], v[76:79], v[136:139]
    ds_read_b64_tr_b16 v[48:49], v9 offset:40960
    v_mfma_f32_16x16x32_bf16 v[140:143], v[60:63], v[80:83], v[140:143]
    ds_read_b64_tr_b16 v[50:51], v9 offset:42240
    v_mfma_f32_16x16x32_bf16 v[144:147], v[60:63], v[84:87], v[144:147]
    s_cmp_ge_u32 s36, 2
    s_cbranch_scc1 k1_kv3_53
    v_mfma_f32_16x16x32_bf16 v[148:151], v[64:67], v[68:71], v[148:151]
    v_mfma_f32_16x16x32_bf16 v[152:155], v[64:67], v[72:75], v[152:155]
    v_mfma_f32_16x16x32_bf16 v[156:159], v[64:67], v[76:79], v[156:159]
    v_mfma_f32_16x16x32_bf16 v[160:163], v[64:67], v[80:83], v[160:163]
    v_mfma_f32_16x16x32_bf16 v[164:167], v[64:67], v[84:87], v[164:167]
k1_kv3_53:
    s_waitcnt lgkmcnt(0)
    v_mfma_f32_16x16x32_bf16 v[88:91], v[16:19], v[32:35], v[88:91]
    ds_read_b64_tr_b16 v[68:69], v5 offset:51200
    v_mfma_f32_16x16x32_bf16 v[92:95], v[16:19], v[36:39], v[92:95]
    ds_read_b64_tr_b16 v[70:71], v5 offset:52480
    v_mfma_f32_16x16x32_bf16 v[96:99], v[16:19], v[40:43], v[96:99]
    ds_read_b128 v[52:55], v13 offset:0
    v_mfma_f32_16x16x32_bf16 v[100:103], v[16:19], v[44:47], v[100:103]
    ds_read_b64_tr_b16 v[72:73], v6 offset:51200
    v_mfma_f32_16x16x32_bf16 v[104:107], v[16:19], v[48:51], v[104:107]
    ds_read_b64_tr_b16 v[74:75], v6 offset:52480
    v_mfma_f32_16x16x32_bf16 v[108:111], v[20:23], v[32:35], v[108:111]
    ds_read_b128 v[56:59], v13 offset:2048
    v_mfma_f32_16x16x32_bf16 v[112:115], v[20:23], v[36:39], v[112:115]
    ds_read_b64_tr_b16 v[76:77], v7 offset:51200
    v_mfma_f32_16x16x32_bf16 v[116:119], v[20:23], v[40:43], v[116:119]
    ds_read_b64_tr_b16 v[78:79], v7 offset:52480
    v_mfma_f32_16x16x32_bf16 v[120:123], v[20:23], v[44:47], v[120:123]
    ds_read_b128 v[60:63], v13 offset:4096
    v_mfma_f32_16x16x32_bf16 v[124:127], v[20:23], v[48:51], v[124:127]
    ds_read_b64_tr_b16 v[80:81], v8 offset:51200
    v_mfma_f32_16x16x32_bf16 v[128:131], v[24:27], v[32:35], v[128:131]
    ds_read_b64_tr_b16 v[82:83], v8 offset:52480
    v_mfma_f32_16x16x32_bf16 v[132:135], v[24:27], v[36:39], v[132:135]
    ds_read_b128 v[64:67], v13 offset:6144
    v_mfma_f32_16x16x32_bf16 v[136:139], v[24:27], v[40:43], v[136:139]
    ds_read_b64_tr_b16 v[84:85], v9 offset:51200
    v_mfma_f32_16x16x32_bf16 v[140:143], v[24:27], v[44:47], v[140:143]
    ds_read_b64_tr_b16 v[86:87], v9 offset:52480
    v_mfma_f32_16x16x32_bf16 v[144:147], v[24:27], v[48:51], v[144:147]
    s_cmp_ge_u32 s36, 2
    s_cbranch_scc1 k1_kv3_54
    v_mfma_f32_16x16x32_bf16 v[148:151], v[28:31], v[32:35], v[148:151]
    v_mfma_f32_16x16x32_bf16 v[152:155], v[28:31], v[36:39], v[152:155]
    v_mfma_f32_16x16x32_bf16 v[156:159], v[28:31], v[40:43], v[156:159]
    v_mfma_f32_16x16x32_bf16 v[160:163], v[28:31], v[44:47], v[160:163]
    v_mfma_f32_16x16x32_bf16 v[164:167], v[28:31], v[48:51], v[164:167]
k1_kv3_54:
    s_waitcnt lgkmcnt(0)
    s_barrier
    v_mfma_f32_16x16x32_bf16 v[88:91], v[52:55], v[68:71], v[88:91]
    ds_read_b64_tr_b16 v[32:33], v5 offset:0
    v_mfma_f32_16x16x32_bf16 v[92:95], v[52:55], v[72:75], v[92:95]
    ds_read_b64_tr_b16 v[34:35], v5 offset:1280
    v_mfma_f32_16x16x32_bf16 v[96:99], v[52:55], v[76:79], v[96:99]
    ds_read_b128 v[16:19], v10 offset:0
    v_mfma_f32_16x16x32_bf16 v[100:103], v[52:55], v[80:83], v[100:103]
    ds_read_b64_tr_b16 v[36:37], v6 offset:0
    v_mfma_f32_16x16x32_bf16 v[104:107], v[52:55], v[84:87], v[104:107]
    ds_read_b64_tr_b16 v[38:39], v6 offset:1280
    v_mfma_f32_16x16x32_bf16 v[108:111], v[56:59], v[68:71], v[108:111]
    ds_read_b128 v[20:23], v10 offset:2048
    v_mfma_f32_16x16x32_bf16 v[112:115], v[56:59], v[72:75], v[112:115]
    ds_read_b64_tr_b16 v[40:41], v7 offset:0
    v_mfma_f32_16x16x32_bf16 v[116:119], v[56:59], v[76:79], v[116:119]
    ds_read_b64_tr_b16 v[42:43], v7 offset:1280
    v_mfma_f32_16x16x32_bf16 v[120:123], v[56:59], v[80:83], v[120:123]
    ds_read_b128 v[24:27], v10 offset:4096
    v_mfma_f32_16x16x32_bf16 v[124:127], v[56:59], v[84:87], v[124:127]
    ds_read_b64_tr_b16 v[44:45], v8 offset:0
    v_mfma_f32_16x16x32_bf16 v[128:131], v[60:63], v[68:71], v[128:131]
    ds_read_b64_tr_b16 v[46:47], v8 offset:1280
    v_mfma_f32_16x16x32_bf16 v[132:135], v[60:63], v[72:75], v[132:135]
    ds_read_b128 v[28:31], v10 offset:6144
    v_mfma_f32_16x16x32_bf16 v[136:139], v[60:63], v[76:79], v[136:139]
    ds_read_b64_tr_b16 v[48:49], v9 offset:0
    v_mfma_f32_16x16x32_bf16 v[140:143], v[60:63], v[80:83], v[140:143]
    ds_read_b64_tr_b16 v[50:51], v9 offset:1280
    v_mfma_f32_16x16x32_bf16 v[144:147], v[60:63], v[84:87], v[144:147]
    s_cmp_ge_u32 s36, 2
    s_cbranch_scc1 k1_kv3_55
    v_mfma_f32_16x16x32_bf16 v[148:151], v[64:67], v[68:71], v[148:151]
    v_mfma_f32_16x16x32_bf16 v[152:155], v[64:67], v[72:75], v[152:155]
    v_mfma_f32_16x16x32_bf16 v[156:159], v[64:67], v[76:79], v[156:159]
    v_mfma_f32_16x16x32_bf16 v[160:163], v[64:67], v[80:83], v[160:163]
    v_mfma_f32_16x16x32_bf16 v[164:167], v[64:67], v[84:87], v[164:167]
k1_kv3_55:
    s_waitcnt lgkmcnt(0)
    v_mfma_f32_16x16x32_bf16 v[88:91], v[16:19], v[32:35], v[88:91]
    ds_read_b64_tr_b16 v[68:69], v5 offset:10240
    v_mfma_f32_16x16x32_bf16 v[92:95], v[16:19], v[36:39], v[92:95]
    ds_read_b64_tr_b16 v[70:71], v5 offset:11520
    v_mfma_f32_16x16x32_bf16 v[96:99], v[16:19], v[40:43], v[96:99]
    ds_read_b128 v[52:55], v11 offset:0
    v_mfma_f32_16x16x32_bf16 v[100:103], v[16:19], v[44:47], v[100:103]
    ds_read_b64_tr_b16 v[72:73], v6 offset:10240
    v_mfma_f32_16x16x32_bf16 v[104:107], v[16:19], v[48:51], v[104:107]
    ds_read_b64_tr_b16 v[74:75], v6 offset:11520
    v_mfma_f32_16x16x32_bf16 v[108:111], v[20:23], v[32:35], v[108:111]
    ds_read_b128 v[56:59], v11 offset:2048
    v_mfma_f32_16x16x32_bf16 v[112:115], v[20:23], v[36:39], v[112:115]
    ds_read_b64_tr_b16 v[76:77], v7 offset:10240
    v_mfma_f32_16x16x32_bf16 v[116:119], v[20:23], v[40:43], v[116:119]
    ds_read_b64_tr_b16 v[78:79], v7 offset:11520
    v_mfma_f32_16x16x32_bf16 v[120:123], v[20:23], v[44:47], v[120:123]
    ds_read_b128 v[60:63], v11 offset:4096
    v_mfma_f32_16x16x32_bf16 v[124:127], v[20:23], v[48:51], v[124:127]
    ds_read_b64_tr_b16 v[80:81], v8 offset:10240
    v_mfma_f32_16x16x32_bf16 v[128:131], v[24:27], v[32:35], v[128:131]
    ds_read_b64_tr_b16 v[82:83], v8 offset:11520
    v_mfma_f32_16x16x32_bf16 v[132:135], v[24:27], v[36:39], v[132:135]
    ds_read_b128 v[64:67], v11 offset:6144
    v_mfma_f32_16x16x32_bf16 v[136:139], v[24:27], v[40:43], v[136:139]
    ds_read_b64_tr_b16 v[84:85], v9 offset:10240
    v_mfma_f32_16x16x32_bf16 v[140:143], v[24:27], v[44:47], v[140:143]
    ds_read_b64_tr_b16 v[86:87], v9 offset:11520
    v_mfma_f32_16x16x32_bf16 v[144:147], v[24:27], v[48:51], v[144:147]
    s_cmp_ge_u32 s36, 2
    s_cbranch_scc1 k1_kv3_56
    v_mfma_f32_16x16x32_bf16 v[148:151], v[28:31], v[32:35], v[148:151]
    v_mfma_f32_16x16x32_bf16 v[152:155], v[28:31], v[36:39], v[152:155]
    v_mfma_f32_16x16x32_bf16 v[156:159], v[28:31], v[40:43], v[156:159]
    v_mfma_f32_16x16x32_bf16 v[160:163], v[28:31], v[44:47], v[160:163]
    v_mfma_f32_16x16x32_bf16 v[164:167], v[28:31], v[48:51], v[164:167]
k1_kv3_56:
    s_waitcnt lgkmcnt(0)
    s_barrier
    v_mfma_f32_16x16x32_bf16 v[88:91], v[52:55], v[68:71], v[88:91]
    ds_read_b64_tr_b16 v[32:33], v5 offset:20480
    v_mfma_f32_16x16x32_bf16 v[92:95], v[52:55], v[72:75], v[92:95]
    ds_read_b64_tr_b16 v[34:35], v5 offset:21760
    v_mfma_f32_16x16x32_bf16 v[96:99], v[52:55], v[76:79], v[96:99]
    ds_read_b128 v[16:19], v10 offset:32768
    v_mfma_f32_16x16x32_bf16 v[100:103], v[52:55], v[80:83], v[100:103]
    ds_read_b64_tr_b16 v[36:37], v6 offset:20480
    v_mfma_f32_16x16x32_bf16 v[104:107], v[52:55], v[84:87], v[104:107]
    ds_read_b64_tr_b16 v[38:39], v6 offset:21760
    v_mfma_f32_16x16x32_bf16 v[108:111], v[56:59], v[68:71], v[108:111]
    ds_read_b128 v[20:23], v10 offset:34816
    v_mfma_f32_16x16x32_bf16 v[112:115], v[56:59], v[72:75], v[112:115]
    ds_read_b64_tr_b16 v[40:41], v7 offset:20480
    v_mfma_f32_16x16x32_bf16 v[116:119], v[56:59], v[76:79], v[116:119]
    ds_read_b64_tr_b16 v[42:43], v7 offset:21760
    v_mfma_f32_16x16x32_bf16 v[120:123], v[56:59], v[80:83], v[120:123]
    ds_read_b128 v[24:27], v10 offset:36864
    v_mfma_f32_16x16x32_bf16 v[124:127], v[56:59], v[84:87], v[124:127]
    ds_read_b64_tr_b16 v[44:45], v8 offset:20480
    v_mfma_f32_16x16x32_bf16 v[128:131], v[60:63], v[68:71], v[128:131]
    ds_read_b64_tr_b16 v[46:47], v8 offset:21760
    v_mfma_f32_16x16x32_bf16 v[132:135], v[60:63], v[72:75], v[132:135]
    ds_read_b128 v[28:31], v10 offset:38912
    v_mfma_f32_16x16x32_bf16 v[136:139], v[60:63], v[76:79], v[136:139]
    ds_read_b64_tr_b16 v[48:49], v9 offset:20480
    v_mfma_f32_16x16x32_bf16 v[140:143], v[60:63], v[80:83], v[140:143]
    ds_read_b64_tr_b16 v[50:51], v9 offset:21760
    v_mfma_f32_16x16x32_bf16 v[144:147], v[60:63], v[84:87], v[144:147]
    s_cmp_ge_u32 s36, 2
    s_cbranch_scc1 k1_kv3_57
    v_mfma_f32_16x16x32_bf16 v[148:151], v[64:67], v[68:71], v[148:151]
    v_mfma_f32_16x16x32_bf16 v[152:155], v[64:67], v[72:75], v[152:155]
    v_mfma_f32_16x16x32_bf16 v[156:159], v[64:67], v[76:79], v[156:159]
    v_mfma_f32_16x16x32_bf16 v[160:163], v[64:67], v[80:83], v[160:163]
    v_mfma_f32_16x16x32_bf16 v[164:167], v[64:67], v[84:87], v[164:167]
k1_kv3_57:
    s_waitcnt lgkmcnt(0)
    v_mfma_f32_16x16x32_bf16 v[88:91], v[16:19], v[32:35], v[88:91]
    ds_read_b64_tr_b16 v[68:69], v5 offset:30720
    v_mfma_f32_16x16x32_bf16 v[92:95], v[16:19], v[36:39], v[92:95]
    ds_read_b64_tr_b16 v[70:71], v5 offset:32000
    v_mfma_f32_16x16x32_bf16 v[96:99], v[16:19], v[40:43], v[96:99]
    ds_read_b128 v[52:55], v11 offset:32768
    v_mfma_f32_16x16x32_bf16 v[100:103], v[16:19], v[44:47], v[100:103]
    ds_read_b64_tr_b16 v[72:73], v6 offset:30720
    v_mfma_f32_16x16x32_bf16 v[104:107], v[16:19], v[48:51], v[104:107]
    ds_read_b64_tr_b16 v[74:75], v6 offset:32000
    v_mfma_f32_16x16x32_bf16 v[108:111], v[20:23], v[32:35], v[108:111]
    ds_read_b128 v[56:59], v11 offset:34816
    v_mfma_f32_16x16x32_bf16 v[112:115], v[20:23], v[36:39], v[112:115]
    ds_read_b64_tr_b16 v[76:77], v7 offset:30720
    v_mfma_f32_16x16x32_bf16 v[116:119], v[20:23], v[40:43], v[116:119]
    ds_read_b64_tr_b16 v[78:79], v7 offset:32000
    v_mfma_f32_16x16x32_bf16 v[120:123], v[20:23], v[44:47], v[120:123]
    ds_read_b128 v[60:63], v11 offset:36864
    v_mfma_f32_16x16x32_bf16 v[124:127], v[20:23], v[48:51], v[124:127]
    ds_read_b64_tr_b16 v[80:81], v8 offset:30720
    v_mfma_f32_16x16x32_bf16 v[128:131], v[24:27], v[32:35], v[128:131]
    ds_read_b64_tr_b16 v[82:83], v8 offset:32000
    v_mfma_f32_16x16x32_bf16 v[132:135], v[24:27], v[36:39], v[132:135]
    ds_read_b128 v[64:67], v11 offset:38912
    v_mfma_f32_16x16x32_bf16 v[136:139], v[24:27], v[40:43], v[136:139]
    ds_read_b64_tr_b16 v[84:85], v9 offset:30720
    v_mfma_f32_16x16x32_bf16 v[140:143], v[24:27], v[44:47], v[140:143]
    ds_read_b64_tr_b16 v[86:87], v9 offset:32000
    v_mfma_f32_16x16x32_bf16 v[144:147], v[24:27], v[48:51], v[144:147]
    s_cmp_ge_u32 s36, 2
    s_cbranch_scc1 k1_kv3_58
    v_mfma_f32_16x16x32_bf16 v[148:151], v[28:31], v[32:35], v[148:151]
    v_mfma_f32_16x16x32_bf16 v[152:155], v[28:31], v[36:39], v[152:155]
    v_mfma_f32_16x16x32_bf16 v[156:159], v[28:31], v[40:43], v[156:159]
    v_mfma_f32_16x16x32_bf16 v[160:163], v[28:31], v[44:47], v[160:163]
    v_mfma_f32_16x16x32_bf16 v[164:167], v[28:31], v[48:51], v[164:167]
k1_kv3_58:
    s_waitcnt lgkmcnt(0)
    s_barrier
    v_mfma_f32_16x16x32_bf16 v[88:91], v[52:55], v[68:71], v[88:91]
    ds_read_b64_tr_b16 v[32:33], v5 offset:40960
    v_mfma_f32_16x16x32_bf16 v[92:95], v[52:55], v[72:75], v[92:95]
    ds_read_b64_tr_b16 v[34:35], v5 offset:42240
    v_mfma_f32_16x16x32_bf16 v[96:99], v[52:55], v[76:79], v[96:99]
    ds_read_b128 v[16:19], v12 offset:0
    v_mfma_f32_16x16x32_bf16 v[100:103], v[52:55], v[80:83], v[100:103]
    ds_read_b64_tr_b16 v[36:37], v6 offset:40960
    v_mfma_f32_16x16x32_bf16 v[104:107], v[52:55], v[84:87], v[104:107]
    ds_read_b64_tr_b16 v[38:39], v6 offset:42240
    v_mfma_f32_16x16x32_bf16 v[108:111], v[56:59], v[68:71], v[108:111]
    ds_read_b128 v[20:23], v12 offset:2048
    v_mfma_f32_16x16x32_bf16 v[112:115], v[56:59], v[72:75], v[112:115]
    ds_read_b64_tr_b16 v[40:41], v7 offset:40960
    v_mfma_f32_16x16x32_bf16 v[116:119], v[56:59], v[76:79], v[116:119]
    ds_read_b64_tr_b16 v[42:43], v7 offset:42240
    v_mfma_f32_16x16x32_bf16 v[120:123], v[56:59], v[80:83], v[120:123]
    ds_read_b128 v[24:27], v12 offset:4096
    v_mfma_f32_16x16x32_bf16 v[124:127], v[56:59], v[84:87], v[124:127]
    ds_read_b64_tr_b16 v[44:45], v8 offset:40960
    v_mfma_f32_16x16x32_bf16 v[128:131], v[60:63], v[68:71], v[128:131]
    ds_read_b64_tr_b16 v[46:47], v8 offset:42240
    v_mfma_f32_16x16x32_bf16 v[132:135], v[60:63], v[72:75], v[132:135]
    ds_read_b128 v[28:31], v12 offset:6144
    v_mfma_f32_16x16x32_bf16 v[136:139], v[60:63], v[76:79], v[136:139]
    ds_read_b64_tr_b16 v[48:49], v9 offset:40960
    v_mfma_f32_16x16x32_bf16 v[140:143], v[60:63], v[80:83], v[140:143]
    ds_read_b64_tr_b16 v[50:51], v9 offset:42240
    v_mfma_f32_16x16x32_bf16 v[144:147], v[60:63], v[84:87], v[144:147]
    s_cmp_ge_u32 s36, 2
    s_cbranch_scc1 k1_kv3_59
    v_mfma_f32_16x16x32_bf16 v[148:151], v[64:67], v[68:71], v[148:151]
    v_mfma_f32_16x16x32_bf16 v[152:155], v[64:67], v[72:75], v[152:155]
    v_mfma_f32_16x16x32_bf16 v[156:159], v[64:67], v[76:79], v[156:159]
    v_mfma_f32_16x16x32_bf16 v[160:163], v[64:67], v[80:83], v[160:163]
    v_mfma_f32_16x16x32_bf16 v[164:167], v[64:67], v[84:87], v[164:167]
k1_kv3_59:
    s_waitcnt lgkmcnt(0)
    v_mfma_f32_16x16x32_bf16 v[88:91], v[16:19], v[32:35], v[88:91]
    ds_read_b64_tr_b16 v[68:69], v5 offset:51200
    v_mfma_f32_16x16x32_bf16 v[92:95], v[16:19], v[36:39], v[92:95]
    ds_read_b64_tr_b16 v[70:71], v5 offset:52480
    v_mfma_f32_16x16x32_bf16 v[96:99], v[16:19], v[40:43], v[96:99]
    ds_read_b128 v[52:55], v13 offset:0
    v_mfma_f32_16x16x32_bf16 v[100:103], v[16:19], v[44:47], v[100:103]
    ds_read_b64_tr_b16 v[72:73], v6 offset:51200
    v_mfma_f32_16x16x32_bf16 v[104:107], v[16:19], v[48:51], v[104:107]
    ds_read_b64_tr_b16 v[74:75], v6 offset:52480
    v_mfma_f32_16x16x32_bf16 v[108:111], v[20:23], v[32:35], v[108:111]
    ds_read_b128 v[56:59], v13 offset:2048
    v_mfma_f32_16x16x32_bf16 v[112:115], v[20:23], v[36:39], v[112:115]
    ds_read_b64_tr_b16 v[76:77], v7 offset:51200
    v_mfma_f32_16x16x32_bf16 v[116:119], v[20:23], v[40:43], v[116:119]
    ds_read_b64_tr_b16 v[78:79], v7 offset:52480
    v_mfma_f32_16x16x32_bf16 v[120:123], v[20:23], v[44:47], v[120:123]
    ds_read_b128 v[60:63], v13 offset:4096
    v_mfma_f32_16x16x32_bf16 v[124:127], v[20:23], v[48:51], v[124:127]
    ds_read_b64_tr_b16 v[80:81], v8 offset:51200
    v_mfma_f32_16x16x32_bf16 v[128:131], v[24:27], v[32:35], v[128:131]
    ds_read_b64_tr_b16 v[82:83], v8 offset:52480
    v_mfma_f32_16x16x32_bf16 v[132:135], v[24:27], v[36:39], v[132:135]
    ds_read_b128 v[64:67], v13 offset:6144
    v_mfma_f32_16x16x32_bf16 v[136:139], v[24:27], v[40:43], v[136:139]
    ds_read_b64_tr_b16 v[84:85], v9 offset:51200
    v_mfma_f32_16x16x32_bf16 v[140:143], v[24:27], v[44:47], v[140:143]
    ds_read_b64_tr_b16 v[86:87], v9 offset:52480
    v_mfma_f32_16x16x32_bf16 v[144:147], v[24:27], v[48:51], v[144:147]
    s_cmp_ge_u32 s36, 2
    s_cbranch_scc1 k1_kv3_60
    v_mfma_f32_16x16x32_bf16 v[148:151], v[28:31], v[32:35], v[148:151]
    v_mfma_f32_16x16x32_bf16 v[152:155], v[28:31], v[36:39], v[152:155]
    v_mfma_f32_16x16x32_bf16 v[156:159], v[28:31], v[40:43], v[156:159]
    v_mfma_f32_16x16x32_bf16 v[160:163], v[28:31], v[44:47], v[160:163]
    v_mfma_f32_16x16x32_bf16 v[164:167], v[28:31], v[48:51], v[164:167]
k1_kv3_60:
    s_waitcnt lgkmcnt(0)
    s_barrier
    v_mfma_f32_16x16x32_bf16 v[88:91], v[52:55], v[68:71], v[88:91]
    ds_read_b64_tr_b16 v[32:33], v5 offset:0
    v_mfma_f32_16x16x32_bf16 v[92:95], v[52:55], v[72:75], v[92:95]
    ds_read_b64_tr_b16 v[34:35], v5 offset:1280
    v_mfma_f32_16x16x32_bf16 v[96:99], v[52:55], v[76:79], v[96:99]
    ds_read_b128 v[16:19], v10 offset:0
    v_mfma_f32_16x16x32_bf16 v[100:103], v[52:55], v[80:83], v[100:103]
    ds_read_b64_tr_b16 v[36:37], v6 offset:0
    v_mfma_f32_16x16x32_bf16 v[104:107], v[52:55], v[84:87], v[104:107]
    ds_read_b64_tr_b16 v[38:39], v6 offset:1280
    v_mfma_f32_16x16x32_bf16 v[108:111], v[56:59], v[68:71], v[108:111]
    ds_read_b128 v[20:23], v10 offset:2048
    v_mfma_f32_16x16x32_bf16 v[112:115], v[56:59], v[72:75], v[112:115]
    ds_read_b64_tr_b16 v[40:41], v7 offset:0
    v_mfma_f32_16x16x32_bf16 v[116:119], v[56:59], v[76:79], v[116:119]
    ds_read_b64_tr_b16 v[42:43], v7 offset:1280
    v_mfma_f32_16x16x32_bf16 v[120:123], v[56:59], v[80:83], v[120:123]
    ds_read_b128 v[24:27], v10 offset:4096
    v_mfma_f32_16x16x32_bf16 v[124:127], v[56:59], v[84:87], v[124:127]
    ds_read_b64_tr_b16 v[44:45], v8 offset:0
    v_mfma_f32_16x16x32_bf16 v[128:131], v[60:63], v[68:71], v[128:131]
    ds_read_b64_tr_b16 v[46:47], v8 offset:1280
    v_mfma_f32_16x16x32_bf16 v[132:135], v[60:63], v[72:75], v[132:135]
    ds_read_b128 v[28:31], v10 offset:6144
    v_mfma_f32_16x16x32_bf16 v[136:139], v[60:63], v[76:79], v[136:139]
    ds_read_b64_tr_b16 v[48:49], v9 offset:0
    v_mfma_f32_16x16x32_bf16 v[140:143], v[60:63], v[80:83], v[140:143]
    ds_read_b64_tr_b16 v[50:51], v9 offset:1280
    v_mfma_f32_16x16x32_bf16 v[144:147], v[60:63], v[84:87], v[144:147]
    s_cmp_ge_u32 s36, 2
    s_cbranch_scc1 k1_kv3_61
    v_mfma_f32_16x16x32_bf16 v[148:151], v[64:67], v[68:71], v[148:151]
    v_mfma_f32_16x16x32_bf16 v[152:155], v[64:67], v[72:75], v[152:155]
    v_mfma_f32_16x16x32_bf16 v[156:159], v[64:67], v[76:79], v[156:159]
    v_mfma_f32_16x16x32_bf16 v[160:163], v[64:67], v[80:83], v[160:163]
    v_mfma_f32_16x16x32_bf16 v[164:167], v[64:67], v[84:87], v[164:167]
k1_kv3_61:
    s_waitcnt lgkmcnt(0)
    v_mfma_f32_16x16x32_bf16 v[88:91], v[16:19], v[32:35], v[88:91]
    ds_read_b64_tr_b16 v[68:69], v5 offset:10240
    v_mfma_f32_16x16x32_bf16 v[92:95], v[16:19], v[36:39], v[92:95]
    ds_read_b64_tr_b16 v[70:71], v5 offset:11520
    v_mfma_f32_16x16x32_bf16 v[96:99], v[16:19], v[40:43], v[96:99]
    ds_read_b128 v[52:55], v11 offset:0
    v_mfma_f32_16x16x32_bf16 v[100:103], v[16:19], v[44:47], v[100:103]
    ds_read_b64_tr_b16 v[72:73], v6 offset:10240
    v_mfma_f32_16x16x32_bf16 v[104:107], v[16:19], v[48:51], v[104:107]
    ds_read_b64_tr_b16 v[74:75], v6 offset:11520
    v_mfma_f32_16x16x32_bf16 v[108:111], v[20:23], v[32:35], v[108:111]
    ds_read_b128 v[56:59], v11 offset:2048
    v_mfma_f32_16x16x32_bf16 v[112:115], v[20:23], v[36:39], v[112:115]
    ds_read_b64_tr_b16 v[76:77], v7 offset:10240
    v_mfma_f32_16x16x32_bf16 v[116:119], v[20:23], v[40:43], v[116:119]
    ds_read_b64_tr_b16 v[78:79], v7 offset:11520
    v_mfma_f32_16x16x32_bf16 v[120:123], v[20:23], v[44:47], v[120:123]
    ds_read_b128 v[60:63], v11 offset:4096
    v_mfma_f32_16x16x32_bf16 v[124:127], v[20:23], v[48:51], v[124:127]
    ds_read_b64_tr_b16 v[80:81], v8 offset:10240
    v_mfma_f32_16x16x32_bf16 v[128:131], v[24:27], v[32:35], v[128:131]
    ds_read_b64_tr_b16 v[82:83], v8 offset:11520
    v_mfma_f32_16x16x32_bf16 v[132:135], v[24:27], v[36:39], v[132:135]
    ds_read_b128 v[64:67], v11 offset:6144
    v_mfma_f32_16x16x32_bf16 v[136:139], v[24:27], v[40:43], v[136:139]
    ds_read_b64_tr_b16 v[84:85], v9 offset:10240
    v_mfma_f32_16x16x32_bf16 v[140:143], v[24:27], v[44:47], v[140:143]
    ds_read_b64_tr_b16 v[86:87], v9 offset:11520
    v_mfma_f32_16x16x32_bf16 v[144:147], v[24:27], v[48:51], v[144:147]
    s_cmp_ge_u32 s36, 2
    s_cbranch_scc1 k1_kv3_62
    v_mfma_f32_16x16x32_bf16 v[148:151], v[28:31], v[32:35], v[148:151]
    v_mfma_f32_16x16x32_bf16 v[152:155], v[28:31], v[36:39], v[152:155]
    v_mfma_f32_16x16x32_bf16 v[156:159], v[28:31], v[40:43], v[156:159]
    v_mfma_f32_16x16x32_bf16 v[160:163], v[28:31], v[44:47], v[160:163]
    v_mfma_f32_16x16x32_bf16 v[164:167], v[28:31], v[48:51], v[164:167]
k1_kv3_62:
    s_waitcnt lgkmcnt(0)
    s_barrier
    v_mfma_f32_16x16x32_bf16 v[88:91], v[52:55], v[68:71], v[88:91]
    ds_read_b64_tr_b16 v[32:33], v5 offset:20480
    v_mfma_f32_16x16x32_bf16 v[92:95], v[52:55], v[72:75], v[92:95]
    ds_read_b64_tr_b16 v[34:35], v5 offset:21760
    v_mfma_f32_16x16x32_bf16 v[96:99], v[52:55], v[76:79], v[96:99]
    ds_read_b128 v[16:19], v10 offset:32768
    v_mfma_f32_16x16x32_bf16 v[100:103], v[52:55], v[80:83], v[100:103]
    ds_read_b64_tr_b16 v[36:37], v6 offset:20480
    v_mfma_f32_16x16x32_bf16 v[104:107], v[52:55], v[84:87], v[104:107]
    ds_read_b64_tr_b16 v[38:39], v6 offset:21760
    v_mfma_f32_16x16x32_bf16 v[108:111], v[56:59], v[68:71], v[108:111]
    ds_read_b128 v[20:23], v10 offset:34816
    v_mfma_f32_16x16x32_bf16 v[112:115], v[56:59], v[72:75], v[112:115]
    ds_read_b64_tr_b16 v[40:41], v7 offset:20480
    v_mfma_f32_16x16x32_bf16 v[116:119], v[56:59], v[76:79], v[116:119]
    ds_read_b64_tr_b16 v[42:43], v7 offset:21760
    v_mfma_f32_16x16x32_bf16 v[120:123], v[56:59], v[80:83], v[120:123]
    ds_read_b128 v[24:27], v10 offset:36864
    v_mfma_f32_16x16x32_bf16 v[124:127], v[56:59], v[84:87], v[124:127]
    ds_read_b64_tr_b16 v[44:45], v8 offset:20480
    v_mfma_f32_16x16x32_bf16 v[128:131], v[60:63], v[68:71], v[128:131]
    ds_read_b64_tr_b16 v[46:47], v8 offset:21760
    v_mfma_f32_16x16x32_bf16 v[132:135], v[60:63], v[72:75], v[132:135]
    ds_read_b128 v[28:31], v10 offset:38912
    v_mfma_f32_16x16x32_bf16 v[136:139], v[60:63], v[76:79], v[136:139]
    ds_read_b64_tr_b16 v[48:49], v9 offset:20480
    v_mfma_f32_16x16x32_bf16 v[140:143], v[60:63], v[80:83], v[140:143]
    ds_read_b64_tr_b16 v[50:51], v9 offset:21760
    v_mfma_f32_16x16x32_bf16 v[144:147], v[60:63], v[84:87], v[144:147]
    s_cmp_ge_u32 s36, 2
    s_cbranch_scc1 k1_kv3_63
    v_mfma_f32_16x16x32_bf16 v[148:151], v[64:67], v[68:71], v[148:151]
    v_mfma_f32_16x16x32_bf16 v[152:155], v[64:67], v[72:75], v[152:155]
    v_mfma_f32_16x16x32_bf16 v[156:159], v[64:67], v[76:79], v[156:159]
    v_mfma_f32_16x16x32_bf16 v[160:163], v[64:67], v[80:83], v[160:163]
    v_mfma_f32_16x16x32_bf16 v[164:167], v[64:67], v[84:87], v[164:167]
k1_kv3_63:
    s_waitcnt lgkmcnt(0)
    v_mfma_f32_16x16x32_bf16 v[88:91], v[16:19], v[32:35], v[88:91]
    ds_read_b64_tr_b16 v[68:69], v5 offset:30720
    v_mfma_f32_16x16x32_bf16 v[92:95], v[16:19], v[36:39], v[92:95]
    ds_read_b64_tr_b16 v[70:71], v5 offset:32000
    v_mfma_f32_16x16x32_bf16 v[96:99], v[16:19], v[40:43], v[96:99]
    ds_read_b128 v[52:55], v11 offset:32768
    v_mfma_f32_16x16x32_bf16 v[100:103], v[16:19], v[44:47], v[100:103]
    ds_read_b64_tr_b16 v[72:73], v6 offset:30720
    v_mfma_f32_16x16x32_bf16 v[104:107], v[16:19], v[48:51], v[104:107]
    ds_read_b64_tr_b16 v[74:75], v6 offset:32000
    v_mfma_f32_16x16x32_bf16 v[108:111], v[20:23], v[32:35], v[108:111]
    ds_read_b128 v[56:59], v11 offset:34816
    v_mfma_f32_16x16x32_bf16 v[112:115], v[20:23], v[36:39], v[112:115]
    ds_read_b64_tr_b16 v[76:77], v7 offset:30720
    v_mfma_f32_16x16x32_bf16 v[116:119], v[20:23], v[40:43], v[116:119]
    ds_read_b64_tr_b16 v[78:79], v7 offset:32000
    v_mfma_f32_16x16x32_bf16 v[120:123], v[20:23], v[44:47], v[120:123]
    ds_read_b128 v[60:63], v11 offset:36864
    v_mfma_f32_16x16x32_bf16 v[124:127], v[20:23], v[48:51], v[124:127]
    ds_read_b64_tr_b16 v[80:81], v8 offset:30720
    v_mfma_f32_16x16x32_bf16 v[128:131], v[24:27], v[32:35], v[128:131]
    ds_read_b64_tr_b16 v[82:83], v8 offset:32000
    v_mfma_f32_16x16x32_bf16 v[132:135], v[24:27], v[36:39], v[132:135]
    ds_read_b128 v[64:67], v11 offset:38912
    v_mfma_f32_16x16x32_bf16 v[136:139], v[24:27], v[40:43], v[136:139]
    ds_read_b64_tr_b16 v[84:85], v9 offset:30720
    v_mfma_f32_16x16x32_bf16 v[140:143], v[24:27], v[44:47], v[140:143]
    ds_read_b64_tr_b16 v[86:87], v9 offset:32000
    v_mfma_f32_16x16x32_bf16 v[144:147], v[24:27], v[48:51], v[144:147]
    s_cmp_ge_u32 s36, 2
    s_cbranch_scc1 k1_kv3_64
    v_mfma_f32_16x16x32_bf16 v[148:151], v[28:31], v[32:35], v[148:151]
    v_mfma_f32_16x16x32_bf16 v[152:155], v[28:31], v[36:39], v[152:155]
    v_mfma_f32_16x16x32_bf16 v[156:159], v[28:31], v[40:43], v[156:159]
    v_mfma_f32_16x16x32_bf16 v[160:163], v[28:31], v[44:47], v[160:163]
    v_mfma_f32_16x16x32_bf16 v[164:167], v[28:31], v[48:51], v[164:167]
k1_kv3_64:
    s_waitcnt lgkmcnt(0)
    s_barrier
    v_mfma_f32_16x16x32_bf16 v[88:91], v[52:55], v[68:71], v[88:91]
    ds_read_b64_tr_b16 v[32:33], v5 offset:40960
    v_mfma_f32_16x16x32_bf16 v[92:95], v[52:55], v[72:75], v[92:95]
    ds_read_b64_tr_b16 v[34:35], v5 offset:42240
    v_mfma_f32_16x16x32_bf16 v[96:99], v[52:55], v[76:79], v[96:99]
    ds_read_b128 v[16:19], v12 offset:0
    v_mfma_f32_16x16x32_bf16 v[100:103], v[52:55], v[80:83], v[100:103]
    ds_read_b64_tr_b16 v[36:37], v6 offset:40960
    v_mfma_f32_16x16x32_bf16 v[104:107], v[52:55], v[84:87], v[104:107]
    ds_read_b64_tr_b16 v[38:39], v6 offset:42240
    v_mfma_f32_16x16x32_bf16 v[108:111], v[56:59], v[68:71], v[108:111]
    ds_read_b128 v[20:23], v12 offset:2048
    v_mfma_f32_16x16x32_bf16 v[112:115], v[56:59], v[72:75], v[112:115]
    ds_read_b64_tr_b16 v[40:41], v7 offset:40960
    v_mfma_f32_16x16x32_bf16 v[116:119], v[56:59], v[76:79], v[116:119]
    ds_read_b64_tr_b16 v[42:43], v7 offset:42240
    v_mfma_f32_16x16x32_bf16 v[120:123], v[56:59], v[80:83], v[120:123]
    ds_read_b128 v[24:27], v12 offset:4096
    v_mfma_f32_16x16x32_bf16 v[124:127], v[56:59], v[84:87], v[124:127]
    ds_read_b64_tr_b16 v[44:45], v8 offset:40960
    v_mfma_f32_16x16x32_bf16 v[128:131], v[60:63], v[68:71], v[128:131]
    ds_read_b64_tr_b16 v[46:47], v8 offset:42240
    v_mfma_f32_16x16x32_bf16 v[132:135], v[60:63], v[72:75], v[132:135]
    ds_read_b128 v[28:31], v12 offset:6144
    v_mfma_f32_16x16x32_bf16 v[136:139], v[60:63], v[76:79], v[136:139]
    ds_read_b64_tr_b16 v[48:49], v9 offset:40960
    v_mfma_f32_16x16x32_bf16 v[140:143], v[60:63], v[80:83], v[140:143]
    ds_read_b64_tr_b16 v[50:51], v9 offset:42240
    v_mfma_f32_16x16x32_bf16 v[144:147], v[60:63], v[84:87], v[144:147]
    s_cmp_ge_u32 s36, 2
    s_cbranch_scc1 k1_kv3_65
    v_mfma_f32_16x16x32_bf16 v[148:151], v[64:67], v[68:71], v[148:151]
    v_mfma_f32_16x16x32_bf16 v[152:155], v[64:67], v[72:75], v[152:155]
    v_mfma_f32_16x16x32_bf16 v[156:159], v[64:67], v[76:79], v[156:159]
    v_mfma_f32_16x16x32_bf16 v[160:163], v[64:67], v[80:83], v[160:163]
    v_mfma_f32_16x16x32_bf16 v[164:167], v[64:67], v[84:87], v[164:167]
k1_kv3_65:
    s_waitcnt lgkmcnt(0)
    v_mfma_f32_16x16x32_bf16 v[88:91], v[16:19], v[32:35], v[88:91]
    ds_read_b64_tr_b16 v[68:69], v5 offset:51200
    v_mfma_f32_16x16x32_bf16 v[92:95], v[16:19], v[36:39], v[92:95]
    ds_read_b64_tr_b16 v[70:71], v5 offset:52480
    v_mfma_f32_16x16x32_bf16 v[96:99], v[16:19], v[40:43], v[96:99]
    ds_read_b128 v[52:55], v13 offset:0
    v_mfma_f32_16x16x32_bf16 v[100:103], v[16:19], v[44:47], v[100:103]
    ds_read_b64_tr_b16 v[72:73], v6 offset:51200
    v_mfma_f32_16x16x32_bf16 v[104:107], v[16:19], v[48:51], v[104:107]
    ds_read_b64_tr_b16 v[74:75], v6 offset:52480
    v_mfma_f32_16x16x32_bf16 v[108:111], v[20:23], v[32:35], v[108:111]
    ds_read_b128 v[56:59], v13 offset:2048
    v_mfma_f32_16x16x32_bf16 v[112:115], v[20:23], v[36:39], v[112:115]
    ds_read_b64_tr_b16 v[76:77], v7 offset:51200
    v_mfma_f32_16x16x32_bf16 v[116:119], v[20:23], v[40:43], v[116:119]
    ds_read_b64_tr_b16 v[78:79], v7 offset:52480
    v_mfma_f32_16x16x32_bf16 v[120:123], v[20:23], v[44:47], v[120:123]
    ds_read_b128 v[60:63], v13 offset:4096
    v_mfma_f32_16x16x32_bf16 v[124:127], v[20:23], v[48:51], v[124:127]
    ds_read_b64_tr_b16 v[80:81], v8 offset:51200
    v_mfma_f32_16x16x32_bf16 v[128:131], v[24:27], v[32:35], v[128:131]
    ds_read_b64_tr_b16 v[82:83], v8 offset:52480
    v_mfma_f32_16x16x32_bf16 v[132:135], v[24:27], v[36:39], v[132:135]
    ds_read_b128 v[64:67], v13 offset:6144
    v_mfma_f32_16x16x32_bf16 v[136:139], v[24:27], v[40:43], v[136:139]
    ds_read_b64_tr_b16 v[84:85], v9 offset:51200
    v_mfma_f32_16x16x32_bf16 v[140:143], v[24:27], v[44:47], v[140:143]
    ds_read_b64_tr_b16 v[86:87], v9 offset:52480
    v_mfma_f32_16x16x32_bf16 v[144:147], v[24:27], v[48:51], v[144:147]
    s_cmp_ge_u32 s36, 2
    s_cbranch_scc1 k1_kv3_66
    v_mfma_f32_16x16x32_bf16 v[148:151], v[28:31], v[32:35], v[148:151]
    v_mfma_f32_16x16x32_bf16 v[152:155], v[28:31], v[36:39], v[152:155]
    v_mfma_f32_16x16x32_bf16 v[156:159], v[28:31], v[40:43], v[156:159]
    v_mfma_f32_16x16x32_bf16 v[160:163], v[28:31], v[44:47], v[160:163]
    v_mfma_f32_16x16x32_bf16 v[164:167], v[28:31], v[48:51], v[164:167]
k1_kv3_66:
    s_waitcnt lgkmcnt(0)
    s_barrier
    v_mfma_f32_16x16x32_bf16 v[88:91], v[52:55], v[68:71], v[88:91]
    ds_read_b64_tr_b16 v[32:33], v5 offset:0
    v_mfma_f32_16x16x32_bf16 v[92:95], v[52:55], v[72:75], v[92:95]
    ds_read_b64_tr_b16 v[34:35], v5 offset:1280
    v_mfma_f32_16x16x32_bf16 v[96:99], v[52:55], v[76:79], v[96:99]
    ds_read_b128 v[16:19], v10 offset:0
    v_mfma_f32_16x16x32_bf16 v[100:103], v[52:55], v[80:83], v[100:103]
    ds_read_b64_tr_b16 v[36:37], v6 offset:0
    v_mfma_f32_16x16x32_bf16 v[104:107], v[52:55], v[84:87], v[104:107]
    ds_read_b64_tr_b16 v[38:39], v6 offset:1280
    v_mfma_f32_16x16x32_bf16 v[108:111], v[56:59], v[68:71], v[108:111]
    ds_read_b128 v[20:23], v10 offset:2048
    v_mfma_f32_16x16x32_bf16 v[112:115], v[56:59], v[72:75], v[112:115]
    ds_read_b64_tr_b16 v[40:41], v7 offset:0
    v_mfma_f32_16x16x32_bf16 v[116:119], v[56:59], v[76:79], v[116:119]
    ds_read_b64_tr_b16 v[42:43], v7 offset:1280
    v_mfma_f32_16x16x32_bf16 v[120:123], v[56:59], v[80:83], v[120:123]
    ds_read_b128 v[24:27], v10 offset:4096
    v_mfma_f32_16x16x32_bf16 v[124:127], v[56:59], v[84:87], v[124:127]
    ds_read_b64_tr_b16 v[44:45], v8 offset:0
    v_mfma_f32_16x16x32_bf16 v[128:131], v[60:63], v[68:71], v[128:131]
    ds_read_b64_tr_b16 v[46:47], v8 offset:1280
    v_mfma_f32_16x16x32_bf16 v[132:135], v[60:63], v[72:75], v[132:135]
    ds_read_b128 v[28:31], v10 offset:6144
    v_mfma_f32_16x16x32_bf16 v[136:139], v[60:63], v[76:79], v[136:139]
    ds_read_b64_tr_b16 v[48:49], v9 offset:0
    v_mfma_f32_16x16x32_bf16 v[140:143], v[60:63], v[80:83], v[140:143]
    ds_read_b64_tr_b16 v[50:51], v9 offset:1280
    v_mfma_f32_16x16x32_bf16 v[144:147], v[60:63], v[84:87], v[144:147]
    s_cmp_ge_u32 s36, 2
    s_cbranch_scc1 k1_kv3_67
    v_mfma_f32_16x16x32_bf16 v[148:151], v[64:67], v[68:71], v[148:151]
    v_mfma_f32_16x16x32_bf16 v[152:155], v[64:67], v[72:75], v[152:155]
    v_mfma_f32_16x16x32_bf16 v[156:159], v[64:67], v[76:79], v[156:159]
    v_mfma_f32_16x16x32_bf16 v[160:163], v[64:67], v[80:83], v[160:163]
    v_mfma_f32_16x16x32_bf16 v[164:167], v[64:67], v[84:87], v[164:167]
k1_kv3_67:
    s_waitcnt lgkmcnt(0)
    v_mfma_f32_16x16x32_bf16 v[88:91], v[16:19], v[32:35], v[88:91]
    ds_read_b64_tr_b16 v[68:69], v5 offset:10240
    v_mfma_f32_16x16x32_bf16 v[92:95], v[16:19], v[36:39], v[92:95]
    ds_read_b64_tr_b16 v[70:71], v5 offset:11520
    v_mfma_f32_16x16x32_bf16 v[96:99], v[16:19], v[40:43], v[96:99]
    ds_read_b128 v[52:55], v11 offset:0
    v_mfma_f32_16x16x32_bf16 v[100:103], v[16:19], v[44:47], v[100:103]
    ds_read_b64_tr_b16 v[72:73], v6 offset:10240
    v_mfma_f32_16x16x32_bf16 v[104:107], v[16:19], v[48:51], v[104:107]
    ds_read_b64_tr_b16 v[74:75], v6 offset:11520
    v_mfma_f32_16x16x32_bf16 v[108:111], v[20:23], v[32:35], v[108:111]
    ds_read_b128 v[56:59], v11 offset:2048
    v_mfma_f32_16x16x32_bf16 v[112:115], v[20:23], v[36:39], v[112:115]
    ds_read_b64_tr_b16 v[76:77], v7 offset:10240
    v_mfma_f32_16x16x32_bf16 v[116:119], v[20:23], v[40:43], v[116:119]
    ds_read_b64_tr_b16 v[78:79], v7 offset:11520
    v_mfma_f32_16x16x32_bf16 v[120:123], v[20:23], v[44:47], v[120:123]
    ds_read_b128 v[60:63], v11 offset:4096
    v_mfma_f32_16x16x32_bf16 v[124:127], v[20:23], v[48:51], v[124:127]
    ds_read_b64_tr_b16 v[80:81], v8 offset:10240
    v_mfma_f32_16x16x32_bf16 v[128:131], v[24:27], v[32:35], v[128:131]
    ds_read_b64_tr_b16 v[82:83], v8 offset:11520
    v_mfma_f32_16x16x32_bf16 v[132:135], v[24:27], v[36:39], v[132:135]
    ds_read_b128 v[64:67], v11 offset:6144
    v_mfma_f32_16x16x32_bf16 v[136:139], v[24:27], v[40:43], v[136:139]
    ds_read_b64_tr_b16 v[84:85], v9 offset:10240
    v_mfma_f32_16x16x32_bf16 v[140:143], v[24:27], v[44:47], v[140:143]
    ds_read_b64_tr_b16 v[86:87], v9 offset:11520
    v_mfma_f32_16x16x32_bf16 v[144:147], v[24:27], v[48:51], v[144:147]
    s_cmp_ge_u32 s36, 2
    s_cbranch_scc1 k1_kv3_68
    v_mfma_f32_16x16x32_bf16 v[148:151], v[28:31], v[32:35], v[148:151]
    v_mfma_f32_16x16x32_bf16 v[152:155], v[28:31], v[36:39], v[152:155]
    v_mfma_f32_16x16x32_bf16 v[156:159], v[28:31], v[40:43], v[156:159]
    v_mfma_f32_16x16x32_bf16 v[160:163], v[28:31], v[44:47], v[160:163]
    v_mfma_f32_16x16x32_bf16 v[164:167], v[28:31], v[48:51], v[164:167]
k1_kv3_68:
    s_waitcnt lgkmcnt(0)
    v_mfma_f32_16x16x32_bf16 v[88:91], v[52:55], v[68:71], v[88:91]
    v_mfma_f32_16x16x32_bf16 v[92:95], v[52:55], v[72:75], v[92:95]
    v_mfma_f32_16x16x32_bf16 v[96:99], v[52:55], v[76:79], v[96:99]
    v_mfma_f32_16x16x32_bf16 v[100:103], v[52:55], v[80:83], v[100:103]
    v_mfma_f32_16x16x32_bf16 v[104:107], v[52:55], v[84:87], v[104:107]
    v_mfma_f32_16x16x32_bf16 v[108:111], v[56:59], v[68:71], v[108:111]
    v_mfma_f32_16x16x32_bf16 v[112:115], v[56:59], v[72:75], v[112:115]
    v_mfma_f32_16x16x32_bf16 v[116:119], v[56:59], v[76:79], v[116:119]
    v_mfma_f32_16x16x32_bf16 v[120:123], v[56:59], v[80:83], v[120:123]
    v_mfma_f32_16x16x32_bf16 v[124:127], v[56:59], v[84:87], v[124:127]
    v_mfma_f32_16x16x32_bf16 v[128:131], v[60:63], v[68:71], v[128:131]
    v_mfma_f32_16x16x32_bf16 v[132:135], v[60:63], v[72:75], v[132:135]
    v_mfma_f32_16x16x32_bf16 v[136:139], v[60:63], v[76:79], v[136:139]
    v_mfma_f32_16x16x32_bf16 v[140:143], v[60:63], v[80:83], v[140:143]
    v_mfma_f32_16x16x32_bf16 v[144:147], v[60:63], v[84:87], v[144:147]
    s_cmp_ge_u32 s36, 2
    s_cbranch_scc1 k1_kv3_69
    v_mfma_f32_16x16x32_bf16 v[148:151], v[64:67], v[68:71], v[148:151]
    v_mfma_f32_16x16x32_bf16 v[152:155], v[64:67], v[72:75], v[152:155]
    v_mfma_f32_16x16x32_bf16 v[156:159], v[64:67], v[76:79], v[156:159]
    v_mfma_f32_16x16x32_bf16 v[160:163], v[64:67], v[80:83], v[160:163]
    v_mfma_f32_16x16x32_bf16 v[164:167], v[64:67], v[84:87], v[164:167]
k1_kv3_69:
    s_waitcnt vmcnt(0)
    s_mov_b32 s42, 0x3fb8aa3b
    s_mov_b32 s43, 0x3fb8aa3b
    s_mov_b32 s44, 0x358637bd
    v_and_b32 v13, 15, v1
    v_cmp_gt_u32 s[40:41], 8, v13
    v_mov_b32 v14, 0x3f803f80
    s_mul_i32 s45, s20, 224
    s_add_u32 s45, s45, s63
    s_cmp_ge_u32 s45, 2048
    s_cbranch_scc1 k1_kvz_70
    v_cvt_pk_bf16_f32 v24, v96, v97
    v_cvt_pk_bf16_f32 v25, v98, v99
    v_cvt_pk_bf16_f32 v26, v116, v117
    v_cvt_pk_bf16_f32 v27, v118, v119
    v_cvt_pk_bf16_f32 v28, v100, v101
    v_cvt_pk_bf16_f32 v29, v102, v103
    v_cvt_pk_bf16_f32 v30, v120, v121
    v_cvt_pk_bf16_f32 v31, v122, v123
    v_cvt_pk_bf16_f32 v36, v104, v105
    v_cvt_pk_bf16_f32 v37, v106, v107
    v_cvt_pk_bf16_f32 v38, v124, v125
    v_cvt_pk_bf16_f32 v39, v126, v127
    v_cndmask_b32 v36, v36, v14, s[40:41]
    v_cndmask_b32 v37, v37, v14, s[40:41]
    v_cndmask_b32 v38, v38, v14, s[40:41]
    v_cndmask_b32 v39, v39, v14, s[40:41]
    v_pk_mul_f32 v[72:73], v[88:89], s[42:43]
    v_pk_mul_f32 v[74:75], v[90:91], s[42:43]
    v_pk_mul_f32 v[76:77], v[108:109], s[42:43]
    v_pk_mul_f32 v[78:79], v[110:111], s[42:43]
    v_exp_f32 v72, v72 clamp
    v_exp_f32 v73, v73 clamp
    v_exp_f32 v74, v74 clamp
    v_exp_f32 v75, v75 clamp
    v_exp_f32 v76, v76 clamp
    v_exp_f32 v77, v77 clamp
    v_exp_f32 v78, v78 clamp
    v_exp_f32 v79, v79 clamp
    v_max_f32 v88, s44, v88
    v_max_f32 v89, s44, v89
    v_max_f32 v90, s44, v90
    v_max_f32 v91, s44, v91
    v_max_f32 v108, s44, v108
    v_max_f32 v109, s44, v109
    v_max_f32 v110, s44, v110
    v_max_f32 v111, s44, v111
    v_pk_add_f32 v[88:89], v[88:89], v[72:73]
    v_pk_add_f32 v[90:91], v[90:91], v[74:75]
    v_pk_add_f32 v[108:109], v[108:109], v[76:77]
    v_pk_add_f32 v[110:111], v[110:111], v[78:79]
    v_cvt_pk_bf16_f32 v16, v88, v89
    v_cvt_pk_bf16_f32 v17, v90, v91
    v_cvt_pk_bf16_f32 v18, v108, v109
    v_cvt_pk_bf16_f32 v19, v110, v111
    v_pk_mul_f32 v[72:73], v[92:93], s[42:43]
    v_pk_mul_f32 v[74:75], v[94:95], s[42:43]
    v_pk_mul_f32 v[76:77], v[112:113], s[42:43]
    v_pk_mul_f32 v[78:79], v[114:115], s[42:43]
    v_exp_f32 v72, v72 clamp
    v_exp_f32 v73, v73 clamp
    v_exp_f32 v74, v74 clamp
    v_exp_f32 v75, v75 clamp
    v_exp_f32 v76, v76 clamp
    v_exp_f32 v77, v77 clamp
    v_exp_f32 v78, v78 clamp
    v_exp_f32 v79, v79 clamp
    v_max_f32 v92, s44, v92
    v_max_f32 v93, s44, v93
    v_max_f32 v94, s44, v94
    v_max_f32 v95, s44, v95
    v_max_f32 v112, s44, v112
    v_max_f32 v113, s44, v113
    v_max_f32 v114, s44, v114
    v_max_f32 v115, s44, v115
    v_pk_add_f32 v[92:93], v[92:93], v[72:73]
    v_pk_add_f32 v[94:95], v[94:95], v[74:75]
    v_pk_add_f32 v[112:113], v[112:113], v[76:77]
    v_pk_add_f32 v[114:115], v[114:115], v[78:79]
    v_cvt_pk_bf16_f32 v20, v92, v93
    v_cvt_pk_bf16_f32 v21, v94, v95
    v_cvt_pk_bf16_f32 v22, v112, v113
    v_cvt_pk_bf16_f32 v23, v114, v115
    v_pk_mul_f32 v[72:73], v[104:105], s[42:43]
    v_pk_mul_f32 v[74:75], v[106:107], s[42:43]
    v_pk_mul_f32 v[76:77], v[124:125], s[42:43]
    v_pk_mul_f32 v[78:79], v[126:127], s[42:43]
    v_exp_f32 v72, v72 clamp
    v_exp_f32 v73, v73 clamp
    v_exp_f32 v74, v74 clamp
    v_exp_f32 v75, v75 clamp
    v_exp_f32 v76, v76 clamp
    v_exp_f32 v77, v77 clamp
    v_exp_f32 v78, v78 clamp
    v_exp_f32 v79, v79 clamp
    v_max_f32 v104, s44, v104
    v_max_f32 v105, s44, v105
    v_max_f32 v106, s44, v106
    v_max_f32 v107, s44, v107
    v_max_f32 v124, s44, v124
    v_max_f32 v125, s44, v125
    v_max_f32 v126, s44, v126
    v_max_f32 v127, s44, v127
    v_pk_add_f32 v[104:105], v[104:105], v[72:73]
    v_pk_add_f32 v[106:107], v[106:107], v[74:75]
    v_pk_add_f32 v[124:125], v[124:125], v[76:77]
    v_pk_add_f32 v[126:127], v[126:127], v[78:79]
    v_cvt_pk_bf16_f32 v32, v104, v105
    v_cvt_pk_bf16_f32 v33, v106, v107
    v_cvt_pk_bf16_f32 v34, v124, v125
    v_cvt_pk_bf16_f32 v35, v126, v127
    v_mfma_f32_16x16x32_bf16 v[40:43], v[16:19], v[24:27], 0
    v_mfma_f32_16x16x32_bf16 v[44:47], v[20:23], v[28:31], 0
    v_mfma_f32_16x16x32_bf16 v[48:51], v[16:19], v[36:39], 0
    v_mfma_f32_16x16x32_bf16 v[52:55], v[20:23], v[36:39], 0
    v_mfma_f32_16x16x32_bf16 v[56:59], v[32:35], v[24:27], 0
    v_mfma_f32_16x16x32_bf16 v[60:63], v[32:35], v[28:31], 0
    v_mfma_f32_16x16x32_bf16 v[64:67], v[32:35], v[36:39], 0
    s_add_u32 s45, s45, 32
    s_cmp_ge_u32 s45, 2048
    s_cbranch_scc1 k1_kvend_72
    s_cmp_ge_u32 s36, 2
    s_cbranch_scc1 k1_kv16_71
    v_cvt_pk_bf16_f32 v24, v136, v137
    v_cvt_pk_bf16_f32 v25, v138, v139
    v_cvt_pk_bf16_f32 v26, v156, v157
    v_cvt_pk_bf16_f32 v27, v158, v159
    v_cvt_pk_bf16_f32 v28, v140, v141
    v_cvt_pk_bf16_f32 v29, v142, v143
    v_cvt_pk_bf16_f32 v30, v160, v161
    v_cvt_pk_bf16_f32 v31, v162, v163
    v_cvt_pk_bf16_f32 v36, v144, v145
    v_cvt_pk_bf16_f32 v37, v146, v147
    v_cvt_pk_bf16_f32 v38, v164, v165
    v_cvt_pk_bf16_f32 v39, v166, v167
    v_cndmask_b32 v36, v36, v14, s[40:41]
    v_cndmask_b32 v37, v37, v14, s[40:41]
    v_cndmask_b32 v38, v38, v14, s[40:41]
    v_cndmask_b32 v39, v39, v14, s[40:41]
    v_pk_mul_f32 v[72:73], v[128:129], s[42:43]
    v_pk_mul_f32 v[74:75], v[130:131], s[42:43]
    v_pk_mul_f32 v[76:77], v[148:149], s[42:43]
    v_pk_mul_f32 v[78:79], v[150:151], s[42:43]
    v_exp_f32 v72, v72 clamp
    v_exp_f32 v73, v73 clamp
    v_exp_f32 v74, v74 clamp
    v_exp_f32 v75, v75 clamp
    v_exp_f32 v76, v76 clamp
    v_exp_f32 v77, v77 clamp
    v_exp_f32 v78, v78 clamp
    v_exp_f32 v79, v79 clamp
    v_max_f32 v128, s44, v128
    v_max_f32 v129, s44, v129
    v_max_f32 v130, s44, v130
    v_max_f32 v131, s44, v131
    v_max_f32 v148, s44, v148
    v_max_f32 v149, s44, v149
    v_max_f32 v150, s44, v150
    v_max_f32 v151, s44, v151
    v_pk_add_f32 v[128:129], v[128:129], v[72:73]
    v_pk_add_f32 v[130:131], v[130:131], v[74:75]
    v_pk_add_f32 v[148:149], v[148:149], v[76:77]
    v_pk_add_f32 v[150:151], v[150:151], v[78:79]
    v_cvt_pk_bf16_f32 v16, v128, v129
    v_cvt_pk_bf16_f32 v17, v130, v131
    v_cvt_pk_bf16_f32 v18, v148, v149
    v_cvt_pk_bf16_f32 v19, v150, v151
    v_pk_mul_f32 v[72:73], v[132:133], s[42:43]
    v_pk_mul_f32 v[74:75], v[134:135], s[42:43]
    v_pk_mul_f32 v[76:77], v[152:153], s[42:43]
    v_pk_mul_f32 v[78:79], v[154:155], s[42:43]
    v_exp_f32 v72, v72 clamp
    v_exp_f32 v73, v73 clamp
    v_exp_f32 v74, v74 clamp
    v_exp_f32 v75, v75 clamp
    v_exp_f32 v76, v76 clamp
    v_exp_f32 v77, v77 clamp
    v_exp_f32 v78, v78 clamp
    v_exp_f32 v79, v79 clamp
    v_max_f32 v132, s44, v132
    v_max_f32 v133, s44, v133
    v_max_f32 v134, s44, v134
    v_max_f32 v135, s44, v135
    v_max_f32 v152, s44, v152
    v_max_f32 v153, s44, v153
    v_max_f32 v154, s44, v154
    v_max_f32 v155, s44, v155
    v_pk_add_f32 v[132:133], v[132:133], v[72:73]
    v_pk_add_f32 v[134:135], v[134:135], v[74:75]
    v_pk_add_f32 v[152:153], v[152:153], v[76:77]
    v_pk_add_f32 v[154:155], v[154:155], v[78:79]
    v_cvt_pk_bf16_f32 v20, v132, v133
    v_cvt_pk_bf16_f32 v21, v134, v135
    v_cvt_pk_bf16_f32 v22, v152, v153
    v_cvt_pk_bf16_f32 v23, v154, v155
    v_pk_mul_f32 v[72:73], v[144:145], s[42:43]
    v_pk_mul_f32 v[74:75], v[146:147], s[42:43]
    v_pk_mul_f32 v[76:77], v[164:165], s[42:43]
    v_pk_mul_f32 v[78:79], v[166:167], s[42:43]
    v_exp_f32 v72, v72 clamp
    v_exp_f32 v73, v73 clamp
    v_exp_f32 v74, v74 clamp
    v_exp_f32 v75, v75 clamp
    v_exp_f32 v76, v76 clamp
    v_exp_f32 v77, v77 clamp
    v_exp_f32 v78, v78 clamp
    v_exp_f32 v79, v79 clamp
    v_max_f32 v144, s44, v144
    v_max_f32 v145, s44, v145
    v_max_f32 v146, s44, v146
    v_max_f32 v147, s44, v147
    v_max_f32 v164, s44, v164
    v_max_f32 v165, s44, v165
    v_max_f32 v166, s44, v166
    v_max_f32 v167, s44, v167
    v_pk_add_f32 v[144:145], v[144:145], v[72:73]
    v_pk_add_f32 v[146:147], v[146:147], v[74:75]
    v_pk_add_f32 v[164:165], v[164:165], v[76:77]
    v_pk_add_f32 v[166:167], v[166:167], v[78:79]
    v_cvt_pk_bf16_f32 v32, v144, v145
    v_cvt_pk_bf16_f32 v33, v146, v147
    v_cvt_pk_bf16_f32 v34, v164, v165
    v_cvt_pk_bf16_f32 v35, v166, v167
    v_mfma_f32_16x16x32_bf16 v[40:43], v[16:19], v[24:27], v[40:43]
    v_mfma_f32_16x16x32_bf16 v[44:47], v[20:23], v[28:31], v[44:47]
    v_mfma_f32_16x16x32_bf16 v[48:51], v[16:19], v[36:39], v[48:51]
    v_mfma_f32_16x16x32_bf16 v[52:55], v[20:23], v[36:39], v[52:55]
    v_mfma_f32_16x16x32_bf16 v[56:59], v[32:35], v[24:27], v[56:59]
    v_mfma_f32_16x16x32_bf16 v[60:63], v[32:35], v[28:31], v[60:63]
    v_mfma_f32_16x16x32_bf16 v[64:67], v[32:35], v[36:39], v[64:67]
    s_branch k1_kvend_72
k1_kv16_71:
    v_cvt_pk_bf16_f32 v24, v136, v137
    v_cvt_pk_bf16_f32 v25, v138, v139
    v_cvt_pk_bf16_f32 v28, v140, v141
    v_cvt_pk_bf16_f32 v29, v142, v143
    v_cvt_pk_bf16_f32 v36, v144, v145
    v_cvt_pk_bf16_f32 v37, v146, v147
    v_cndmask_b32 v36, v36, v14, s[40:41]
    v_cndmask_b32 v37, v37, v14, s[40:41]
    v_pk_mul_f32 v[72:73], v[128:129], s[42:43]
    v_pk_mul_f32 v[74:75], v[130:131], s[42:43]
    v_exp_f32 v72, v72 clamp
    v_exp_f32 v73, v73 clamp
    v_exp_f32 v74, v74 clamp
    v_exp_f32 v75, v75 clamp
    v_max_f32 v128, s44, v128
    v_max_f32 v129, s44, v129
    v_max_f32 v130, s44, v130
    v_max_f32 v131, s44, v131
    v_pk_add_f32 v[128:129], v[128:129], v[72:73]
    v_pk_add_f32 v[130:131], v[130:131], v[74:75]
    v_cvt_pk_bf16_f32 v16, v128, v129
    v_cvt_pk_bf16_f32 v17, v130, v131
    v_pk_mul_f32 v[72:73], v[132:133], s[42:43]
    v_pk_mul_f32 v[74:75], v[134:135], s[42:43]
    v_exp_f32 v72, v72 clamp
    v_exp_f32 v73, v73 clamp
    v_exp_f32 v74, v74 clamp
    v_exp_f32 v75, v75 clamp
    v_max_f32 v132, s44, v132
    v_max_f32 v133, s44, v133
    v_max_f32 v134, s44, v134
    v_max_f32 v135, s44, v135
    v_pk_add_f32 v[132:133], v[132:133], v[72:73]
    v_pk_add_f32 v[134:135], v[134:135], v[74:75]
    v_cvt_pk_bf16_f32 v20, v132, v133
    v_cvt_pk_bf16_f32 v21, v134, v135
    v_pk_mul_f32 v[72:73], v[144:145], s[42:43]
    v_pk_mul_f32 v[74:75], v[146:147], s[42:43]
    v_exp_f32 v72, v72 clamp
    v_exp_f32 v73, v73 clamp
    v_exp_f32 v74, v74 clamp
    v_exp_f32 v75, v75 clamp
    v_max_f32 v144, s44, v144
    v_max_f32 v145, s44, v145
    v_max_f32 v146, s44, v146
    v_max_f32 v147, s44, v147
    v_pk_add_f32 v[144:145], v[144:145], v[72:73]
    v_pk_add_f32 v[146:147], v[146:147], v[74:75]
    v_cvt_pk_bf16_f32 v32, v144, v145
    v_cvt_pk_bf16_f32 v33, v146, v147
    v_mfma_f32_16x16x16bf16_1k v[40:43], v[16:17], v[24:25], v[40:43]
    v_mfma_f32_16x16x16bf16_1k v[44:47], v[20:21], v[28:29], v[44:47]
    v_mfma_f32_16x16x16bf16_1k v[48:51], v[16:17], v[36:37], v[48:51]
    v_mfma_f32_16x16x16bf16_1k v[52:55], v[20:21], v[36:37], v[52:55]
    v_mfma_f32_16x16x16bf16_1k v[56:59], v[32:33], v[24:25], v[56:59]
    v_mfma_f32_16x16x16bf16_1k v[60:63], v[32:33], v[28:29], v[60:63]
    v_mfma_f32_16x16x16bf16_1k v[64:67], v[32:33], v[36:37], v[64:67]
    s_branch k1_kvend_72
k1_kvz_70:
    v_mov_b32 v40, 0
    v_mov_b32 v41, 0
    v_mov_b32 v42, 0
    v_mov_b32 v43, 0
    v_mov_b32 v44, 0
    v_mov_b32 v45, 0
    v_mov_b32 v46, 0
    v_mov_b32 v47, 0
    v_mov_b32 v48, 0
    v_mov_b32 v49, 0
    v_mov_b32 v50, 0
    v_mov_b32 v51, 0
    v_mov_b32 v52, 0
    v_mov_b32 v53, 0
    v_mov_b32 v54, 0
    v_mov_b32 v55, 0
    v_mov_b32 v56, 0
    v_mov_b32 v57, 0
    v_mov_b32 v58, 0
    v_mov_b32 v59, 0
    v_mov_b32 v60, 0
    v_mov_b32 v61, 0
    v_mov_b32 v62, 0
    v_mov_b32 v63, 0
    v_mov_b32 v64, 0
    v_mov_b32 v65, 0
    v_mov_b32 v66, 0
    v_mov_b32 v67, 0
k1_kvend_72:
    s_mul_i32 s45, s22, 7168
    s_add_u32 s45, s45, 94208
    v_lshlrev_b32 v12, 4, v1
    v_add_u32 v12, s45, v12
    ds_write_b128 v12, v[40:43] offset:0
    ds_write_b128 v12, v[44:47] offset:1024
    ds_write_b128 v12, v[48:51] offset:2048
    ds_write_b128 v12, v[52:55] offset:3072
    ds_write_b128 v12, v[56:59] offset:4096
    ds_write_b128 v12, v[60:63] offset:5120
    ds_write_b128 v12, v[64:67] offset:6144
    s_cmp_ge_u32 s22, 6
    s_cselect_b32 s54, 1, 0
    s_mul_i32 s55, s54, 6
    s_sub_u32 s55, s22, s55
    s_cmp_ge_u32 s55, 3
    s_cselect_b32 s45, 1, 0
    s_mul_i32 s46, s45, 3
    s_sub_u32 s46, s55, s46
    v_lshrrev_b32 v13, 5, v1
    v_and_b32 v14, 31, v1
    s_lshl_b32 s47, s46, 1
    v_add_u32 v13, s47, v13
    v_mov_b32 v15, s45
    s_cmp_eq_u32 s46, 2
    s_cselect_b64 s[48:49], -1, 0
    v_cndmask_b32 v13, v13, v15, s[48:49]
    s_add_u32 s50, s45, 4
    s_add_u32 s51, s45, 2
    s_cmp_eq_u32 s46, 2
    s_cselect_b32 s50, s50, s45
    s_cselect_b32 s51, 6, s51
    v_mov_b32 v15, s51
    v_mov_b32 v9, s50
    v_cmp_gt_u32 s[52:53], 16, v14
    s_nop 1
    v_cndmask_b32 v15, v15, v9, s[52:53]
    s_lshl_b32 s56, s45, 2
    s_sub_u32 s56, s56, 8
    v_add_u32 v8, s56, v14
    v_cmp_gt_u32 s[58:59], 20, v14
    s_nop 1
    v_cndmask_b32 v8, 0, v8, s[58:59]
    v_cndmask_b32 v8, v8, v14, s[52:53]
    v_lshl_add_u32 v8, v13, 4, v8
    v_lshlrev_b32 v8, 4, v8
    v_lshl_add_u32 v8, v15, 10, v8
    s_mul_i32 s57, s54, 7168
    s_add_u32 s57, s57, 94208
    v_add_u32 v8, s57, v8
    s_lshl_b32 s55, s21, 2
    s_lshl_b32 s57, s54, 1
    s_add_u32 s55, s55, s57
    s_add_u32 s55, s55, s45
    s_mul_i32 s55, s55, 10
    s_add_u32 s55, s55, s20
    s_mul_i32 s55, s55, 3
    s_add_u32 s55, s55, s46
    s_lshl_b32 s55, s55, 10
    s_add_u32 s55, s55, 15728640
    v_lshlrev_b32 v9, 4, v1
    v_add_u32 v9, s55, v9
    s_cmp_ge_u32 s22, 4
    s_cbranch_scc1 k1_kv1_73
    s_add_u32 s60, s22, 8
    s_cmp_ge_u32 s60, 6
    s_cselect_b32 s54, 1, 0
    s_mul_i32 s55, s54, 6
    s_sub_u32 s55, s60, s55
    s_cmp_ge_u32 s55, 3
    s_cselect_b32 s45, 1, 0
    s_mul_i32 s46, s45, 3
    s_sub_u32 s46, s55, s46
    v_lshrrev_b32 v13, 5, v1
    v_and_b32 v14, 31, v1
    s_lshl_b32 s47, s46, 1
    v_add_u32 v13, s47, v13
    v_mov_b32 v15, s45
    s_cmp_eq_u32 s46, 2
    s_cselect_b64 s[48:49], -1, 0
    v_cndmask_b32 v13, v13, v15, s[48:49]
    s_add_u32 s50, s45, 4
    s_add_u32 s51, s45, 2
    s_cmp_eq_u32 s46, 2
    s_cselect_b32 s50, s50, s45
    s_cselect_b32 s51, 6, s51
    v_mov_b32 v15, s51
    v_mov_b32 v11, s50
    v_cmp_gt_u32 s[52:53], 16, v14
    s_nop 1
    v_cndmask_b32 v15, v15, v11, s[52:53]
    s_lshl_b32 s56, s45, 2
    s_sub_u32 s56, s56, 8
    v_add_u32 v10, s56, v14
    v_cmp_gt_u32 s[58:59], 20, v14
    s_nop 1
    v_cndmask_b32 v10, 0, v10, s[58:59]
    v_cndmask_b32 v10, v10, v14, s[52:53]
    v_lshl_add_u32 v10, v13, 4, v10
    v_lshlrev_b32 v10, 4, v10
    v_lshl_add_u32 v10, v15, 10, v10
    s_mul_i32 s57, s54, 7168
    s_add_u32 s57, s57, 94208
    v_add_u32 v10, s57, v10
    s_lshl_b32 s55, s21, 2
    s_lshl_b32 s57, s54, 1
    s_add_u32 s55, s55, s57
    s_add_u32 s55, s55, s45
    s_mul_i32 s55, s55, 10
    s_add_u32 s55, s55, s20
    s_mul_i32 s55, s55, 3
    s_add_u32 s55, s55, s46
    s_lshl_b32 s55, s55, 10
    s_add_u32 s55, s55, 15728640
    v_lshlrev_b32 v11, 4, v1
    v_add_u32 v11, s55, v11
    s_waitcnt lgkmcnt(0)
    s_barrier
    ds_read_b128 v[16:19], v8 offset:0
    ds_read_b128 v[20:23], v8 offset:14336
    ds_read_b128 v[24:27], v8 offset:28672
    ds_read_b128 v[28:31], v8 offset:43008
    ds_read_b128 v[32:35], v10 offset:0
    ds_read_b128 v[36:39], v10 offset:14336
    ds_read_b128 v[40:43], v10 offset:28672
    ds_read_b128 v[44:47], v10 offset:43008
    s_waitcnt lgkmcnt(6)
    v_add_f32 v16, v16, v20
    v_add_f32 v17, v17, v21
    v_add_f32 v18, v18, v22
    v_add_f32 v19, v19, v23
    s_waitcnt lgkmcnt(5)
    v_add_f32 v16, v16, v24
    v_add_f32 v17, v17, v25
    v_add_f32 v18, v18, v26
    v_add_f32 v19, v19, v27
    s_waitcnt lgkmcnt(4)
    v_add_f32 v16, v16, v28
    v_add_f32 v17, v17, v29
    v_add_f32 v18, v18, v30
    v_add_f32 v19, v19, v31
    buffer_store_dwordx4 v[16:19], v9, s[16:19], 0 offen sc1
    s_waitcnt lgkmcnt(2)
    v_add_f32 v32, v32, v36
    v_add_f32 v33, v33, v37
    v_add_f32 v34, v34, v38
    v_add_f32 v35, v35, v39
    s_waitcnt lgkmcnt(1)
    v_add_f32 v32, v32, v40
    v_add_f32 v33, v33, v41
    v_add_f32 v34, v34, v42
    v_add_f32 v35, v35, v43
    s_waitcnt lgkmcnt(0)
    v_add_f32 v32, v32, v44
    v_add_f32 v33, v33, v45
    v_add_f32 v34, v34, v46
    v_add_f32 v35, v35, v47
    buffer_store_dwordx4 v[32:35], v11, s[16:19], 0 offen sc1
    s_branch k1_kv2_74
k1_kv1_73:
    s_waitcnt lgkmcnt(0)
    s_barrier
    ds_read_b128 v[16:19], v8 offset:0
    ds_read_b128 v[20:23], v8 offset:14336
    ds_read_b128 v[24:27], v8 offset:28672
    ds_read_b128 v[28:31], v8 offset:43008
    s_waitcnt lgkmcnt(2)
    v_add_f32 v16, v16, v20
    v_add_f32 v17, v17, v21
    v_add_f32 v18, v18, v22
    v_add_f32 v19, v19, v23
    s_waitcnt lgkmcnt(1)
    v_add_f32 v16, v16, v24
    v_add_f32 v17, v17, v25
    v_add_f32 v18, v18, v26
    v_add_f32 v19, v19, v27
    s_waitcnt lgkmcnt(0)
    v_add_f32 v16, v16, v28
    v_add_f32 v17, v17, v29
    v_add_f32 v18, v18, v30
    v_add_f32 v19, v19, v31
    buffer_store_dwordx4 v[16:19], v9, s[16:19], 0 offen sc1
k1_kv2_74:
k1_done_35:
    s_load_dwordx4 s[88:91], s[0:1], 40
    s_load_dwordx2 s[86:87], s[0:1], 16
    s_waitcnt vmcnt(0)
    s_barrier
    s_cmp_lg_u32 s22, 0
    s_cbranch_scc1 k1_nf1_75
    s_lshl_b32 s23, s2, 7
    s_add_u32 s23, s23, 16777216
    v_mov_b32 v14, s23
    v_mov_b32 v15, 1
    s_mov_b64 exec, 1
    buffer_store_dword v15, v14, s[16:19], 0 offen sc1
    s_mov_b64 exec, -1
k1_nf1_75:
    s_branch phase2_1
k1_spare_8:
    s_lshl_b32 s23, s22, 6
    v_add_u32 v7, s23, v1
    s_cmp_lg_u32 s22, 0
    s_cbranch_scc1 k1_spare_nt_76
    s_and_b32 s23, s3, 1
    s_lshl_b32 s23, s23, 10
    s_mul_i32 s24, s30, s54
    s_add_u32 s23, s23, s24
    v_add_u32 v13, s23, v1
    v_mul_u32_u24 v13, 1280, v13
    v_mov_b32 v14, 0x7f000000
    v_cmp_gt_u32 s[48:49], s54, v1
    s_nop 1
    v_cndmask_b32 v2, v14, v13, s[48:49]
    v_cmp_gt_u32 s[48:49], 32, v1
    v_and_b32 v15, 15, v1
    v_add_u32 v13, s50, v15
    v_mov_b32 v16, s52
    v_cmp_le_u32 s[36:37], s51, v15
    s_nop 1
    v_cndmask_b32 v16, 0, v16, s[36:37]
    v_cmp_le_u32 s[36:37], s53, v15
    s_nop 1
    v_cndmask_b32 v17, 0, 5, s[36:37]
    v_add3_u32 v13, v13, v16, v17
    v_lshlrev_b32 v13, 7, v13
    v_bfe_u32 v15, v1, 4, 1
    s_lshl_b32 s24, s30, 1
    v_add_u32 v15, s24, v15
    v_mul_u32_u24 v15, 3840, v15
    v_add_u32 v13, v13, v15
    v_cndmask_b32 v3, v13, v14, s[48:49]
    buffer_load_dword v8, v2, s[8:11], 0 offen offset:0
    s_mov_b32 s35, 0
    buffer_load_dword v9, v3, s[12:15], s35 offen
    buffer_load_dword v10, v2, s[8:11], 0 offen offset:128
    s_mov_b32 s35, 245760
    buffer_load_dword v11, v3, s[12:15], s35 offen
    s_waitcnt vmcnt(2)
    buffer_load_dword v8, v2, s[8:11], 0 offen offset:256
    s_mov_b32 s35, 491520
    buffer_load_dword v9, v3, s[12:15], s35 offen
    s_waitcnt vmcnt(2)
    buffer_load_dword v10, v2, s[8:11], 0 offen offset:384
    s_mov_b32 s35, 737280
    buffer_load_dword v11, v3, s[12:15], s35 offen
    s_waitcnt vmcnt(2)
    buffer_load_dword v8, v2, s[8:11], 0 offen offset:512
    s_mov_b32 s35, 983040
    buffer_load_dword v9, v3, s[12:15], s35 offen
    s_waitcnt vmcnt(2)
    buffer_load_dword v10, v2, s[8:11], 0 offen offset:640
    s_mov_b32 s35, 1228800
    buffer_load_dword v11, v3, s[12:15], s35 offen
    s_waitcnt vmcnt(2)
    buffer_load_dword v8, v2, s[8:11], 0 offen offset:768
    s_mov_b32 s35, 1474560
    buffer_load_dword v9, v3, s[12:15], s35 offen
    s_waitcnt vmcnt(2)
    buffer_load_dword v10, v2, s[8:11], 0 offen offset:896
    s_mov_b32 s35, 1720320
    buffer_load_dword v11, v3, s[12:15], s35 offen
    s_waitcnt vmcnt(2)
    buffer_load_dword v8, v2, s[8:11], 0 offen offset:1024
    s_mov_b32 s35, 1966080
    buffer_load_dword v9, v3, s[12:15], s35 offen
    s_waitcnt vmcnt(2)
    buffer_load_dword v10, v2, s[8:11], 0 offen offset:1152
    s_mov_b32 s35, 2211840
    buffer_load_dword v11, v3, s[12:15], s35 offen
    s_waitcnt vmcnt(0)
k1_spare_nt_76:
    s_barrier
    s_load_dwordx2 s[48:49], s[0:1], 16
    s_load_dwordx2 s[50:51], s[0:1], 40
    s_and_b32 s20, s3, 1
    s_and_b32 s21, s30, 3
    s_lshl_b32 s21, s21, 1
    s_add_u32 s20, s20, s21
    s_mul_i32 s20, s20, 102400
    v_lshlrev_b32 v2, 7, v7
    v_add_u32 v2, s20, v2
    s_waitcnt lgkmcnt(0)
    s_cmp_eq_u32 s31, 0
    s_cselect_b32 s4, s48, s50
    s_cselect_b32 s5, s49, s51
    s_mov_b32 s8, s4
    s_mov_b32 s9, s5
    s_mov_b32 s10, 819200
    s_mov_b32 s11, 0x20000
    buffer_load_dword v4, v2, s[8:11], 0 offen
    s_mov_b32 s21, 73728
    v_cmp_gt_u32 vcc, 224, v7
    s_nop 1
    s_and_saveexec_b64 s[52:53], vcc
    s_cbranch_execz k1_pfz_78
    buffer_load_dword v5, v2, s[8:11], s21 offen
k1_pfz_78:
    s_mov_b64 exec, -1
    s_waitcnt vmcnt(0)
k1_nopf_77:
    s_cmp_lg_u32 s22, 8
    s_cbranch_scc1 k1_cnt0_79
    v_and_b32 v14, 7, v1
    v_lshlrev_b32 v14, 5, v14
    s_mov_b32 s24, 0
k1_cntp_80:
    buffer_load_dword v15, v14, s[96:99], 0 offen sc1
    s_add_u32 s24, s24, 1
    s_waitcnt vmcnt(0)
    v_cmp_gt_u32 s[46:47], 32, v15
    s_nop 1
    s_cmp_eq_u64 s[46:47], 0
    s_cbranch_scc1 k1_cntok_81
    s_sleep 4
    s_cmp_lt_u32 s24, 0x8000
    s_cbranch_scc1 k1_cntp_80
k1_cntok_81:
k1_cnt0_79:
    s_load_dwordx4 s[88:91], s[0:1], 40
    s_load_dwordx2 s[86:87], s[0:1], 16
    s_barrier
    s_branch phase2_1
k1_end_2:
    s_endpgm
phase2_1:
    s_and_b32 s3, s2, 7
    s_lshr_b32 s30, s2, 3
    s_lshr_b32 s62, s3, 2
    s_and_b32 s63, s3, 3
    s_lshl_b32 s63, s63, 2
    s_and_b32 s23, s30, 3
    s_add_u32 s63, s63, s23
    s_lshr_b32 s72, s30, 2
    s_mov_b32 s3, s2
    s_and_b32 s20, s3, 7
    s_lshr_b32 s23, s3, 6
    s_lshl_b32 s23, s23, 3
    s_add_u32 s20, s20, s23
    s_lshr_b32 s21, s3, 3
    s_and_b32 s21, s21, 7
    s_lshl_b32 s24, s20, 6
    s_lshl_b32 s23, s21, 3
    s_add_u32 s24, s24, s23
    s_cmp_eq_u32 s21, 0
    s_cselect_b32 s23, 0, 8
    s_sub_u32 s25, s24, s23
    s_add_u32 s26, s24, s22
    v_lshlrev_b32 v8, 4, v1
    v_lshrrev_b32 v11, 5, v1
    v_and_b32 v12, 31, v1
    s_mul_i32 s36, s26, 1280
    v_and_b32 v13, 15, v1
    v_lshlrev_b32 v13, 4, v13
    v_add_u32 v13, s36, v13
    v_bfe_u32 v14, v1, 4, 1
    v_lshl_add_u32 v9, v14, 3, v13
    v_lshl_add_u32 v13, v14, 9, v13
    v_lshl_add_u32 v10, v11, 8, v13
    s_waitcnt lgkmcnt(0)
    s_cmp_eq_u32 s62, 0
    s_cselect_b32 s4, s86, s88
    s_cselect_b32 s5, s87, s89
    s_mov_b32 s8, s4
    s_mov_b32 s9, s5
    s_mov_b32 s10, 819200
    s_mov_b32 s11, 0x20000
    s_mov_b32 s12, s90
    s_mov_b32 s13, s91
    s_mov_b32 s14, 5242880
    s_mov_b32 s15, 0x20000
    s_mul_i32 s73, s72, 160
    s_cmp_lt_u32 s22, 8
    s_cbranch_scc1 k23_attn_83
    s_sub_u32 s82, s22, 8
    s_mul_i32 s30, s25, 1280
    s_mul_i32 s31, s24, 1280
    s_bitcmp1_b32 s82, 0
    s_cselect_b32 s34, s31, s30
    s_mov_b32 s35, 2621440
    s_mov_b32 s37, 5242880
    s_cmp_ge_u32 s82, 2
    s_cselect_b32 s35, s37, s35
    s_add_u32 s34, s34, s35
    s_mul_i32 s33, s82, 10240
    s_cmp_lg_u32 s82, 0
    s_cbranch_scc1 k23_hnp0_84
    s_mul_i32 s40, s20, 20
    s_lshr_b32 s41, s40, 7
    s_add_u32 s40, s40, 19
    s_lshr_b32 s40, s40, 7
    s_sub_u32 s42, s21, 1
    s_max_i32 s42, s42, 0
    v_min_u32 v2, 9, v1
    v_and_b32 v3, 1, v2
    v_lshrrev_b32 v2, 1, v2
    v_mov_b32 v4, s41
    v_mov_b32 v5, s40
    v_cmp_eq_u32 s[46:47], 1, v3
    s_nop 1
    v_cndmask_b32 v4, v4, v5, s[46:47]
    v_mov_b32 v5, s21
    v_mov_b32 v6, s42
    v_cmp_eq_u32 s[46:47], 2, v2
    v_cmp_eq_u32 s[48:49], 4, v2
    s_nop 1
    s_or_b64 s[46:47], s[46:47], s[48:49]
    v_cndmask_b32 v5, v5, v6, s[46:47]
    v_add_u32 v6, 1, v2
    v_lshrrev_b32 v6, 1, v6
    v_mul_u32_u24 v6, 5, v6
    v_add_u32 v6, v6, v4
    v_lshrrev_b32 v7, 2, v5
    v_and_b32 v14, 3, v5
    v_lshrrev_b32 v15, 3, v6
    v_lshl_add_u32 v15, v15, 1, v7
    v_add_u32 v15, 4, v15
    v_and_b32 v6, 7, v6
    v_lshl_add_u32 v6, v6, 2, v14
    v_lshl_add_u32 v6, v6, 3, v15
    v_cmp_le_u32 s[48:49], 3, v4
    s_nop 1
    v_cndmask_b32 v15, 0, 1, s[48:49]
    v_mul_u32_u24 v3, 3, v15
    v_sub_u32 v3, v4, v3
    v_lshl_add_u32 v3, v3, 2, v14
    v_lshl_add_u32 v15, v15, 1, v7
    v_lshl_add_u32 v3, v3, 3, v15
    v_cmp_eq_u32 s[48:49], 5, v2
    s_nop 1
    v_cndmask_b32 v6, v6, v3, s[48:49]
    v_lshlrev_b32 v6, 7, v6
    v_add_u32 v6, 16777216, v6
    s_mov_b32 s44, 0
k23_hpoll_85:
    buffer_load_dword v15, v6, s[16:19], 0 offen sc1
    s_add_u32 s44, s44, 1
    s_waitcnt vmcnt(0)
    v_cmp_ne_u32 s[46:47], 1, v15
    s_nop 1
    s_cmp_eq_u64 s[46:47], 0
    s_cbranch_scc1 k23_hpok_86
    s_sleep 8
    s_cmp_lt_u32 s44, 0x8000
    s_cbranch_scc1 k23_hpoll_85
k23_hpok_86:
k23_hnp0_84:
    s_barrier
    buffer_load_dwordx4 v[32:35], v8, s[16:19], s34 offen sc1
    s_add_u32 s34, s34, 1024
    buffer_load_dwordx4 v[36:39], v8, s[16:19], s34 offen sc1
    s_add_u32 s34, s34, 1024
    buffer_load_dwordx4 v[40:43], v8, s[16:19], s34 offen sc1
    s_add_u32 s34, s34, 1024
    buffer_load_dwordx4 v[44:47], v8, s[16:19], s34 offen sc1
    s_add_u32 s34, s34, 1024
    buffer_load_dwordx4 v[48:51], v8, s[16:19], s34 offen sc1
    s_add_u32 s34, s34, 1024
    buffer_load_dwordx4 v[52:55], v8, s[16:19], s34 offen sc1
    s_add_u32 s34, s34, 1024
    buffer_load_dwordx4 v[56:59], v8, s[16:19], s34 offen sc1
    s_add_u32 s34, s34, 1024
    buffer_load_dwordx4 v[60:63], v8, s[16:19], s34 offen sc1
    s_add_u32 s34, s34, 1024
    buffer_load_dwordx4 v[64:67], v8, s[16:19], s34 offen sc1
    s_add_u32 s34, s34, 1024
    buffer_load_dwordx4 v[68:71], v8, s[16:19], s34 offen sc1
    v_add_u32 v14, s33, v8
    s_cmp_lg_u32 s82, 0
    s_cbranch_scc1 k23_hz_87
    v_mov_b32 v72, 0
    v_mov_b32 v73, 0
    v_mov_b32 v74, 0
    v_mov_b32 v75, 0
    v_mov_b32 v15, 42496
    ds_write_b128 v15, v[72:75]
    ds_write_b128 v15, v[72:75] offset:16
k23_hz_87:
    s_cmp_eq_u32 s62, 0
    s_cselect_b32 s74, 8, 4
    s_cselect_b32 s75, 4, 20
    v_add_u32 v2, 0, v1
    v_mul_u32_u24 v3, 6554, v2
    v_lshrrev_b32 v3, 16, v3
    v_mul_u32_u24 v4, 10, v3
    v_sub_u32 v4, v2, v4
    v_lshlrev_b32 v4, 4, v4
    v_add_u32 v4, s73, v4
    v_lshrrev_b32 v5, 4, v3
    v_mul_u32_u24 v6, s74, v5
    v_add_u32 v6, v6, v3
    v_mul_u32_u24 v6, 1280, v6
    v_add_u32 v16, v6, v4
    v_lshlrev_b32 v5, 1, v5
    v_bfe_u32 v6, v3, 2, 1
    v_add_u32 v5, v5, v6
    v_mul_u32_u24 v5, 40, v5
    v_bfe_u32 v6, v3, 3, 1
    v_mul_u32_u24 v6, s75, v6
    v_add_u32 v5, v5, v6
    v_and_b32 v6, 3, v3
    v_add3_u32 v5, v5, v6, 16
    v_mul_u32_u24 v5, 1280, v5
    v_add_u32 v21, v5, v4
    v_add_u32 v2, 64, v1
    v_mul_u32_u24 v3, 6554, v2
    v_lshrrev_b32 v3, 16, v3
    v_mul_u32_u24 v4, 10, v3
    v_sub_u32 v4, v2, v4
    v_lshlrev_b32 v4, 4, v4
    v_add_u32 v4, s73, v4
    v_lshrrev_b32 v5, 4, v3
    v_mul_u32_u24 v6, s74, v5
    v_add_u32 v6, v6, v3
    v_mul_u32_u24 v6, 1280, v6
    v_add_u32 v17, v6, v4
    v_lshlrev_b32 v5, 1, v5
    v_bfe_u32 v6, v3, 2, 1
    v_add_u32 v5, v5, v6
    v_mul_u32_u24 v5, 40, v5
    v_bfe_u32 v6, v3, 3, 1
    v_mul_u32_u24 v6, s75, v6
    v_add_u32 v5, v5, v6
    v_and_b32 v6, 3, v3
    v_add3_u32 v5, v5, v6, 16
    v_mul_u32_u24 v5, 1280, v5
    v_add_u32 v22, v5, v4
    v_add_u32 v2, 128, v1
    v_mul_u32_u24 v3, 6554, v2
    v_lshrrev_b32 v3, 16, v3
    v_mul_u32_u24 v4, 10, v3
    v_sub_u32 v4, v2, v4
    v_lshlrev_b32 v4, 4, v4
    v_add_u32 v4, s73, v4
    v_lshrrev_b32 v5, 4, v3
    v_mul_u32_u24 v6, s74, v5
    v_add_u32 v6, v6, v3
    v_mul_u32_u24 v6, 1280, v6
    v_add_u32 v18, v6, v4
    v_lshlrev_b32 v5, 1, v5
    v_bfe_u32 v6, v3, 2, 1
    v_add_u32 v5, v5, v6
    v_mul_u32_u24 v5, 40, v5
    v_bfe_u32 v6, v3, 3, 1
    v_mul_u32_u24 v6, s75, v6
    v_add_u32 v5, v5, v6
    v_and_b32 v6, 3, v3
    v_add3_u32 v5, v5, v6, 16
    v_mul_u32_u24 v5, 1280, v5
    v_add_u32 v23, v5, v4
    v_add_u32 v2, 192, v1
    v_mul_u32_u24 v3, 6554, v2
    v_lshrrev_b32 v3, 16, v3
    v_mul_u32_u24 v4, 10, v3
    v_sub_u32 v4, v2, v4
    v_lshlrev_b32 v4, 4, v4
    v_add_u32 v4, s73, v4
    v_lshrrev_b32 v5, 4, v3
    v_mul_u32_u24 v6, s74, v5
    v_add_u32 v6, v6, v3
    v_mul_u32_u24 v6, 1280, v6
    v_add_u32 v19, v6, v4
    v_lshlrev_b32 v5, 1, v5
    v_bfe_u32 v6, v3, 2, 1
    v_add_u32 v5, v5, v6
    v_mul_u32_u24 v5, 40, v5
    v_bfe_u32 v6, v3, 3, 1
    v_mul_u32_u24 v6, s75, v6
    v_add_u32 v5, v5, v6
    v_and_b32 v6, 3, v3
    v_add3_u32 v5, v5, v6, 16
    v_mul_u32_u24 v5, 1280, v5
    v_add_u32 v24, v5, v4
    v_add_u32 v2, 256, v1
    v_mul_u32_u24 v3, 6554, v2
    v_lshrrev_b32 v3, 16, v3
    v_mul_u32_u24 v4, 10, v3
    v_sub_u32 v4, v2, v4
    v_lshlrev_b32 v4, 4, v4
    v_add_u32 v4, s73, v4
    v_lshrrev_b32 v5, 4, v3
    v_mul_u32_u24 v6, s74, v5
    v_add_u32 v6, v6, v3
    v_mul_u32_u24 v6, 1280, v6
    v_add_u32 v20, v6, v4
    v_lshlrev_b32 v5, 1, v5
    v_bfe_u32 v6, v3, 2, 1
    v_add_u32 v5, v5, v6
    v_mul_u32_u24 v5, 40, v5
    v_bfe_u32 v6, v3, 3, 1
    v_mul_u32_u24 v6, s75, v6
    v_add_u32 v5, v5, v6
    v_and_b32 v6, 3, v3
    v_add3_u32 v5, v5, v6, 16
    v_mul_u32_u24 v5, 1280, v5
    v_add_u32 v25, v5, v4
    s_waitcnt vmcnt(9)
    ds_write_b128 v14, v[32:35] offset:0
    s_waitcnt vmcnt(8)
    ds_write_b128 v14, v[36:39] offset:1024
    s_waitcnt vmcnt(7)
    ds_write_b128 v14, v[40:43] offset:2048
    s_waitcnt vmcnt(6)
    ds_write_b128 v14, v[44:47] offset:3072
    s_waitcnt vmcnt(5)
    ds_write_b128 v14, v[48:51] offset:4096
    s_waitcnt vmcnt(4)
    ds_write_b128 v14, v[52:55] offset:5120
    s_waitcnt vmcnt(3)
    ds_write_b128 v14, v[56:59] offset:6144
    s_waitcnt vmcnt(2)
    ds_write_b128 v14, v[60:63] offset:7168
    s_waitcnt vmcnt(1)
    ds_write_b128 v14, v[64:67] offset:8192
    s_waitcnt vmcnt(0)
    ds_write_b128 v14, v[68:71] offset:9216
    s_waitcnt vmcnt(0) lgkmcnt(0)
    s_barrier
    s_cmp_ge_u32 s82, 3
    s_cbranch_scc1 k23_nokv_88
    s_mul_i32 s40, s20, 30
    s_add_u32 s40, s40, s82
    s_lshl_b32 s40, s40, 10
    s_add_u32 s40, s40, 15728640
    s_lshr_b32 s41, s20, 2
    s_lshr_b32 s42, s41, 2
    s_and_b32 s41, s41, 3
    s_mul_i32 s41, s41, 5
    s_lshl_b32 s43, s42, 2
    s_sub_u32 s41, s41, s43
    s_add_u32 s41, s41, 12
    s_lshl_b32 s42, s42, 1
    v_min_u32 v2, 9, v1
    v_cmp_le_u32 s[46:47], 5, v2
    s_nop 1
    v_cndmask_b32 v3, 0, 1, s[46:47]
    v_mul_u32_u24 v4, 5, v3
    v_sub_u32 v4, v2, v4
    v_add_u32 v4, s41, v4
    v_add_u32 v3, s42, v3
    v_lshl_add_u32 v4, v4, 3, v3
    v_lshlrev_b32 v4, 7, v4
    v_add_u32 v4, 16777216, v4
    s_mov_b32 s44, 0
k23_hpoll_89:
    buffer_load_dword v15, v4, s[16:19], 0 offen sc1
    s_add_u32 s44, s44, 1
    s_waitcnt vmcnt(0)
    v_cmp_ne_u32 s[46:47], 1, v15
    s_nop 1
    s_cmp_eq_u64 s[46:47], 0
    s_cbranch_scc1 k23_hpok_90
    s_sleep 8
    s_cmp_lt_u32 s44, 0x8000
    s_cbranch_scc1 k23_hpoll_89
k23_hpok_90:
    buffer_load_dwordx4 v[32:35], v8, s[16:19], s40 offen sc1
    s_add_u32 s40, s40, 3072
    buffer_load_dwordx4 v[36:39], v8, s[16:19], s40 offen sc1
    s_add_u32 s40, s40, 3072
    buffer_load_dwordx4 v[40:43], v8, s[16:19], s40 offen sc1
    s_add_u32 s40, s40, 3072
    buffer_load_dwordx4 v[44:47], v8, s[16:19], s40 offen sc1
    s_add_u32 s40, s40, 3072
    buffer_load_dwordx4 v[48:51], v8, s[16:19], s40 offen sc1
    s_add_u32 s40, s40, 3072
    buffer_load_dwordx4 v[52:55], v8, s[16:19], s40 offen sc1
    s_add_u32 s40, s40, 3072
    buffer_load_dwordx4 v[56:59], v8, s[16:19], s40 offen sc1
    s_add_u32 s40, s40, 3072
    buffer_load_dwordx4 v[60:63], v8, s[16:19], s40 offen sc1
    s_add_u32 s40, s40, 3072
    buffer_load_dwordx4 v[64:67], v8, s[16:19], s40 offen sc1
    s_add_u32 s40, s40, 3072
    buffer_load_dwordx4 v[68:71], v8, s[16:19], s40 offen sc1
    s_waitcnt vmcnt(8)
    v_add_f32 v32, v32, v36
    v_add_f32 v33, v33, v37
    v_add_f32 v34, v34, v38
    v_add_f32 v35, v35, v39
    s_waitcnt vmcnt(7)
    v_add_f32 v32, v32, v40
    v_add_f32 v33, v33, v41
    v_add_f32 v34, v34, v42
    v_add_f32 v35, v35, v43
    s_waitcnt vmcnt(6)
    v_add_f32 v32, v32, v44
    v_add_f32 v33, v33, v45
    v_add_f32 v34, v34, v46
    v_add_f32 v35, v35, v47
    s_waitcnt vmcnt(5)
    v_add_f32 v32, v32, v48
    v_add_f32 v33, v33, v49
    v_add_f32 v34, v34, v50
    v_add_f32 v35, v35, v51
    s_waitcnt vmcnt(4)
    v_add_f32 v32, v32, v52
    v_add_f32 v33, v33, v53
    v_add_f32 v34, v34, v54
    v_add_f32 v35, v35, v55
    s_waitcnt vmcnt(3)
    v_add_f32 v32, v32, v56
    v_add_f32 v33, v33, v57
    v_add_f32 v34, v34, v58
    v_add_f32 v35, v35, v59
    s_waitcnt vmcnt(2)
    v_add_f32 v32, v32, v60
    v_add_f32 v33, v33, v61
    v_add_f32 v34, v34, v62
    v_add_f32 v35, v35, v63
    s_waitcnt vmcnt(1)
    v_add_f32 v32, v32, v64
    v_add_f32 v33, v33, v65
    v_add_f32 v34, v34, v66
    v_add_f32 v35, v35, v67
    s_waitcnt vmcnt(0)
    v_add_f32 v32, v32, v68
    v_add_f32 v33, v33, v69
    v_add_f32 v34, v34, v70
    v_add_f32 v35, v35, v71
    v_cvt_pk_bf16_f32 v32, v32, v33
    v_cvt_pk_bf16_f32 v33, v34, v35
    s_lshl_b32 s41, s82, 3
    s_add_u32 s41, s41, 40960
    v_add_u32 v14, s41, v8
    v_lshlrev_b32 v15, 3, v1
    v_add_u32 v15, 41984, v15
    s_cmp_eq_u32 s82, 2
    s_cselect_b64 s[46:47], -1, 0
    v_cndmask_b32 v14, v14, v15, s[46:47]
    ds_write_b64 v14, v[32:33]
    s_lshl_b32 s41, s82, 2
    s_add_u32 s41, s41, 42496
    v_mov_b32 v14, s41
    v_mov_b32 v15, 1
    s_waitcnt lgkmcnt(0)
    ds_write_b32 v14, v15
k23_nokv_88:
    s_cmp_lg_u32 s82, 3
    s_cbranch_scc1 k23_hna_91
    s_mul_i32 s40, s20, 20
    s_lshr_b32 s41, s40, 7
    s_add_u32 s40, s40, 19
    s_lshr_b32 s40, s40, 7
    v_mov_b32 v4, s41
    v_mov_b32 v5, s40
    v_cmp_eq_u32 s[46:47], 0, v1
    s_nop 1
    v_cndmask_b32 v4, v5, v4, s[46:47]
    v_cmp_le_u32 s[48:49], 3, v4
    s_nop 1
    v_cndmask_b32 v5, 0, 1, s[48:49]
    v_mul_u32_u24 v3, 3, v5
    v_sub_u32 v3, v4, v3
    s_and_b32 s42, s21, 3
    s_lshr_b32 s43, s21, 2
    v_lshlrev_b32 v3, 2, v3
    v_add_u32 v3, s42, v3
    v_lshlrev_b32 v5, 1, v5
    v_add_u32 v5, s43, v5
    v_lshl_add_u32 v3, v3, 3, v5
    v_lshlrev_b32 v3, 7, v3
    v_add_u32 v3, 16777216, v3
    s_mov_b32 s44, 0
k23_hpoll_92:
    buffer_load_dword v15, v3, s[16:19], 0 offen sc1
    s_add_u32 s44, s44, 1
    s_waitcnt vmcnt(0)
    v_cmp_ne_u32 s[46:47], 1, v15
    s_nop 1
    s_cmp_eq_u64 s[46:47], 0
    s_cbranch_scc1 k23_hpok_93
    s_sleep 8
    s_cmp_lt_u32 s44, 0x8000
    s_cbranch_scc1 k23_hpoll_92
k23_hpok_93:
    v_mov_b32 v14, 42512
    v_mov_b32 v15, 1
    ds_write_b32 v14, v15
k23_hna_91:
    s_mul_i32 s76, s82, 51200
    s_mul_i32 s78, s82, 204800
    s_mul_i32 s79, s82, 5120
    s_add_u32 s79, s79, 43008
    s_add_u32 m0, s79, 0
    s_nop 0
    buffer_load_dwordx4 v16, s[8:11], s76 offen lds
    s_add_u32 m0, s79, 1024
    s_nop 0
    buffer_load_dwordx4 v17, s[8:11], s76 offen lds
    s_add_u32 m0, s79, 2048
    s_nop 0
    buffer_load_dwordx4 v18, s[8:11], s76 offen lds
    s_add_u32 m0, s79, 3072
    s_nop 0
    buffer_load_dwordx4 v19, s[8:11], s76 offen lds
    s_add_u32 m0, s79, 4096
    s_nop 0
    buffer_load_dwordx4 v20, s[8:11], s76 offen lds
    s_add_u32 m0, s79, 20480
    s_add_u32 s76, s76, 204800
    buffer_load_dwordx4 v16, s[8:11], s76 offen lds
    s_add_u32 m0, s79, 21504
    s_nop 0
    buffer_load_dwordx4 v17, s[8:11], s76 offen lds
    s_add_u32 m0, s79, 22528
    s_nop 0
    buffer_load_dwordx4 v18, s[8:11], s76 offen lds
    s_add_u32 m0, s79, 23552
    s_nop 0
    buffer_load_dwordx4 v19, s[8:11], s76 offen lds
    s_add_u32 m0, s79, 24576
    s_nop 0
    buffer_load_dwordx4 v20, s[8:11], s76 offen lds
    s_add_u32 m0, s79, 40960
    s_add_u32 s76, s76, 204800
    buffer_load_dwordx4 v16, s[8:11], s76 offen lds
    s_add_u32 m0, s79, 41984
    s_nop 0
    buffer_load_dwordx4 v17, s[8:11], s76 offen lds
    s_add_u32 m0, s79, 43008
    s_nop 0
    buffer_load_dwordx4 v18, s[8:11], s76 offen lds
    s_add_u32 m0, s79, 44032
    s_nop 0
    buffer_load_dwordx4 v19, s[8:11], s76 offen lds
    s_add_u32 m0, s79, 45056
    s_nop 0
    buffer_load_dwordx4 v20, s[8:11], s76 offen lds
    s_add_u32 m0, s79, 61440
    s_add_u32 s76, s76, 204800
    buffer_load_dwordx4 v16, s[8:11], s76 offen lds
    s_add_u32 m0, s79, 62464
    s_nop 0
    buffer_load_dwordx4 v17, s[8:11], s76 offen lds
    s_add_u32 m0, s79, 63488
    s_nop 0
    buffer_load_dwordx4 v18, s[8:11], s76 offen lds
    s_add_u32 m0, s79, 64512
    s_nop 0
    buffer_load_dwordx4 v19, s[8:11], s76 offen lds
    s_add_u32 m0, s79, 65536
    s_nop 0
    buffer_load_dwordx4 v20, s[8:11], s76 offen lds
    s_add_u32 m0, s79, 81920
    s_nop 0
    buffer_load_dwordx4 v21, s[8:11], s78 offen lds
    s_add_u32 m0, s79, 82944
    s_nop 0
    buffer_load_dwordx4 v22, s[8:11], s78 offen lds
    s_add_u32 m0, s79, 83968
    s_nop 0
    buffer_load_dwordx4 v23, s[8:11], s78 offen lds
    s_add_u32 m0, s79, 84992
    s_nop 0
    buffer_load_dwordx4 v24, s[8:11], s78 offen lds
    s_add_u32 m0, s79, 86016
    s_nop 0
    buffer_load_dwordx4 v25, s[8:11], s78 offen lds
    s_cmp_lg_u32 s82, 3
    s_cbranch_scc1 k23_hnf_94
    v_mov_b32 v14, 42508
    s_mov_b32 s24, 0
k23_hp_95:
    ds_read_b32 v15, v14
    s_add_u32 s24, s24, 1
    s_waitcnt lgkmcnt(0)
    v_cmp_ne_u32 s[46:47], 8, v15
    s_nop 1
    s_cmp_eq_u64 s[46:47], 0
    s_cbranch_scc1 k23_hok_96
    s_sleep 1
    s_cmp_lt_u32 s24, 0x100000
    s_cbranch_scc1 k23_hp_95
k23_hok_96:
    s_lshl_b32 s23, s21, 5
    s_add_u32 s23, s23, s20
    s_add_u32 s23, s23, 256
    s_lshl_b32 s23, s23, 7
    s_add_u32 s23, s23, 16711680
    v_mov_b32 v14, s23
    v_mov_b32 v15, 1
    s_mov_b64 exec, 1
    buffer_store_dword v15, v14, s[16:19], 0 offen sc1
    s_mov_b64 exec, -1
k23_hnf_94:
    s_waitcnt vmcnt(0) lgkmcnt(0)
    s_barrier
    s_endpgm
k23_attn_83:
    v_cmp_gt_u32 s[38:39], 32, v1
    v_and_b32 v13, 7, v12
    v_bfe_u32 v14, v12, 3, 1
    v_lshl_or_b32 v13, v14, 4, v13
    v_bfe_u32 v14, v12, 4, 1
    v_lshl_or_b32 v13, v14, 3, v13
    s_mul_i32 s41, s22, 1280
    v_and_b32 v14, 15, v13
    v_lshlrev_b32 v14, 4, v14
    v_lshrrev_b32 v15, 4, v13
    v_lshl_add_u32 v14, v15, 3, v14
    v_add_u32 v3, s41, v14
    v_lshl_add_u32 v2, v11, 8, v3
    v_mul_u32_u24 v15, 320, v11
    v_lshl_add_u32 v14, v12, 4, v15
    s_add_u32 s41, s41, 20480
    v_add_u32 v4, s41, v14
    s_mul_i32 s36, s26, 1280
    v_lshlrev_b32 v14, 4, v1
    v_add_u32 v5, s36, v14
    v_lshlrev_b32 v14, 3, v12
    v_add_u32 v14, s36, v14
    v_add_u32 v14, 1024, v14
    v_mov_b32 v15, 0x7f000000
    v_cndmask_b32 v6, v15, v14, s[38:39]
    v_mov_b32 v98, 0x3f803f80
    v_mov_b32 v99, 0x3f803f80
    v_mov_b32 v100, 0x3f803f80
    v_mov_b32 v101, 0x3f803f80
    v_mov_b32 v102, 0x3f803f80
    v_mov_b32 v103, 0x3f803f80
    v_mov_b32 v104, 0x3f803f80
    v_mov_b32 v105, 0x3f803f80
    s_mov_b32 s27, 0
    s_cmp_lg_u32 s21, 0
    s_cbranch_scc1 k2_r0_97
    s_sub_u32 s27, 8, s22
    v_mov_b32 v16, 0xff800000
    v_mov_b32 v17, 0xff800000
    v_mov_b32 v18, 0xff800000
    v_mov_b32 v19, 0xff800000
    v_mov_b32 v20, 0xff800000
    v_mov_b32 v21, 0xff800000
    v_mov_b32 v22, 0xff800000
    v_mov_b32 v23, 0xff800000
    v_mov_b32 v24, 0xff800000
    v_mov_b32 v25, 0xff800000
    v_mov_b32 v26, 0xff800000
    v_mov_b32 v27, 0xff800000
    v_mov_b32 v28, 0xff800000
    v_mov_b32 v29, 0xff800000
    v_mov_b32 v30, 0xff800000
    v_mov_b32 v31, 0xff800000
    s_branch k2_r1_98
k2_r0_97:
    v_lshlrev_b32 v14, 2, v11
    v_sub_u32 v14, v12, v14
    v_mov_b32 v15, 0xff800000
    v_cmp_gt_i32 s[46:47], 0, v14
    s_nop 1
    v_cndmask_b32 v16, v15, 0, s[46:47]
    v_cmp_gt_i32 s[48:49], 1, v14
    s_nop 1
    v_cndmask_b32 v17, v15, 0, s[48:49]
    v_cmp_gt_i32 s[46:47], 2, v14
    s_nop 1
    v_cndmask_b32 v18, v15, 0, s[46:47]
    v_cmp_gt_i32 s[48:49], 3, v14
    s_nop 1
    v_cndmask_b32 v19, v15, 0, s[48:49]
    v_cmp_gt_i32 s[46:47], 16, v14
    s_nop 1
    v_cndmask_b32 v20, v15, 0, s[46:47]
    v_cmp_gt_i32 s[48:49], 17, v14
    s_nop 1
    v_cndmask_b32 v21, v15, 0, s[48:49]
    v_cmp_gt_i32 s[46:47], 18, v14
    s_nop 1
    v_cndmask_b32 v22, v15, 0, s[46:47]
    v_cmp_gt_i32 s[48:49], 19, v14
    s_nop 1
    v_cndmask_b32 v23, v15, 0, s[48:49]
    v_cmp_gt_i32 s[46:47], 8, v14
    s_nop 1
    v_cndmask_b32 v24, v15, 0, s[46:47]
    v_cmp_gt_i32 s[48:49], 9, v14
    s_nop 1
    v_cndmask_b32 v25, v15, 0, s[48:49]
    v_cmp_gt_i32 s[46:47], 10, v14
    s_nop 1
    v_cndmask_b32 v26, v15, 0, s[46:47]
    v_cmp_gt_i32 s[48:49], 11, v14
    s_nop 1
    v_cndmask_b32 v27, v15, 0, s[48:49]
    v_cmp_gt_i32 s[46:47], 24, v14
    s_nop 1
    v_cndmask_b32 v28, v15, 0, s[46:47]
    v_cmp_gt_i32 s[48:49], 25, v14
    s_nop 1
    v_cndmask_b32 v29, v15, 0, s[48:49]
    v_cmp_gt_i32 s[46:47], 26, v14
    s_nop 1
    v_cndmask_b32 v30, v15, 0, s[46:47]
    v_cmp_gt_i32 s[48:49], 27, v14
    s_nop 1
    v_cndmask_b32 v31, v15, 0, s[48:49]
k2_r1_98:
    s_barrier
    v_mov_b32 v84, 0
    v_mov_b32 v85, 0
    buffer_load_dwordx4 v[80:83], v10, s[16:19], 0 offen sc1
    s_mov_b32 exec_hi, 0
    buffer_load_dwordx2 v[84:85], v9, s[16:19], 0 offen offset:1024 sc1
    s_mov_b32 exec_hi, -1
    s_waitcnt vmcnt(0)
    s_barrier
    v_permlane16_swap_b32 v80, v82
    v_permlane16_swap_b32 v81, v83
    ds_read_b64 v[86:87], v2 offset:0
    ds_read_b64 v[88:89], v2 offset:512
    ds_read_b64 v[94:95], v3 offset:1024
    ds_read_b64 v[90:91], v2 offset:1280
    ds_read_b64 v[92:93], v2 offset:1792
    ds_read_b64 v[96:97], v3 offset:2304
    s_mov_b32 exec_lo, 0xfffff
    s_mov_b32 exec_hi, 0xfffff
    ds_read_b128 v[98:101], v4 offset:0
    ds_read_b128 v[102:105], v4 offset:640
    s_mov_b64 exec, -1
    s_waitcnt lgkmcnt(5)
    v_mfma_f32_32x32x16_bf16 v[32:47], v[86:89], v[80:83], v[16:31]
    v_mfma_f32_32x32x8bf16_1k v[32:47], v[94:95], v[84:85], v[32:47]
    s_waitcnt lgkmcnt(2)
    s_cmp_gt_u32 s27, 1
    s_cbranch_scc1 k2_neg_99
    v_mfma_f32_32x32x16_bf16 v[48:63], v[90:93], v[80:83], 0
    s_branch k2_join_100
k2_neg_99:
    v_mfma_f32_32x32x16_bf16 v[48:63], v[90:93], v[80:83], v[16:31]
k2_join_100:
    v_mfma_f32_32x32x8bf16_1k v[48:63], v[96:97], v[84:85], v[48:63]
    ds_read_b64 v[86:87], v2 offset:2560
    ds_read_b64 v[88:89], v2 offset:3072
    ds_read_b64 v[94:95], v3 offset:3584
    s_nop 3
    v_exp_f32 v32, v32
    v_exp_f32 v33, v33
    v_exp_f32 v34, v34
    v_exp_f32 v35, v35
    v_exp_f32 v36, v36
    v_exp_f32 v37, v37
    v_exp_f32 v38, v38
    v_exp_f32 v39, v39
    v_cvt_pk_bf16_f32 v106, v32, v33
    v_cvt_pk_bf16_f32 v107, v34, v35
    v_cvt_pk_bf16_f32 v108, v36, v37
    v_cvt_pk_bf16_f32 v109, v38, v39
    s_waitcnt lgkmcnt(3)
    s_nop 0
    v_mfma_f32_32x32x16_bf16 v[64:79], v[98:101], v[106:109], 0
    v_exp_f32 v40, v40
    v_exp_f32 v41, v41
    v_exp_f32 v42, v42
    v_exp_f32 v43, v43
    v_exp_f32 v44, v44
    v_exp_f32 v45, v45
    v_exp_f32 v46, v46
    v_exp_f32 v47, v47
    v_cvt_pk_bf16_f32 v110, v40, v41
    v_cvt_pk_bf16_f32 v111, v42, v43
    v_cvt_pk_bf16_f32 v112, v44, v45
    v_cvt_pk_bf16_f32 v113, v46, v47
    s_nop 1
    v_mfma_f32_32x32x16_bf16 v[64:79], v[102:105], v[110:113], v[64:79]
    s_mov_b32 exec_lo, 0xfffff
    s_mov_b32 exec_hi, 0xfffff
    ds_read_b128 v[98:101], v4 offset:1280
    ds_read_b128 v[102:105], v4 offset:1920
    s_mov_b64 exec, -1
    s_waitcnt lgkmcnt(2)
    s_cmp_gt_u32 s27, 2
    s_cbranch_scc1 k2_neg_101
    v_mfma_f32_32x32x16_bf16 v[32:47], v[86:89], v[80:83], 0
    s_branch k2_join_102
k2_neg_101:
    v_mfma_f32_32x32x16_bf16 v[32:47], v[86:89], v[80:83], v[16:31]
k2_join_102:
    v_mfma_f32_32x32x8bf16_1k v[32:47], v[94:95], v[84:85], v[32:47]
    ds_read_b64 v[90:91], v2 offset:3840
    ds_read_b64 v[92:93], v2 offset:4352
    ds_read_b64 v[96:97], v3 offset:4864
    v_exp_f32 v48, v48
    v_exp_f32 v49, v49
    v_exp_f32 v50, v50
    v_exp_f32 v51, v51
    v_exp_f32 v52, v52
    v_exp_f32 v53, v53
    v_exp_f32 v54, v54
    v_exp_f32 v55, v55
    v_cvt_pk_bf16_f32 v106, v48, v49
    v_cvt_pk_bf16_f32 v107, v50, v51
    v_cvt_pk_bf16_f32 v108, v52, v53
    v_cvt_pk_bf16_f32 v109, v54, v55
    s_waitcnt lgkmcnt(3)
    s_nop 0
    v_mfma_f32_32x32x16_bf16 v[64:79], v[98:101], v[106:109], v[64:79]
    v_exp_f32 v56, v56
    v_exp_f32 v57, v57
    v_exp_f32 v58, v58
    v_exp_f32 v59, v59
    v_exp_f32 v60, v60
    v_exp_f32 v61, v61
    v_exp_f32 v62, v62
    v_exp_f32 v63, v63
    v_cvt_pk_bf16_f32 v110, v56, v57
    v_cvt_pk_bf16_f32 v111, v58, v59
    v_cvt_pk_bf16_f32 v112, v60, v61
    v_cvt_pk_bf16_f32 v113, v62, v63
    s_nop 1
    v_mfma_f32_32x32x16_bf16 v[64:79], v[102:105], v[110:113], v[64:79]
    s_mov_b32 exec_lo, 0xfffff
    s_mov_b32 exec_hi, 0xfffff
    ds_read_b128 v[98:101], v4 offset:2560
    ds_read_b128 v[102:105], v4 offset:3200
    s_mov_b64 exec, -1
    s_waitcnt lgkmcnt(2)
    s_cmp_gt_u32 s27, 3
    s_cbranch_scc1 k2_neg_103
    v_mfma_f32_32x32x16_bf16 v[48:63], v[90:93], v[80:83], 0
    s_branch k2_join_104
k2_neg_103:
    v_mfma_f32_32x32x16_bf16 v[48:63], v[90:93], v[80:83], v[16:31]
k2_join_104:
    v_mfma_f32_32x32x8bf16_1k v[48:63], v[96:97], v[84:85], v[48:63]
    ds_read_b64 v[86:87], v2 offset:5120
    ds_read_b64 v[88:89], v2 offset:5632
    ds_read_b64 v[94:95], v3 offset:6144
    v_exp_f32 v32, v32
    v_exp_f32 v33, v33
    v_exp_f32 v34, v34
    v_exp_f32 v35, v35
    v_exp_f32 v36, v36
    v_exp_f32 v37, v37
    v_exp_f32 v38, v38
    v_exp_f32 v39, v39
    v_cvt_pk_bf16_f32 v106, v32, v33
    v_cvt_pk_bf16_f32 v107, v34, v35
    v_cvt_pk_bf16_f32 v108, v36, v37
    v_cvt_pk_bf16_f32 v109, v38, v39
    s_waitcnt lgkmcnt(3)
    s_nop 0
    v_mfma_f32_32x32x16_bf16 v[64:79], v[98:101], v[106:109], v[64:79]
    v_exp_f32 v40, v40
    v_exp_f32 v41, v41
    v_exp_f32 v42, v42
    v_exp_f32 v43, v43
    v_exp_f32 v44, v44
    v_exp_f32 v45, v45
    v_exp_f32 v46, v46
    v_exp_f32 v47, v47
    v_cvt_pk_bf16_f32 v110, v40, v41
    v_cvt_pk_bf16_f32 v111, v42, v43
    v_cvt_pk_bf16_f32 v112, v44, v45
    v_cvt_pk_bf16_f32 v113, v46, v47
    s_nop 1
    v_mfma_f32_32x32x16_bf16 v[64:79], v[102:105], v[110:113], v[64:79]
    s_mov_b32 exec_lo, 0xfffff
    s_mov_b32 exec_hi, 0xfffff
    ds_read_b128 v[98:101], v4 offset:3840
    ds_read_b128 v[102:105], v4 offset:4480
    s_mov_b64 exec, -1
    v_mov_b32 v14, 42512
    s_mov_b32 s24, 0
k23_pqw_105:
    ds_read_b32 v15, v14
    s_add_u32 s24, s24, 1
    s_waitcnt lgkmcnt(0)
    v_cmp_ne_u32 s[46:47], 1, v15
    s_nop 1
    s_cmp_eq_u64 s[46:47], 0
    s_cbranch_scc1 k23_pqok_106
    s_cmp_lt_u32 s24, 0x100000
    s_cbranch_scc1 k23_pqw_105
k23_pqok_106:
    s_and_b32 s44, s20, 1
    s_lshl_b32 s45, s44, 8
    s_add_u32 s45, s45, 7864320
    s_xor_b32 s46, s44, 1
    s_lshl_b32 s46, s46, 10
    s_add_u32 s46, s46, 7864320
    v_mov_b32 v118, 0
    v_mov_b32 v119, 0
    buffer_load_dwordx4 v[114:117], v10, s[16:19], s45 offen sc1
    s_mov_b32 exec_hi, 0
    buffer_load_dwordx2 v[118:119], v9, s[16:19], s46 offen sc1
    s_mov_b32 exec_hi, -1
    s_waitcnt lgkmcnt(2)
    s_cmp_gt_u32 s27, 4
    s_cbranch_scc1 k2_neg_107
    v_mfma_f32_32x32x16_bf16 v[32:47], v[86:89], v[80:83], 0
    s_branch k2_join_108
k2_neg_107:
    v_mfma_f32_32x32x16_bf16 v[32:47], v[86:89], v[80:83], v[16:31]
k2_join_108:
    v_mfma_f32_32x32x8bf16_1k v[32:47], v[94:95], v[84:85], v[32:47]
    ds_read_b64 v[90:91], v2 offset:6400
    ds_read_b64 v[92:93], v2 offset:6912
    ds_read_b64 v[96:97], v3 offset:7424
    v_exp_f32 v48, v48
    v_exp_f32 v49, v49
    v_exp_f32 v50, v50
    v_exp_f32 v51, v51
    v_exp_f32 v52, v52
    v_exp_f32 v53, v53
    v_exp_f32 v54, v54
    v_exp_f32 v55, v55
    v_cvt_pk_bf16_f32 v106, v48, v49
    v_cvt_pk_bf16_f32 v107, v50, v51
    v_cvt_pk_bf16_f32 v108, v52, v53
    v_cvt_pk_bf16_f32 v109, v54, v55
    s_waitcnt lgkmcnt(3)
    s_nop 0
    v_mfma_f32_32x32x16_bf16 v[64:79], v[98:101], v[106:109], v[64:79]
    v_exp_f32 v56, v56
    v_exp_f32 v57, v57
    v_exp_f32 v58, v58
    v_exp_f32 v59, v59
    v_exp_f32 v60, v60
    v_exp_f32 v61, v61
    v_exp_f32 v62, v62
    v_exp_f32 v63, v63
    v_cvt_pk_bf16_f32 v110, v56, v57
    v_cvt_pk_bf16_f32 v111, v58, v59
    v_cvt_pk_bf16_f32 v112, v60, v61
    v_cvt_pk_bf16_f32 v113, v62, v63
    s_nop 1
    v_mfma_f32_32x32x16_bf16 v[64:79], v[102:105], v[110:113], v[64:79]
    s_mov_b32 exec_lo, 0xfffff
    s_mov_b32 exec_hi, 0xfffff
    ds_read_b128 v[98:101], v4 offset:5120
    ds_read_b128 v[102:105], v4 offset:5760
    s_mov_b64 exec, -1
    s_waitcnt lgkmcnt(2)
    s_cmp_gt_u32 s27, 5
    s_cbranch_scc1 k2_neg_109
    v_mfma_f32_32x32x16_bf16 v[48:63], v[90:93], v[80:83], 0
    s_branch k2_join_110
k2_neg_109:
    v_mfma_f32_32x32x16_bf16 v[48:63], v[90:93], v[80:83], v[16:31]
k2_join_110:
    v_mfma_f32_32x32x8bf16_1k v[48:63], v[96:97], v[84:85], v[48:63]
    ds_read_b64 v[86:87], v2 offset:7680
    ds_read_b64 v[88:89], v2 offset:8192
    ds_read_b64 v[94:95], v3 offset:8704
    v_exp_f32 v32, v32
    v_exp_f32 v33, v33
    v_exp_f32 v34, v34
    v_exp_f32 v35, v35
    v_exp_f32 v36, v36
    v_exp_f32 v37, v37
    v_exp_f32 v38, v38
    v_exp_f32 v39, v39
    v_cvt_pk_bf16_f32 v106, v32, v33
    v_cvt_pk_bf16_f32 v107, v34, v35
    v_cvt_pk_bf16_f32 v108, v36, v37
    v_cvt_pk_bf16_f32 v109, v38, v39
    s_waitcnt lgkmcnt(3)
    s_nop 0
    v_mfma_f32_32x32x16_bf16 v[64:79], v[98:101], v[106:109], v[64:79]
    v_exp_f32 v40, v40
    v_exp_f32 v41, v41
    v_exp_f32 v42, v42
    v_exp_f32 v43, v43
    v_exp_f32 v44, v44
    v_exp_f32 v45, v45
    v_exp_f32 v46, v46
    v_exp_f32 v47, v47
    v_cvt_pk_bf16_f32 v110, v40, v41
    v_cvt_pk_bf16_f32 v111, v42, v43
    v_cvt_pk_bf16_f32 v112, v44, v45
    v_cvt_pk_bf16_f32 v113, v46, v47
    s_nop 1
    v_mfma_f32_32x32x16_bf16 v[64:79], v[102:105], v[110:113], v[64:79]
    s_mov_b32 exec_lo, 0xfffff
    s_mov_b32 exec_hi, 0xfffff
    ds_read_b128 v[98:101], v4 offset:6400
    ds_read_b128 v[102:105], v4 offset:7040
    s_mov_b64 exec, -1
    s_waitcnt vmcnt(0)
    v_permlane16_swap_b32 v114, v116
    v_permlane16_swap_b32 v115, v117
    v_mov_b32 v14, 42496
    s_mov_b32 s24, 0
k23_kvw_111:
    ds_read_b128 v[128:131], v14
    s_add_u32 s24, s24, 1
    s_waitcnt lgkmcnt(0)
    v_and_b32 v128, v128, v129
    v_and_b32 v128, v128, v130
    v_cmp_ne_u32 s[46:47], 1, v128
    s_nop 1
    s_cmp_eq_u64 s[46:47], 0
    s_cbranch_scc1 k23_kvok_112
    s_cmp_lt_u32 s24, 0x100000
    s_cbranch_scc1 k23_kvw_111
k23_kvok_112:
    v_lshlrev_b32 v14, 4, v1
    v_lshlrev_b32 v15, 3, v1
    ds_read_b128 v[120:123], v14 offset:40960
    ds_read_b64 v[124:125], v15 offset:41984
    s_mov_b32 s43, 0x358637bd
    s_mov_b32 s61, 10485760
    s_waitcnt lgkmcnt(0)
    v_mfma_f32_32x32x16_bf16 v[128:143], v[120:123], v[114:117], 0
    v_mfma_f32_32x32x8bf16_1k v[128:143], v[124:125], v[118:119], v[128:143]
    s_waitcnt lgkmcnt(2)
    s_cmp_gt_u32 s27, 6
    s_cbranch_scc1 k2_neg_113
    v_mfma_f32_32x32x16_bf16 v[32:47], v[86:89], v[80:83], 0
    s_branch k2_join_114
k2_neg_113:
    v_mfma_f32_32x32x16_bf16 v[32:47], v[86:89], v[80:83], v[16:31]
k2_join_114:
    v_mfma_f32_32x32x8bf16_1k v[32:47], v[94:95], v[84:85], v[32:47]
    ds_read_b64 v[90:91], v2 offset:8960
    ds_read_b64 v[92:93], v2 offset:9472
    ds_read_b64 v[96:97], v3 offset:9984
    s_nop 3
    v_cndmask_b32 v7, v136, v140, s[38:39]
    v_add_f32 v7, s43, v7
    v_rcp_f32 v8, v7
    s_nop 0
    v_mul_f32 v128, v8, v128
    v_mul_f32 v129, v8, v129
    v_mul_f32 v130, v8, v130
    v_mul_f32 v131, v8, v131
    v_mul_f32 v132, v8, v132
    v_mul_f32 v133, v8, v133
    v_mul_f32 v134, v8, v134
    v_mul_f32 v135, v8, v135
    v_mul_f32 v136, v8, v136
    v_mul_f32 v137, v8, v137
    v_mul_f32 v138, v8, v138
    v_mul_f32 v139, v8, v139
    v_cvt_pk_bf16_f32 v144, v128, v129
    v_cvt_pk_bf16_f32 v145, v130, v131
    v_cvt_pk_bf16_f32 v146, v132, v133
    v_cvt_pk_bf16_f32 v147, v134, v135
    v_cvt_pk_bf16_f32 v148, v136, v137
    v_cvt_pk_bf16_f32 v149, v138, v139
    buffer_store_dwordx4 v[144:147], v5, s[16:19], s61 offen offset:0 sc1
    buffer_store_dwordx2 v[148:149], v6, s[16:19], s61 offen offset:0 sc1
    v_exp_f32 v48, v48
    v_exp_f32 v49, v49
    v_exp_f32 v50, v50
    v_exp_f32 v51, v51
    v_exp_f32 v52, v52
    v_exp_f32 v53, v53
    v_exp_f32 v54, v54
    v_exp_f32 v55, v55
    v_cvt_pk_bf16_f32 v106, v48, v49
    v_cvt_pk_bf16_f32 v107, v50, v51
    v_cvt_pk_bf16_f32 v108, v52, v53
    v_cvt_pk_bf16_f32 v109, v54, v55
    s_waitcnt lgkmcnt(3)
    s_nop 0
    v_mfma_f32_32x32x16_bf16 v[64:79], v[98:101], v[106:109], v[64:79]
    v_exp_f32 v56, v56
    v_exp_f32 v57, v57
    v_exp_f32 v58, v58
    v_exp_f32 v59, v59
    v_exp_f32 v60, v60
    v_exp_f32 v61, v61
    v_exp_f32 v62, v62
    v_exp_f32 v63, v63
    v_cvt_pk_bf16_f32 v110, v56, v57
    v_cvt_pk_bf16_f32 v111, v58, v59
    v_cvt_pk_bf16_f32 v112, v60, v61
    v_cvt_pk_bf16_f32 v113, v62, v63
    s_nop 1
    v_mfma_f32_32x32x16_bf16 v[64:79], v[102:105], v[110:113], v[64:79]
    s_mov_b32 exec_lo, 0xfffff
    s_mov_b32 exec_hi, 0xfffff
    ds_read_b128 v[98:101], v4 offset:7680
    ds_read_b128 v[102:105], v4 offset:8320
    s_mov_b64 exec, -1
    s_waitcnt lgkmcnt(2)
    s_cmp_gt_u32 s27, 7
    s_cbranch_scc1 k2_neg_115
    v_mfma_f32_32x32x16_bf16 v[48:63], v[90:93], v[80:83], 0
    s_branch k2_join_116
k2_neg_115:
    v_mfma_f32_32x32x16_bf16 v[48:63], v[90:93], v[80:83], v[16:31]
k2_join_116:
    v_mfma_f32_32x32x8bf16_1k v[48:63], v[96:97], v[84:85], v[48:63]
    ds_read_b64 v[86:87], v2 offset:10240
    ds_read_b64 v[88:89], v2 offset:10752
    ds_read_b64 v[94:95], v3 offset:11264
    v_exp_f32 v32, v32
    v_exp_f32 v33, v33
    v_exp_f32 v34, v34
    v_exp_f32 v35, v35
    v_exp_f32 v36, v36
    v_exp_f32 v37, v37
    v_exp_f32 v38, v38
    v_exp_f32 v39, v39
    v_cvt_pk_bf16_f32 v106, v32, v33
    v_cvt_pk_bf16_f32 v107, v34, v35
    v_cvt_pk_bf16_f32 v108, v36, v37
    v_cvt_pk_bf16_f32 v109, v38, v39
    s_waitcnt lgkmcnt(3)
    s_nop 0
    v_mfma_f32_32x32x16_bf16 v[64:79], v[98:101], v[106:109], v[64:79]
    v_exp_f32 v40, v40
    v_exp_f32 v41, v41
    v_exp_f32 v42, v42
    v_exp_f32 v43, v43
    v_exp_f32 v44, v44
    v_exp_f32 v45, v45
    v_exp_f32 v46, v46
    v_exp_f32 v47, v47
    v_cvt_pk_bf16_f32 v110, v40, v41
    v_cvt_pk_bf16_f32 v111, v42, v43
    v_cvt_pk_bf16_f32 v112, v44, v45
    v_cvt_pk_bf16_f32 v113, v46, v47
    s_nop 1
    v_mfma_f32_32x32x16_bf16 v[64:79], v[102:105], v[110:113], v[64:79]
    s_mov_b32 exec_lo, 0xfffff
    s_mov_b32 exec_hi, 0xfffff
    ds_read_b128 v[98:101], v4 offset:8960
    ds_read_b128 v[102:105], v4 offset:9600
    s_mov_b64 exec, -1
    s_cmp_eq_u32 s21, 0
    s_cbranch_scc1 k2_m0_117
    v_xor_b32 v16, 0xff800000, v16
    v_xor_b32 v17, 0xff800000, v17
    v_xor_b32 v18, 0xff800000, v18
    v_xor_b32 v19, 0xff800000, v19
    v_xor_b32 v20, 0xff800000, v20
    v_xor_b32 v21, 0xff800000, v21
    v_xor_b32 v22, 0xff800000, v22
    v_xor_b32 v23, 0xff800000, v23
    v_xor_b32 v24, 0xff800000, v24
    v_xor_b32 v25, 0xff800000, v25
    v_xor_b32 v26, 0xff800000, v26
    v_xor_b32 v27, 0xff800000, v27
    v_xor_b32 v28, 0xff800000, v28
    v_xor_b32 v29, 0xff800000, v29
    v_xor_b32 v30, 0xff800000, v30
    v_xor_b32 v31, 0xff800000, v31
    s_branch k2_m1_118
k2_m0_117:
    v_lshlrev_b32 v14, 2, v11
    v_sub_u32 v14, v12, v14
    v_mov_b32 v15, 0xff800000
    v_cmp_gt_i32 s[46:47], 0, v14
    s_nop 1
    v_cndmask_b32 v16, 0, v15, s[46:47]
    v_cmp_gt_i32 s[48:49], 1, v14
    s_nop 1
    v_cndmask_b32 v17, 0, v15, s[48:49]
    v_cmp_gt_i32 s[46:47], 2, v14
    s_nop 1
    v_cndmask_b32 v18, 0, v15, s[46:47]
    v_cmp_gt_i32 s[48:49], 3, v14
    s_nop 1
    v_cndmask_b32 v19, 0, v15, s[48:49]
    v_cmp_gt_i32 s[46:47], 16, v14
    s_nop 1
    v_cndmask_b32 v20, 0, v15, s[46:47]
    v_cmp_gt_i32 s[48:49], 17, v14
    s_nop 1
    v_cndmask_b32 v21, 0, v15, s[48:49]
    v_cmp_gt_i32 s[46:47], 18, v14
    s_nop 1
    v_cndmask_b32 v22, 0, v15, s[46:47]
    v_cmp_gt_i32 s[48:49], 19, v14
    s_nop 1
    v_cndmask_b32 v23, 0, v15, s[48:49]
    v_cmp_gt_i32 s[46:47], 8, v14
    s_nop 1
    v_cndmask_b32 v24, 0, v15, s[46:47]
    v_cmp_gt_i32 s[48:49], 9, v14
    s_nop 1
    v_cndmask_b32 v25, 0, v15, s[48:49]
    v_cmp_gt_i32 s[46:47], 10, v14
    s_nop 1
    v_cndmask_b32 v26, 0, v15, s[46:47]
    v_cmp_gt_i32 s[48:49], 11, v14
    s_nop 1
    v_cndmask_b32 v27, 0, v15, s[48:49]
    v_cmp_gt_i32 s[46:47], 24, v14
    s_nop 1
    v_cndmask_b32 v28, 0, v15, s[46:47]
    v_cmp_gt_i32 s[48:49], 25, v14
    s_nop 1
    v_cndmask_b32 v29, 0, v15, s[48:49]
    v_cmp_gt_i32 s[46:47], 26, v14
    s_nop 1
    v_cndmask_b32 v30, 0, v15, s[46:47]
    v_cmp_gt_i32 s[48:49], 27, v14
    s_nop 1
    v_cndmask_b32 v31, 0, v15, s[48:49]
k2_m1_118:
    s_waitcnt lgkmcnt(2)
    s_nop 0
    v_mfma_f32_32x32x16_bf16 v[32:47], v[86:89], v[80:83], v[16:31]
    v_mfma_f32_32x32x8bf16_1k v[32:47], v[94:95], v[84:85], v[32:47]
    v_exp_f32 v48, v48
    v_exp_f32 v49, v49
    v_exp_f32 v50, v50
    v_exp_f32 v51, v51
    v_exp_f32 v52, v52
    v_exp_f32 v53, v53
    v_exp_f32 v54, v54
    v_exp_f32 v55, v55
    v_cvt_pk_bf16_f32 v106, v48, v49
    v_cvt_pk_bf16_f32 v107, v50, v51
    v_cvt_pk_bf16_f32 v108, v52, v53
    v_cvt_pk_bf16_f32 v109, v54, v55
    s_waitcnt lgkmcnt(0)
    s_nop 0
    v_mfma_f32_32x32x16_bf16 v[64:79], v[98:101], v[106:109], v[64:79]
    v_exp_f32 v56, v56
    v_exp_f32 v57, v57
    v_exp_f32 v58, v58
    v_exp_f32 v59, v59
    v_exp_f32 v60, v60
    v_exp_f32 v61, v61
    v_exp_f32 v62, v62
    v_exp_f32 v63, v63
    v_cvt_pk_bf16_f32 v110, v56, v57
    v_cvt_pk_bf16_f32 v111, v58, v59
    v_cvt_pk_bf16_f32 v112, v60, v61
    v_cvt_pk_bf16_f32 v113, v62, v63
    s_nop 1
    v_mfma_f32_32x32x16_bf16 v[64:79], v[102:105], v[110:113], v[64:79]
    s_mov_b32 exec_lo, 0xfffff
    s_mov_b32 exec_hi, 0xfffff
    ds_read_b128 v[98:101], v4 offset:10240
    ds_read_b128 v[102:105], v4 offset:10880
    s_mov_b64 exec, -1
    v_exp_f32 v32, v32
    v_exp_f32 v33, v33
    v_exp_f32 v34, v34
    v_exp_f32 v35, v35
    v_exp_f32 v36, v36
    v_exp_f32 v37, v37
    v_exp_f32 v38, v38
    v_exp_f32 v39, v39
    v_cvt_pk_bf16_f32 v106, v32, v33
    v_cvt_pk_bf16_f32 v107, v34, v35
    v_cvt_pk_bf16_f32 v108, v36, v37
    v_cvt_pk_bf16_f32 v109, v38, v39
    s_waitcnt lgkmcnt(0)
    s_nop 0
    v_mfma_f32_32x32x16_bf16 v[64:79], v[98:101], v[106:109], v[64:79]
    v_exp_f32 v40, v40
    v_exp_f32 v41, v41
    v_exp_f32 v42, v42
    v_exp_f32 v43, v43
    v_exp_f32 v44, v44
    v_exp_f32 v45, v45
    v_exp_f32 v46, v46
    v_exp_f32 v47, v47
    v_cvt_pk_bf16_f32 v110, v40, v41
    v_cvt_pk_bf16_f32 v111, v42, v43
    v_cvt_pk_bf16_f32 v112, v44, v45
    v_cvt_pk_bf16_f32 v113, v46, v47
    s_nop 1
    v_mfma_f32_32x32x16_bf16 v[64:79], v[102:105], v[110:113], v[64:79]
    s_waitcnt vmcnt(0)
    v_mov_b32 v14, 42508
    v_mov_b32 v15, 1
    s_mov_b64 exec, 1
    ds_add_u32 v14, v15
    s_mov_b64 exec, -1
    s_waitcnt lgkmcnt(0)
    s_mov_b32 s60, 13107200
    s_nop 3
    v_cndmask_b32 v7, v72, v76, s[38:39]
    v_mov_b32 v9, 0
    v_fma_f32 v9, v64, 0, v9
    v_fma_f32 v9, v65, 0, v9
    v_fma_f32 v9, v66, 0, v9
    v_fma_f32 v9, v67, 0, v9
    v_fma_f32 v9, v68, 0, v9
    v_fma_f32 v9, v69, 0, v9
    v_fma_f32 v9, v70, 0, v9
    v_fma_f32 v9, v71, 0, v9
    v_fma_f32 v9, v72, 0, v9
    v_fma_f32 v9, v73, 0, v9
    v_fma_f32 v9, v74, 0, v9
    v_fma_f32 v9, v75, 0, v9
    s_mov_b32 s50, 0x1f800000
    s_mov_b32 s51, 0x5f800000
    v_cmp_nge_f32 s[52:53], v7, s50
    v_cmp_nle_f32 s[54:55], v7, s51
    v_cmp_u_f32 s[56:57], v9, v9
    s_nop 0
    s_or_b64 s[52:53], s[52:53], s[54:55]
    s_or_b64 s[52:53], s[52:53], s[56:57]
    s_cmp_lg_u64 s[52:53], 0
    s_cbranch_scc1 k2_slow_119
k2_fin_120:
    v_rcp_f32 v8, v7
    s_nop 0
    v_mul_f32 v64, v8, v64
    v_mul_f32 v65, v8, v65
    v_mul_f32 v66, v8, v66
    v_mul_f32 v67, v8, v67
    v_mul_f32 v68, v8, v68
    v_mul_f32 v69, v8, v69
    v_mul_f32 v70, v8, v70
    v_mul_f32 v71, v8, v71
    v_mul_f32 v72, v8, v72
    v_mul_f32 v73, v8, v73
    v_mul_f32 v74, v8, v74
    v_mul_f32 v75, v8, v75
    v_cvt_pk_bf16_f32 v106, v64, v65
    v_cvt_pk_bf16_f32 v107, v66, v67
    v_cvt_pk_bf16_f32 v108, v68, v69
    v_cvt_pk_bf16_f32 v109, v70, v71
    v_cvt_pk_bf16_f32 v110, v72, v73
    v_cvt_pk_bf16_f32 v111, v74, v75
    buffer_store_dwordx4 v[106:109], v5, s[16:19], s60 offen offset:0 sc1
    buffer_store_dwordx2 v[110:111], v6, s[16:19], s60 offen offset:0 sc1
    s_lshl_b32 s31, s63, 2
    s_add_u32 s31, s31, s22
    s_mul_i32 s32, s31, 1280
    s_cmp_eq_u32 s62, 0
    s_mov_b32 s33, 10485760
    s_mov_b32 s34, 13107200
    s_cselect_b32 s33, s33, s34
    s_add_u32 s32, s32, s33
    v_lshrrev_b32 v18, 4, v1
    v_and_b32 v19, 15, v1
    v_lshrrev_b32 v16, 1, v18
    v_mul_u32_u24 v16, 81920, v16
    v_and_b32 v17, 1, v18
    v_lshl_add_u32 v16, v17, 9, v16
    v_lshl_add_u32 v16, v19, 4, v16
    v_add_u32 v2, s32, v16
    v_mul_u32_u24 v16, 163840, v18
    v_lshl_add_u32 v16, v19, 3, v16
    v_add_u32 v16, s32, v16
    v_add_u32 v3, 1024, v16
    v_lshrrev_b32 v18, 5, v1
    v_lshlrev_b32 v18, 4, v18
    v_bfe_u32 v19, v1, 4, 1
    v_lshl_add_u32 v18, v19, 2, v18
    v_bfe_u32 v19, v1, 2, 2
    v_add_u32 v18, v18, v19
    v_mul_u32_u24 v18, 160, v18
    v_and_b32 v19, 3, v1
    v_lshl_add_u32 v18, v19, 3, v18
    v_add_u32 v4, 43008, v18
    v_add_u32 v11, 81920, v4
    v_lshrrev_b32 v18, 4, v1
    v_and_b32 v19, 15, v1
    s_lshl_b32 s41, s31, 5
    v_add_u32 v19, s41, v19
    v_mul_u32_u24 v19, 2560, v19
    s_mul_i32 s42, s62, 1280
    s_add_u32 s42, s42, s73
    v_add_u32 v19, s42, v19
    v_and_b32 v16, 1, v18
    v_lshlrev_b32 v16, 5, v16
    v_lshrrev_b32 v17, 1, v18
    v_lshl_add_u32 v16, v17, 4, v16
    v_add_u32 v6, v19, v16
    v_lshl_add_u32 v7, v18, 3, v19
    s_mov_b32 s43, 40960
    s_waitcnt vmcnt(0)
    s_barrier
    s_cmp_ge_u32 s22, 4
    s_cbranch_scc1 k23_rest_121
    s_cmp_lg_u32 s22, 0
    s_cbranch_scc1 k23_noflag_124
    s_lshl_b32 s23, s21, 5
    s_add_u32 s23, s23, s20
    s_lshl_b32 s23, s23, 7
    s_add_u32 s23, s23, 16711680
    v_mov_b32 v8, s23
    v_mov_b32 v9, 1
    s_mov_b64 exec, 1
    buffer_store_dword v9, v8, s[16:19], 0 offen sc1
    s_mov_b64 exec, -1
k23_noflag_124:
    s_lshr_b32 s23, s63, 1
    s_xor_b32 s24, s62, 1
    s_mul_i32 s24, s24, 8
    s_add_u32 s23, s23, s24
    s_lshl_b32 s23, s23, 12
    s_add_u32 s23, s23, 16711680
    v_and_b32 v8, 31, v1
    v_lshlrev_b32 v8, 7, v8
    v_add_u32 v8, s23, v8
    s_mov_b32 s24, 0
k23_poll_125:
    buffer_load_dword v9, v8, s[16:19], 0 offen sc1
    s_add_u32 s24, s24, 1
    s_waitcnt vmcnt(0)
    v_cmp_ne_u32 s[46:47], 1, v9
    s_nop 1
    s_cmp_eq_u64 s[46:47], 0
    s_cbranch_scc1 k23_ok_126
    s_sleep 8
    s_cmp_lt_u32 s24, 0x8000
    s_cbranch_scc1 k23_poll_125
k23_ok_126:
    s_lshl_b32 s84, s72, 1
    s_mov_b32 s84, 0
    s_mov_b32 s85, s84
    s_mul_i32 s40, s84, 163840
    s_add_u32 s84, s84, 1
    s_and_b32 s84, s84, 15
    buffer_load_dwordx4 v[76:79], v2, s[16:19], s40 offen offset:0 sc1
    buffer_load_dwordx4 v[80:83], v2, s[16:19], s40 offen offset:256 sc1
    s_mul_i32 s40, s84, 163840
    s_add_u32 s84, s84, 1
    s_and_b32 s84, s84, 15
    buffer_load_dwordx4 v[84:87], v2, s[16:19], s40 offen offset:0 sc1
    buffer_load_dwordx4 v[88:91], v2, s[16:19], s40 offen offset:256 sc1
    s_mul_i32 s40, s84, 163840
    s_add_u32 s84, s84, 1
    s_and_b32 s84, s84, 15
    buffer_load_dwordx4 v[92:95], v2, s[16:19], s40 offen offset:0 sc1
    buffer_load_dwordx4 v[96:99], v2, s[16:19], s40 offen offset:256 sc1
    s_mul_i32 s40, s84, 163840
    s_add_u32 s84, s84, 1
    s_and_b32 s84, s84, 15
    buffer_load_dwordx4 v[100:103], v2, s[16:19], s40 offen offset:0 sc1
    buffer_load_dwordx4 v[104:107], v2, s[16:19], s40 offen offset:256 sc1
    s_mul_i32 s40, s84, 163840
    s_add_u32 s84, s84, 1
    s_and_b32 s84, s84, 15
    buffer_load_dwordx4 v[108:111], v2, s[16:19], s40 offen offset:0 sc1
    buffer_load_dwordx4 v[112:115], v2, s[16:19], s40 offen offset:256 sc1
    s_mul_i32 s40, s84, 163840
    s_add_u32 s84, s84, 1
    s_and_b32 s84, s84, 15
    buffer_load_dwordx4 v[116:119], v2, s[16:19], s40 offen offset:0 sc1
    buffer_load_dwordx4 v[120:123], v2, s[16:19], s40 offen offset:256 sc1
    s_mul_i32 s40, s84, 163840
    s_add_u32 s84, s84, 1
    s_and_b32 s84, s84, 15
    buffer_load_dwordx4 v[124:127], v2, s[16:19], s40 offen offset:0 sc1
    buffer_load_dwordx4 v[128:131], v2, s[16:19], s40 offen offset:256 sc1
    s_mul_i32 s40, s84, 163840
    s_add_u32 s84, s84, 1
    s_and_b32 s84, s84, 15
    buffer_load_dwordx4 v[132:135], v2, s[16:19], s40 offen offset:0 sc1
    buffer_load_dwordx4 v[136:139], v2, s[16:19], s40 offen offset:256 sc1
    s_mul_i32 s41, s85, 5120
    s_add_u32 s85, s85, 1
    s_and_b32 s85, s85, 15
    v_add_u32 v10, s41, v4
    ds_read_b64_tr_b16 v[20:21], v10 offset:0
    ds_read_b64_tr_b16 v[22:23], v10 offset:1280
    ds_read_b64_tr_b16 v[24:25], v10 offset:32
    ds_read_b64_tr_b16 v[26:27], v10 offset:1312
    ds_read_b64_tr_b16 v[28:29], v10 offset:64
    ds_read_b64_tr_b16 v[30:31], v10 offset:1344
    s_waitcnt vmcnt(14)
    ds_read_b64_tr_b16 v[32:33], v10 offset:96
    ds_read_b64_tr_b16 v[34:35], v10 offset:1376
    s_waitcnt lgkmcnt(6)
    v_mfma_f32_16x16x32_bf16 v[36:39], v[20:23], v[76:79], 0
    v_mfma_f32_16x16x32_bf16 v[40:43], v[20:23], v[80:83], 0
    s_mul_i32 s40, s84, 163840
    s_add_u32 s84, s84, 1
    s_and_b32 s84, s84, 15
    buffer_load_dwordx4 v[140:143], v2, s[16:19], s40 offen offset:0 sc1
    ds_read_b64_tr_b16 v[20:21], v10 offset:128
    ds_read_b64_tr_b16 v[22:23], v10 offset:1408
    s_waitcnt lgkmcnt(6)
    v_mfma_f32_16x16x32_bf16 v[44:47], v[24:27], v[76:79], 0
    v_mfma_f32_16x16x32_bf16 v[48:51], v[24:27], v[80:83], 0
    buffer_load_dwordx4 v[144:147], v2, s[16:19], s40 offen offset:256 sc1
    s_mul_i32 s41, s85, 5120
    s_add_u32 s85, s85, 1
    s_and_b32 s85, s85, 15
    v_add_u32 v5, s41, v4
    ds_read_b64_tr_b16 v[24:25], v5 offset:0
    ds_read_b64_tr_b16 v[26:27], v5 offset:1280
    s_waitcnt lgkmcnt(6)
    v_mfma_f32_16x16x32_bf16 v[52:55], v[28:31], v[76:79], 0
    v_mfma_f32_16x16x32_bf16 v[56:59], v[28:31], v[80:83], 0
    s_mul_i32 s40, s84, 163840
    s_add_u32 s84, s84, 1
    s_and_b32 s84, s84, 15
    buffer_load_dwordx4 v[148:151], v2, s[16:19], s40 offen offset:0 sc1
    ds_read_b64_tr_b16 v[28:29], v5 offset:32
    ds_read_b64_tr_b16 v[30:31], v5 offset:1312
    s_waitcnt lgkmcnt(6)
    v_mfma_f32_16x16x32_bf16 v[60:63], v[32:35], v[76:79], 0
    v_mfma_f32_16x16x32_bf16 v[64:67], v[32:35], v[80:83], 0
    buffer_load_dwordx4 v[152:155], v2, s[16:19], s40 offen offset:256 sc1
    ds_read_b64_tr_b16 v[32:33], v5 offset:64
    ds_read_b64_tr_b16 v[34:35], v5 offset:1344
    s_waitcnt lgkmcnt(6)
    v_mfma_f32_16x16x32_bf16 v[68:71], v[20:23], v[76:79], 0
    v_mfma_f32_16x16x32_bf16 v[72:75], v[20:23], v[80:83], 0
    s_mul_i32 s40, s84, 163840
    s_add_u32 s84, s84, 1
    s_and_b32 s84, s84, 15
    buffer_load_dwordx4 v[76:79], v2, s[16:19], s40 offen offset:0 sc1
    s_waitcnt vmcnt(17)
    ds_read_b64_tr_b16 v[20:21], v5 offset:96
    ds_read_b64_tr_b16 v[22:23], v5 offset:1376
    s_waitcnt lgkmcnt(6)
    v_mfma_f32_16x16x32_bf16 v[36:39], v[24:27], v[84:87], v[36:39]
    v_mfma_f32_16x16x32_bf16 v[40:43], v[24:27], v[88:91], v[40:43]
    buffer_load_dwordx4 v[80:83], v2, s[16:19], s40 offen offset:256 sc1
    ds_read_b64_tr_b16 v[24:25], v5 offset:128
    ds_read_b64_tr_b16 v[26:27], v5 offset:1408
    s_waitcnt lgkmcnt(6)
    v_mfma_f32_16x16x32_bf16 v[44:47], v[28:31], v[84:87], v[44:47]
    v_mfma_f32_16x16x32_bf16 v[48:51], v[28:31], v[88:91], v[48:51]
    s_mul_i32 s41, s85, 5120
    s_add_u32 s85, s85, 1
    s_and_b32 s85, s85, 15
    v_add_u32 v10, s41, v4
    ds_read_b64_tr_b16 v[28:29], v10 offset:0
    ds_read_b64_tr_b16 v[30:31], v10 offset:1280
    s_waitcnt lgkmcnt(6)
    v_mfma_f32_16x16x32_bf16 v[52:55], v[32:35], v[84:87], v[52:55]
    v_mfma_f32_16x16x32_bf16 v[56:59], v[32:35], v[88:91], v[56:59]
    ds_read_b64_tr_b16 v[32:33], v10 offset:32
    ds_read_b64_tr_b16 v[34:35], v10 offset:1312
    s_waitcnt lgkmcnt(6)
    v_mfma_f32_16x16x32_bf16 v[60:63], v[20:23], v[84:87], v[60:63]
    v_mfma_f32_16x16x32_bf16 v[64:67], v[20:23], v[88:91], v[64:67]
    ds_read_b64_tr_b16 v[20:21], v10 offset:64
    ds_read_b64_tr_b16 v[22:23], v10 offset:1344
    s_waitcnt lgkmcnt(6)
    v_mfma_f32_16x16x32_bf16 v[68:71], v[24:27], v[84:87], v[68:71]
    v_mfma_f32_16x16x32_bf16 v[72:75], v[24:27], v[88:91], v[72:75]
    s_mul_i32 s40, s84, 163840
    s_add_u32 s84, s84, 1
    s_and_b32 s84, s84, 15
    buffer_load_dwordx4 v[84:87], v2, s[16:19], s40 offen offset:0 sc1
    s_waitcnt vmcnt(17)
    ds_read_b64_tr_b16 v[24:25], v10 offset:96
    ds_read_b64_tr_b16 v[26:27], v10 offset:1376
    s_waitcnt lgkmcnt(6)
    v_mfma_f32_16x16x32_bf16 v[36:39], v[28:31], v[92:95], v[36:39]
    v_mfma_f32_16x16x32_bf16 v[40:43], v[28:31], v[96:99], v[40:43]
    buffer_load_dwordx4 v[88:91], v2, s[16:19], s40 offen offset:256 sc1
    ds_read_b64_tr_b16 v[28:29], v10 offset:128
    ds_read_b64_tr_b16 v[30:31], v10 offset:1408
    s_waitcnt lgkmcnt(6)
    v_mfma_f32_16x16x32_bf16 v[44:47], v[32:35], v[92:95], v[44:47]
    v_mfma_f32_16x16x32_bf16 v[48:51], v[32:35], v[96:99], v[48:51]
    s_mul_i32 s41, s85, 5120
    s_add_u32 s85, s85, 1
    s_and_b32 s85, s85, 15
    v_add_u32 v5, s41, v4
    ds_read_b64_tr_b16 v[32:33], v5 offset:0
    ds_read_b64_tr_b16 v[34:35], v5 offset:1280
    s_waitcnt lgkmcnt(6)
    v_mfma_f32_16x16x32_bf16 v[52:55], v[20:23], v[92:95], v[52:55]
    v_mfma_f32_16x16x32_bf16 v[56:59], v[20:23], v[96:99], v[56:59]
    ds_read_b64_tr_b16 v[20:21], v5 offset:32
    ds_read_b64_tr_b16 v[22:23], v5 offset:1312
    s_waitcnt lgkmcnt(6)
    v_mfma_f32_16x16x32_bf16 v[60:63], v[24:27], v[92:95], v[60:63]
    v_mfma_f32_16x16x32_bf16 v[64:67], v[24:27], v[96:99], v[64:67]
    ds_read_b64_tr_b16 v[24:25], v5 offset:64
    ds_read_b64_tr_b16 v[26:27], v5 offset:1344
    s_waitcnt lgkmcnt(6)
    v_mfma_f32_16x16x32_bf16 v[68:71], v[28:31], v[92:95], v[68:71]
    v_mfma_f32_16x16x32_bf16 v[72:75], v[28:31], v[96:99], v[72:75]
    s_mul_i32 s40, s84, 163840
    s_add_u32 s84, s84, 1
    s_and_b32 s84, s84, 15
    buffer_load_dwordx4 v[92:95], v2, s[16:19], s40 offen offset:0 sc1
    s_waitcnt vmcnt(17)
    ds_read_b64_tr_b16 v[28:29], v5 offset:96
    ds_read_b64_tr_b16 v[30:31], v5 offset:1376
    s_waitcnt lgkmcnt(6)
    v_mfma_f32_16x16x32_bf16 v[36:39], v[32:35], v[100:103], v[36:39]
    v_mfma_f32_16x16x32_bf16 v[40:43], v[32:35], v[104:107], v[40:43]
    buffer_load_dwordx4 v[96:99], v2, s[16:19], s40 offen offset:256 sc1
    ds_read_b64_tr_b16 v[32:33], v5 offset:128
    ds_read_b64_tr_b16 v[34:35], v5 offset:1408
    s_waitcnt lgkmcnt(6)
    v_mfma_f32_16x16x32_bf16 v[44:47], v[20:23], v[100:103], v[44:47]
    v_mfma_f32_16x16x32_bf16 v[48:51], v[20:23], v[104:107], v[48:51]
    s_mul_i32 s41, s85, 5120
    s_add_u32 s85, s85, 1
    s_and_b32 s85, s85, 15
    v_add_u32 v10, s41, v4
    ds_read_b64_tr_b16 v[20:21], v10 offset:0
    ds_read_b64_tr_b16 v[22:23], v10 offset:1280
    s_waitcnt lgkmcnt(6)
    v_mfma_f32_16x16x32_bf16 v[52:55], v[24:27], v[100:103], v[52:55]
    v_mfma_f32_16x16x32_bf16 v[56:59], v[24:27], v[104:107], v[56:59]
    ds_read_b64_tr_b16 v[24:25], v10 offset:32
    ds_read_b64_tr_b16 v[26:27], v10 offset:1312
    s_waitcnt lgkmcnt(6)
    v_mfma_f32_16x16x32_bf16 v[60:63], v[28:31], v[100:103], v[60:63]
    v_mfma_f32_16x16x32_bf16 v[64:67], v[28:31], v[104:107], v[64:67]
    ds_read_b64_tr_b16 v[28:29], v10 offset:64
    ds_read_b64_tr_b16 v[30:31], v10 offset:1344
    s_waitcnt lgkmcnt(6)
    v_mfma_f32_16x16x32_bf16 v[68:71], v[32:35], v[100:103], v[68:71]
    v_mfma_f32_16x16x32_bf16 v[72:75], v[32:35], v[104:107], v[72:75]
    s_mul_i32 s40, s84, 163840
    s_add_u32 s84, s84, 1
    s_and_b32 s84, s84, 15
    buffer_load_dwordx4 v[100:103], v2, s[16:19], s40 offen offset:0 sc1
    s_waitcnt vmcnt(17)
    ds_read_b64_tr_b16 v[32:33], v10 offset:96
    ds_read_b64_tr_b16 v[34:35], v10 offset:1376
    s_waitcnt lgkmcnt(6)
    v_mfma_f32_16x16x32_bf16 v[36:39], v[20:23], v[108:111], v[36:39]
    v_mfma_f32_16x16x32_bf16 v[40:43], v[20:23], v[112:115], v[40:43]
    buffer_load_dwordx4 v[104:107], v2, s[16:19], s40 offen offset:256 sc1
    ds_read_b64_tr_b16 v[20:21], v10 offset:128
    ds_read_b64_tr_b16 v[22:23], v10 offset:1408
    s_waitcnt lgkmcnt(6)
    v_mfma_f32_16x16x32_bf16 v[44:47], v[24:27], v[108:111], v[44:47]
    v_mfma_f32_16x16x32_bf16 v[48:51], v[24:27], v[112:115], v[48:51]
    s_mul_i32 s41, s85, 5120
    s_add_u32 s85, s85, 1
    s_and_b32 s85, s85, 15
    v_add_u32 v5, s41, v4
    ds_read_b64_tr_b16 v[24:25], v5 offset:0
    ds_read_b64_tr_b16 v[26:27], v5 offset:1280
    s_waitcnt lgkmcnt(6)
    v_mfma_f32_16x16x32_bf16 v[52:55], v[28:31], v[108:111], v[52:55]
    v_mfma_f32_16x16x32_bf16 v[56:59], v[28:31], v[112:115], v[56:59]
    ds_read_b64_tr_b16 v[28:29], v5 offset:32
    ds_read_b64_tr_b16 v[30:31], v5 offset:1312
    s_waitcnt lgkmcnt(6)
    v_mfma_f32_16x16x32_bf16 v[60:63], v[32:35], v[108:111], v[60:63]
    v_mfma_f32_16x16x32_bf16 v[64:67], v[32:35], v[112:115], v[64:67]
    ds_read_b64_tr_b16 v[32:33], v5 offset:64
    ds_read_b64_tr_b16 v[34:35], v5 offset:1344
    s_waitcnt lgkmcnt(6)
    v_mfma_f32_16x16x32_bf16 v[68:71], v[20:23], v[108:111], v[68:71]
    v_mfma_f32_16x16x32_bf16 v[72:75], v[20:23], v[112:115], v[72:75]
    s_mul_i32 s40, s84, 163840
    s_add_u32 s84, s84, 1
    s_and_b32 s84, s84, 15
    buffer_load_dwordx4 v[108:111], v2, s[16:19], s40 offen offset:0 sc1
    s_waitcnt vmcnt(17)
    ds_read_b64_tr_b16 v[20:21], v5 offset:96
    ds_read_b64_tr_b16 v[22:23], v5 offset:1376
    s_waitcnt lgkmcnt(6)
    v_mfma_f32_16x16x32_bf16 v[36:39], v[24:27], v[116:119], v[36:39]
    v_mfma_f32_16x16x32_bf16 v[40:43], v[24:27], v[120:123], v[40:43]
    buffer_load_dwordx4 v[112:115], v2, s[16:19], s40 offen offset:256 sc1
    ds_read_b64_tr_b16 v[24:25], v5 offset:128
    ds_read_b64_tr_b16 v[26:27], v5 offset:1408
    s_waitcnt lgkmcnt(6)
    v_mfma_f32_16x16x32_bf16 v[44:47], v[28:31], v[116:119], v[44:47]
    v_mfma_f32_16x16x32_bf16 v[48:51], v[28:31], v[120:123], v[48:51]
    s_mul_i32 s41, s85, 5120
    s_add_u32 s85, s85, 1
    s_and_b32 s85, s85, 15
    v_add_u32 v10, s41, v4
    ds_read_b64_tr_b16 v[28:29], v10 offset:0
    ds_read_b64_tr_b16 v[30:31], v10 offset:1280
    s_waitcnt lgkmcnt(6)
    v_mfma_f32_16x16x32_bf16 v[52:55], v[32:35], v[116:119], v[52:55]
    v_mfma_f32_16x16x32_bf16 v[56:59], v[32:35], v[120:123], v[56:59]
    ds_read_b64_tr_b16 v[32:33], v10 offset:32
    ds_read_b64_tr_b16 v[34:35], v10 offset:1312
    s_waitcnt lgkmcnt(6)
    v_mfma_f32_16x16x32_bf16 v[60:63], v[20:23], v[116:119], v[60:63]
    v_mfma_f32_16x16x32_bf16 v[64:67], v[20:23], v[120:123], v[64:67]
    ds_read_b64_tr_b16 v[20:21], v10 offset:64
    ds_read_b64_tr_b16 v[22:23], v10 offset:1344
    s_waitcnt lgkmcnt(6)
    v_mfma_f32_16x16x32_bf16 v[68:71], v[24:27], v[116:119], v[68:71]
    v_mfma_f32_16x16x32_bf16 v[72:75], v[24:27], v[120:123], v[72:75]
    s_mul_i32 s40, s84, 163840
    s_add_u32 s84, s84, 1
    s_and_b32 s84, s84, 15
    buffer_load_dwordx4 v[116:119], v2, s[16:19], s40 offen offset:0 sc1
    s_waitcnt vmcnt(17)
    ds_read_b64_tr_b16 v[24:25], v10 offset:96
    ds_read_b64_tr_b16 v[26:27], v10 offset:1376
    s_waitcnt lgkmcnt(6)
    v_mfma_f32_16x16x32_bf16 v[36:39], v[28:31], v[124:127], v[36:39]
    v_mfma_f32_16x16x32_bf16 v[40:43], v[28:31], v[128:131], v[40:43]
    buffer_load_dwordx4 v[120:123], v2, s[16:19], s40 offen offset:256 sc1
    ds_read_b64_tr_b16 v[28:29], v10 offset:128
    ds_read_b64_tr_b16 v[30:31], v10 offset:1408
    s_waitcnt lgkmcnt(6)
    v_mfma_f32_16x16x32_bf16 v[44:47], v[32:35], v[124:127], v[44:47]
    v_mfma_f32_16x16x32_bf16 v[48:51], v[32:35], v[128:131], v[48:51]
    s_mul_i32 s41, s85, 5120
    s_add_u32 s85, s85, 1
    s_and_b32 s85, s85, 15
    v_add_u32 v5, s41, v4
    ds_read_b64_tr_b16 v[32:33], v5 offset:0
    ds_read_b64_tr_b16 v[34:35], v5 offset:1280
    s_waitcnt lgkmcnt(6)
    v_mfma_f32_16x16x32_bf16 v[52:55], v[20:23], v[124:127], v[52:55]
    v_mfma_f32_16x16x32_bf16 v[56:59], v[20:23], v[128:131], v[56:59]
    ds_read_b64_tr_b16 v[20:21], v5 offset:32
    ds_read_b64_tr_b16 v[22:23], v5 offset:1312
    s_waitcnt lgkmcnt(6)
    v_mfma_f32_16x16x32_bf16 v[60:63], v[24:27], v[124:127], v[60:63]
    v_mfma_f32_16x16x32_bf16 v[64:67], v[24:27], v[128:131], v[64:67]
    ds_read_b64_tr_b16 v[24:25], v5 offset:64
    ds_read_b64_tr_b16 v[26:27], v5 offset:1344
    s_waitcnt lgkmcnt(6)
    v_mfma_f32_16x16x32_bf16 v[68:71], v[28:31], v[124:127], v[68:71]
    v_mfma_f32_16x16x32_bf16 v[72:75], v[28:31], v[128:131], v[72:75]
    s_mov_b32 s40, 0
    buffer_load_dwordx2 v[124:125], v3, s[16:19], s40 offen offset:0 sc1
    s_waitcnt vmcnt(17)
    ds_read_b64_tr_b16 v[28:29], v5 offset:96
    ds_read_b64_tr_b16 v[30:31], v5 offset:1376
    s_waitcnt lgkmcnt(6)
    v_mfma_f32_16x16x32_bf16 v[36:39], v[32:35], v[132:135], v[36:39]
    v_mfma_f32_16x16x32_bf16 v[40:43], v[32:35], v[136:139], v[40:43]
    buffer_load_dwordx2 v[128:129], v3, s[16:19], s40 offen offset:128 sc1
    ds_read_b64_tr_b16 v[32:33], v5 offset:128
    ds_read_b64_tr_b16 v[34:35], v5 offset:1408
    s_waitcnt lgkmcnt(6)
    v_mfma_f32_16x16x32_bf16 v[44:47], v[20:23], v[132:135], v[44:47]
    v_mfma_f32_16x16x32_bf16 v[48:51], v[20:23], v[136:139], v[48:51]
    s_mov_b32 s40, 81920
    buffer_load_dwordx2 v[126:127], v3, s[16:19], s40 offen offset:0 sc1
    s_mul_i32 s41, s85, 5120
    s_add_u32 s85, s85, 1
    s_and_b32 s85, s85, 15
    v_add_u32 v10, s41, v4
    ds_read_b64_tr_b16 v[20:21], v10 offset:0
    ds_read_b64_tr_b16 v[22:23], v10 offset:1280
    s_waitcnt lgkmcnt(6)
    v_mfma_f32_16x16x32_bf16 v[52:55], v[24:27], v[132:135], v[52:55]
    v_mfma_f32_16x16x32_bf16 v[56:59], v[24:27], v[136:139], v[56:59]
    buffer_load_dwordx2 v[130:131], v3, s[16:19], s40 offen offset:128 sc1
    ds_read_b64_tr_b16 v[24:25], v10 offset:32
    ds_read_b64_tr_b16 v[26:27], v10 offset:1312
    s_waitcnt lgkmcnt(6)
    v_mfma_f32_16x16x32_bf16 v[60:63], v[28:31], v[132:135], v[60:63]
    v_mfma_f32_16x16x32_bf16 v[64:67], v[28:31], v[136:139], v[64:67]
    ds_read_b64_tr_b16 v[28:29], v10 offset:64
    ds_read_b64_tr_b16 v[30:31], v10 offset:1344
    s_waitcnt lgkmcnt(6)
    v_mfma_f32_16x16x32_bf16 v[68:71], v[32:35], v[132:135], v[68:71]
    v_mfma_f32_16x16x32_bf16 v[72:75], v[32:35], v[136:139], v[72:75]
    s_mov_b32 s40, 655360
    buffer_load_dwordx2 v[132:133], v3, s[16:19], s40 offen offset:0 sc1
    s_waitcnt vmcnt(19)
    ds_read_b64_tr_b16 v[32:33], v10 offset:96
    ds_read_b64_tr_b16 v[34:35], v10 offset:1376
    s_waitcnt lgkmcnt(6)
    v_mfma_f32_16x16x32_bf16 v[36:39], v[20:23], v[140:143], v[36:39]
    v_mfma_f32_16x16x32_bf16 v[40:43], v[20:23], v[144:147], v[40:43]
    buffer_load_dwordx2 v[136:137], v3, s[16:19], s40 offen offset:128 sc1
    ds_read_b64_tr_b16 v[20:21], v10 offset:128
    ds_read_b64_tr_b16 v[22:23], v10 offset:1408
    s_waitcnt lgkmcnt(6)
    v_mfma_f32_16x16x32_bf16 v[44:47], v[24:27], v[140:143], v[44:47]
    v_mfma_f32_16x16x32_bf16 v[48:51], v[24:27], v[144:147], v[48:51]
    s_mov_b32 s40, 737280
    buffer_load_dwordx2 v[134:135], v3, s[16:19], s40 offen offset:0 sc1
    s_mul_i32 s41, s85, 5120
    s_add_u32 s85, s85, 1
    s_and_b32 s85, s85, 15
    v_add_u32 v5, s41, v4
    ds_read_b64_tr_b16 v[24:25], v5 offset:0
    ds_read_b64_tr_b16 v[26:27], v5 offset:1280
    s_waitcnt lgkmcnt(6)
    v_mfma_f32_16x16x32_bf16 v[52:55], v[28:31], v[140:143], v[52:55]
    v_mfma_f32_16x16x32_bf16 v[56:59], v[28:31], v[144:147], v[56:59]
    buffer_load_dwordx2 v[138:139], v3, s[16:19], s40 offen offset:128 sc1
    ds_read_b64_tr_b16 v[28:29], v5 offset:32
    ds_read_b64_tr_b16 v[30:31], v5 offset:1312
    s_waitcnt lgkmcnt(6)
    v_mfma_f32_16x16x32_bf16 v[60:63], v[32:35], v[140:143], v[60:63]
    v_mfma_f32_16x16x32_bf16 v[64:67], v[32:35], v[144:147], v[64:67]
    ds_read_b64_tr_b16 v[32:33], v5 offset:64
    ds_read_b64_tr_b16 v[34:35], v5 offset:1344
    s_waitcnt lgkmcnt(6)
    v_mfma_f32_16x16x32_bf16 v[68:71], v[20:23], v[140:143], v[68:71]
    v_mfma_f32_16x16x32_bf16 v[72:75], v[20:23], v[144:147], v[72:75]
    s_mov_b32 s40, 1310720
    buffer_load_dwordx2 v[140:141], v3, s[16:19], s40 offen offset:0 sc1
    s_waitcnt vmcnt(21)
    ds_read_b64_tr_b16 v[20:21], v5 offset:96
    ds_read_b64_tr_b16 v[22:23], v5 offset:1376
    s_waitcnt lgkmcnt(6)
    v_mfma_f32_16x16x32_bf16 v[36:39], v[24:27], v[148:151], v[36:39]
    v_mfma_f32_16x16x32_bf16 v[40:43], v[24:27], v[152:155], v[40:43]
    buffer_load_dwordx2 v[144:145], v3, s[16:19], s40 offen offset:128 sc1
    ds_read_b64_tr_b16 v[24:25], v5 offset:128
    ds_read_b64_tr_b16 v[26:27], v5 offset:1408
    s_waitcnt lgkmcnt(6)
    v_mfma_f32_16x16x32_bf16 v[44:47], v[28:31], v[148:151], v[44:47]
    v_mfma_f32_16x16x32_bf16 v[48:51], v[28:31], v[152:155], v[48:51]
    s_mov_b32 s40, 1392640
    buffer_load_dwordx2 v[142:143], v3, s[16:19], s40 offen offset:0 sc1
    s_mul_i32 s41, s85, 5120
    s_add_u32 s85, s85, 1
    s_and_b32 s85, s85, 15
    v_add_u32 v10, s41, v4
    ds_read_b64_tr_b16 v[28:29], v10 offset:0
    ds_read_b64_tr_b16 v[30:31], v10 offset:1280
    s_waitcnt lgkmcnt(6)
    v_mfma_f32_16x16x32_bf16 v[52:55], v[32:35], v[148:151], v[52:55]
    v_mfma_f32_16x16x32_bf16 v[56:59], v[32:35], v[152:155], v[56:59]
    buffer_load_dwordx2 v[146:147], v3, s[16:19], s40 offen offset:128 sc1
    ds_read_b64_tr_b16 v[32:33], v10 offset:32
    ds_read_b64_tr_b16 v[34:35], v10 offset:1312
    s_waitcnt lgkmcnt(6)
    v_mfma_f32_16x16x32_bf16 v[60:63], v[20:23], v[148:151], v[60:63]
    v_mfma_f32_16x16x32_bf16 v[64:67], v[20:23], v[152:155], v[64:67]
    ds_read_b64_tr_b16 v[20:21], v10 offset:64
    ds_read_b64_tr_b16 v[22:23], v10 offset:1344
    s_waitcnt lgkmcnt(6)
    v_mfma_f32_16x16x32_bf16 v[68:71], v[24:27], v[148:151], v[68:71]
    v_mfma_f32_16x16x32_bf16 v[72:75], v[24:27], v[152:155], v[72:75]
    s_mov_b32 s40, 1966080
    buffer_load_dwordx2 v[148:149], v3, s[16:19], s40 offen offset:0 sc1
    s_waitcnt vmcnt(23)
    ds_read_b64_tr_b16 v[24:25], v10 offset:96
    ds_read_b64_tr_b16 v[26:27], v10 offset:1376
    s_waitcnt lgkmcnt(6)
    v_mfma_f32_16x16x32_bf16 v[36:39], v[28:31], v[76:79], v[36:39]
    v_mfma_f32_16x16x32_bf16 v[40:43], v[28:31], v[80:83], v[40:43]
    buffer_load_dwordx2 v[152:153], v3, s[16:19], s40 offen offset:128 sc1
    ds_read_b64_tr_b16 v[28:29], v10 offset:128
    ds_read_b64_tr_b16 v[30:31], v10 offset:1408
    s_waitcnt lgkmcnt(6)
    v_mfma_f32_16x16x32_bf16 v[44:47], v[32:35], v[76:79], v[44:47]
    v_mfma_f32_16x16x32_bf16 v[48:51], v[32:35], v[80:83], v[48:51]
    s_mov_b32 s40, 2048000
    buffer_load_dwordx2 v[150:151], v3, s[16:19], s40 offen offset:0 sc1
    s_mul_i32 s41, s85, 5120
    s_add_u32 s85, s85, 1
    s_and_b32 s85, s85, 15
    v_add_u32 v5, s41, v4
    ds_read_b64_tr_b16 v[32:33], v5 offset:0
    ds_read_b64_tr_b16 v[34:35], v5 offset:1280
    s_waitcnt lgkmcnt(6)
    v_mfma_f32_16x16x32_bf16 v[52:55], v[20:23], v[76:79], v[52:55]
    v_mfma_f32_16x16x32_bf16 v[56:59], v[20:23], v[80:83], v[56:59]
    buffer_load_dwordx2 v[154:155], v3, s[16:19], s40 offen offset:128 sc1
    ds_read_b64_tr_b16 v[20:21], v5 offset:32
    ds_read_b64_tr_b16 v[22:23], v5 offset:1312
    s_waitcnt lgkmcnt(6)
    v_mfma_f32_16x16x32_bf16 v[60:63], v[24:27], v[76:79], v[60:63]
    v_mfma_f32_16x16x32_bf16 v[64:67], v[24:27], v[80:83], v[64:67]
    ds_read_b64_tr_b16 v[24:25], v5 offset:64
    ds_read_b64_tr_b16 v[26:27], v5 offset:1344
    s_waitcnt lgkmcnt(6)
    v_mfma_f32_16x16x32_bf16 v[68:71], v[28:31], v[76:79], v[68:71]
    v_mfma_f32_16x16x32_bf16 v[72:75], v[28:31], v[80:83], v[72:75]
    s_waitcnt vmcnt(24)
    ds_read_b64_tr_b16 v[28:29], v5 offset:96
    ds_read_b64_tr_b16 v[30:31], v5 offset:1376
    s_waitcnt lgkmcnt(6)
    v_mfma_f32_16x16x32_bf16 v[36:39], v[32:35], v[84:87], v[36:39]
    v_mfma_f32_16x16x32_bf16 v[40:43], v[32:35], v[88:91], v[40:43]
    ds_read_b64_tr_b16 v[32:33], v5 offset:128
    ds_read_b64_tr_b16 v[34:35], v5 offset:1408
    s_waitcnt lgkmcnt(6)
    v_mfma_f32_16x16x32_bf16 v[44:47], v[20:23], v[84:87], v[44:47]
    v_mfma_f32_16x16x32_bf16 v[48:51], v[20:23], v[88:91], v[48:51]
    s_mul_i32 s41, s85, 5120
    s_add_u32 s85, s85, 1
    s_and_b32 s85, s85, 15
    v_add_u32 v10, s41, v4
    ds_read_b64_tr_b16 v[20:21], v10 offset:0
    ds_read_b64_tr_b16 v[22:23], v10 offset:1280
    s_waitcnt lgkmcnt(6)
    v_mfma_f32_16x16x32_bf16 v[52:55], v[24:27], v[84:87], v[52:55]
    v_mfma_f32_16x16x32_bf16 v[56:59], v[24:27], v[88:91], v[56:59]
    ds_read_b64_tr_b16 v[24:25], v10 offset:32
    ds_read_b64_tr_b16 v[26:27], v10 offset:1312
    s_waitcnt lgkmcnt(6)
    v_mfma_f32_16x16x32_bf16 v[60:63], v[28:31], v[84:87], v[60:63]
    v_mfma_f32_16x16x32_bf16 v[64:67], v[28:31], v[88:91], v[64:67]
    ds_read_b64_tr_b16 v[28:29], v10 offset:64
    ds_read_b64_tr_b16 v[30:31], v10 offset:1344
    s_waitcnt lgkmcnt(6)
    v_mfma_f32_16x16x32_bf16 v[68:71], v[32:35], v[84:87], v[68:71]
    v_mfma_f32_16x16x32_bf16 v[72:75], v[32:35], v[88:91], v[72:75]
    s_waitcnt vmcnt(22)
    ds_read_b64_tr_b16 v[32:33], v10 offset:96
    ds_read_b64_tr_b16 v[34:35], v10 offset:1376
    s_waitcnt lgkmcnt(6)
    v_mfma_f32_16x16x32_bf16 v[36:39], v[20:23], v[92:95], v[36:39]
    v_mfma_f32_16x16x32_bf16 v[40:43], v[20:23], v[96:99], v[40:43]
    ds_read_b64_tr_b16 v[20:21], v10 offset:128
    ds_read_b64_tr_b16 v[22:23], v10 offset:1408
    s_waitcnt lgkmcnt(6)
    v_mfma_f32_16x16x32_bf16 v[44:47], v[24:27], v[92:95], v[44:47]
    v_mfma_f32_16x16x32_bf16 v[48:51], v[24:27], v[96:99], v[48:51]
    s_mul_i32 s41, s85, 5120
    s_add_u32 s85, s85, 1
    s_and_b32 s85, s85, 15
    v_add_u32 v5, s41, v4
    ds_read_b64_tr_b16 v[24:25], v5 offset:0
    ds_read_b64_tr_b16 v[26:27], v5 offset:1280
    s_waitcnt lgkmcnt(6)
    v_mfma_f32_16x16x32_bf16 v[52:55], v[28:31], v[92:95], v[52:55]
    v_mfma_f32_16x16x32_bf16 v[56:59], v[28:31], v[96:99], v[56:59]
    ds_read_b64_tr_b16 v[28:29], v5 offset:32
    ds_read_b64_tr_b16 v[30:31], v5 offset:1312
    s_waitcnt lgkmcnt(6)
    v_mfma_f32_16x16x32_bf16 v[60:63], v[32:35], v[92:95], v[60:63]
    v_mfma_f32_16x16x32_bf16 v[64:67], v[32:35], v[96:99], v[64:67]
    ds_read_b64_tr_b16 v[32:33], v5 offset:64
    ds_read_b64_tr_b16 v[34:35], v5 offset:1344
    s_waitcnt lgkmcnt(6)
    v_mfma_f32_16x16x32_bf16 v[68:71], v[20:23], v[92:95], v[68:71]
    v_mfma_f32_16x16x32_bf16 v[72:75], v[20:23], v[96:99], v[72:75]
    s_waitcnt vmcnt(20)
    ds_read_b64_tr_b16 v[20:21], v5 offset:96
    ds_read_b64_tr_b16 v[22:23], v5 offset:1376
    s_waitcnt lgkmcnt(6)
    v_mfma_f32_16x16x32_bf16 v[36:39], v[24:27], v[100:103], v[36:39]
    v_mfma_f32_16x16x32_bf16 v[40:43], v[24:27], v[104:107], v[40:43]
    ds_read_b64_tr_b16 v[24:25], v5 offset:128
    ds_read_b64_tr_b16 v[26:27], v5 offset:1408
    s_waitcnt lgkmcnt(6)
    v_mfma_f32_16x16x32_bf16 v[44:47], v[28:31], v[100:103], v[44:47]
    v_mfma_f32_16x16x32_bf16 v[48:51], v[28:31], v[104:107], v[48:51]
    s_mul_i32 s41, s85, 5120
    s_add_u32 s85, s85, 1
    s_and_b32 s85, s85, 15
    v_add_u32 v10, s41, v4
    ds_read_b64_tr_b16 v[28:29], v10 offset:0
    ds_read_b64_tr_b16 v[30:31], v10 offset:1280
    s_waitcnt lgkmcnt(6)
    v_mfma_f32_16x16x32_bf16 v[52:55], v[32:35], v[100:103], v[52:55]
    v_mfma_f32_16x16x32_bf16 v[56:59], v[32:35], v[104:107], v[56:59]
    ds_read_b64_tr_b16 v[32:33], v10 offset:32
    ds_read_b64_tr_b16 v[34:35], v10 offset:1312
    s_waitcnt lgkmcnt(6)
    v_mfma_f32_16x16x32_bf16 v[60:63], v[20:23], v[100:103], v[60:63]
    v_mfma_f32_16x16x32_bf16 v[64:67], v[20:23], v[104:107], v[64:67]
    ds_read_b64_tr_b16 v[20:21], v10 offset:64
    ds_read_b64_tr_b16 v[22:23], v10 offset:1344
    s_waitcnt lgkmcnt(6)
    v_mfma_f32_16x16x32_bf16 v[68:71], v[24:27], v[100:103], v[68:71]
    v_mfma_f32_16x16x32_bf16 v[72:75], v[24:27], v[104:107], v[72:75]
    s_waitcnt vmcnt(18)
    ds_read_b64_tr_b16 v[24:25], v10 offset:96
    ds_read_b64_tr_b16 v[26:27], v10 offset:1376
    s_waitcnt lgkmcnt(6)
    v_mfma_f32_16x16x32_bf16 v[36:39], v[28:31], v[108:111], v[36:39]
    v_mfma_f32_16x16x32_bf16 v[40:43], v[28:31], v[112:115], v[40:43]
    ds_read_b64_tr_b16 v[28:29], v10 offset:128
    ds_read_b64_tr_b16 v[30:31], v10 offset:1408
    s_waitcnt lgkmcnt(6)
    v_mfma_f32_16x16x32_bf16 v[44:47], v[32:35], v[108:111], v[44:47]
    v_mfma_f32_16x16x32_bf16 v[48:51], v[32:35], v[112:115], v[48:51]
    s_mul_i32 s41, s85, 5120
    s_add_u32 s85, s85, 1
    s_and_b32 s85, s85, 15
    v_add_u32 v5, s41, v4
    ds_read_b64_tr_b16 v[32:33], v5 offset:0
    ds_read_b64_tr_b16 v[34:35], v5 offset:1280
    s_waitcnt lgkmcnt(6)
    v_mfma_f32_16x16x32_bf16 v[52:55], v[20:23], v[108:111], v[52:55]
    v_mfma_f32_16x16x32_bf16 v[56:59], v[20:23], v[112:115], v[56:59]
    ds_read_b64_tr_b16 v[20:21], v5 offset:32
    ds_read_b64_tr_b16 v[22:23], v5 offset:1312
    s_waitcnt lgkmcnt(6)
    v_mfma_f32_16x16x32_bf16 v[60:63], v[24:27], v[108:111], v[60:63]
    v_mfma_f32_16x16x32_bf16 v[64:67], v[24:27], v[112:115], v[64:67]
    ds_read_b64_tr_b16 v[24:25], v5 offset:64
    ds_read_b64_tr_b16 v[26:27], v5 offset:1344
    s_waitcnt lgkmcnt(6)
    v_mfma_f32_16x16x32_bf16 v[68:71], v[28:31], v[108:111], v[68:71]
    v_mfma_f32_16x16x32_bf16 v[72:75], v[28:31], v[112:115], v[72:75]
    s_waitcnt vmcnt(16)
    ds_read_b64_tr_b16 v[28:29], v5 offset:96
    ds_read_b64_tr_b16 v[30:31], v5 offset:1376
    s_waitcnt lgkmcnt(6)
    v_mfma_f32_16x16x32_bf16 v[36:39], v[32:35], v[116:119], v[36:39]
    v_mfma_f32_16x16x32_bf16 v[40:43], v[32:35], v[120:123], v[40:43]
    ds_read_b64_tr_b16 v[32:33], v5 offset:128
    ds_read_b64_tr_b16 v[34:35], v5 offset:1408
    s_waitcnt lgkmcnt(6)
    v_mfma_f32_16x16x32_bf16 v[44:47], v[20:23], v[116:119], v[44:47]
    v_mfma_f32_16x16x32_bf16 v[48:51], v[20:23], v[120:123], v[48:51]
    ds_read_b64_tr_b16 v[20:21], v11 offset:0
    ds_read_b64_tr_b16 v[22:23], v11 offset:1280
    s_waitcnt lgkmcnt(6)
    v_mfma_f32_16x16x32_bf16 v[52:55], v[24:27], v[116:119], v[52:55]
    v_mfma_f32_16x16x32_bf16 v[56:59], v[24:27], v[120:123], v[56:59]
    ds_read_b64_tr_b16 v[24:25], v11 offset:32
    ds_read_b64_tr_b16 v[26:27], v11 offset:1312
    s_waitcnt lgkmcnt(6)
    v_mfma_f32_16x16x32_bf16 v[60:63], v[28:31], v[116:119], v[60:63]
    v_mfma_f32_16x16x32_bf16 v[64:67], v[28:31], v[120:123], v[64:67]
    ds_read_b64_tr_b16 v[28:29], v11 offset:64
    ds_read_b64_tr_b16 v[30:31], v11 offset:1344
    s_waitcnt lgkmcnt(6)
    v_mfma_f32_16x16x32_bf16 v[68:71], v[32:35], v[116:119], v[68:71]
    v_mfma_f32_16x16x32_bf16 v[72:75], v[32:35], v[120:123], v[72:75]
    s_waitcnt vmcnt(12)
    ds_read_b64_tr_b16 v[32:33], v11 offset:96
    ds_read_b64_tr_b16 v[34:35], v11 offset:1376
    s_waitcnt lgkmcnt(6)
    v_mfma_f32_16x16x32_bf16 v[36:39], v[20:23], v[124:127], v[36:39]
    v_mfma_f32_16x16x32_bf16 v[40:43], v[20:23], v[128:131], v[40:43]
    ds_read_b64_tr_b16 v[20:21], v11 offset:128
    ds_read_b64_tr_b16 v[22:23], v11 offset:1408
    s_waitcnt lgkmcnt(6)
    v_mfma_f32_16x16x32_bf16 v[44:47], v[24:27], v[124:127], v[44:47]
    v_mfma_f32_16x16x32_bf16 v[48:51], v[24:27], v[128:131], v[48:51]
    ds_read_b64_tr_b16 v[24:25], v11 offset:5120
    ds_read_b64_tr_b16 v[26:27], v11 offset:6400
    s_waitcnt lgkmcnt(6)
    v_mfma_f32_16x16x32_bf16 v[52:55], v[28:31], v[124:127], v[52:55]
    v_mfma_f32_16x16x32_bf16 v[56:59], v[28:31], v[128:131], v[56:59]
    ds_read_b64_tr_b16 v[28:29], v11 offset:5152
    ds_read_b64_tr_b16 v[30:31], v11 offset:6432
    s_waitcnt lgkmcnt(6)
    v_mfma_f32_16x16x32_bf16 v[60:63], v[32:35], v[124:127], v[60:63]
    v_mfma_f32_16x16x32_bf16 v[64:67], v[32:35], v[128:131], v[64:67]
    ds_read_b64_tr_b16 v[32:33], v11 offset:5184
    ds_read_b64_tr_b16 v[34:35], v11 offset:6464
    s_waitcnt lgkmcnt(6)
    v_mfma_f32_16x16x32_bf16 v[68:71], v[20:23], v[124:127], v[68:71]
    v_mfma_f32_16x16x32_bf16 v[72:75], v[20:23], v[128:131], v[72:75]
    s_waitcnt vmcnt(8)
    ds_read_b64_tr_b16 v[20:21], v11 offset:5216
    ds_read_b64_tr_b16 v[22:23], v11 offset:6496
    s_waitcnt lgkmcnt(6)
    v_mfma_f32_16x16x32_bf16 v[36:39], v[24:27], v[132:135], v[36:39]
    v_mfma_f32_16x16x32_bf16 v[40:43], v[24:27], v[136:139], v[40:43]
    ds_read_b64_tr_b16 v[24:25], v11 offset:5248
    ds_read_b64_tr_b16 v[26:27], v11 offset:6528
    s_waitcnt lgkmcnt(6)
    v_mfma_f32_16x16x32_bf16 v[44:47], v[28:31], v[132:135], v[44:47]
    v_mfma_f32_16x16x32_bf16 v[48:51], v[28:31], v[136:139], v[48:51]
    ds_read_b64_tr_b16 v[28:29], v11 offset:10240
    ds_read_b64_tr_b16 v[30:31], v11 offset:11520
    s_waitcnt lgkmcnt(6)
    v_mfma_f32_16x16x32_bf16 v[52:55], v[32:35], v[132:135], v[52:55]
    v_mfma_f32_16x16x32_bf16 v[56:59], v[32:35], v[136:139], v[56:59]
    ds_read_b64_tr_b16 v[32:33], v11 offset:10272
    ds_read_b64_tr_b16 v[34:35], v11 offset:11552
    s_waitcnt lgkmcnt(6)
    v_mfma_f32_16x16x32_bf16 v[60:63], v[20:23], v[132:135], v[60:63]
    v_mfma_f32_16x16x32_bf16 v[64:67], v[20:23], v[136:139], v[64:67]
    ds_read_b64_tr_b16 v[20:21], v11 offset:10304
    ds_read_b64_tr_b16 v[22:23], v11 offset:11584
    s_waitcnt lgkmcnt(6)
    v_mfma_f32_16x16x32_bf16 v[68:71], v[24:27], v[132:135], v[68:71]
    v_mfma_f32_16x16x32_bf16 v[72:75], v[24:27], v[136:139], v[72:75]
    s_waitcnt vmcnt(4)
    ds_read_b64_tr_b16 v[24:25], v11 offset:10336
    ds_read_b64_tr_b16 v[26:27], v11 offset:11616
    s_waitcnt lgkmcnt(6)
    v_mfma_f32_16x16x32_bf16 v[36:39], v[28:31], v[140:143], v[36:39]
    v_mfma_f32_16x16x32_bf16 v[40:43], v[28:31], v[144:147], v[40:43]
    ds_read_b64_tr_b16 v[28:29], v11 offset:10368
    ds_read_b64_tr_b16 v[30:31], v11 offset:11648
    s_waitcnt lgkmcnt(6)
    v_mfma_f32_16x16x32_bf16 v[44:47], v[32:35], v[140:143], v[44:47]
    v_mfma_f32_16x16x32_bf16 v[48:51], v[32:35], v[144:147], v[48:51]
    ds_read_b64_tr_b16 v[32:33], v11 offset:15360
    ds_read_b64_tr_b16 v[34:35], v11 offset:16640
    s_waitcnt lgkmcnt(6)
    v_mfma_f32_16x16x32_bf16 v[52:55], v[20:23], v[140:143], v[52:55]
    v_mfma_f32_16x16x32_bf16 v[56:59], v[20:23], v[144:147], v[56:59]
    ds_read_b64_tr_b16 v[20:21], v11 offset:15392
    ds_read_b64_tr_b16 v[22:23], v11 offset:16672
    s_waitcnt lgkmcnt(6)
    v_mfma_f32_16x16x32_bf16 v[60:63], v[24:27], v[140:143], v[60:63]
    v_mfma_f32_16x16x32_bf16 v[64:67], v[24:27], v[144:147], v[64:67]
    ds_read_b64_tr_b16 v[24:25], v11 offset:15424
    ds_read_b64_tr_b16 v[26:27], v11 offset:16704
    s_waitcnt lgkmcnt(6)
    v_mfma_f32_16x16x32_bf16 v[68:71], v[28:31], v[140:143], v[68:71]
    v_mfma_f32_16x16x32_bf16 v[72:75], v[28:31], v[144:147], v[72:75]
    s_waitcnt vmcnt(0)
    ds_read_b64_tr_b16 v[28:29], v11 offset:15456
    ds_read_b64_tr_b16 v[30:31], v11 offset:16736
    s_waitcnt lgkmcnt(6)
    v_mfma_f32_16x16x32_bf16 v[36:39], v[32:35], v[148:151], v[36:39]
    v_mfma_f32_16x16x32_bf16 v[40:43], v[32:35], v[152:155], v[40:43]
    ds_read_b64_tr_b16 v[32:33], v11 offset:15488
    ds_read_b64_tr_b16 v[34:35], v11 offset:16768
    s_waitcnt lgkmcnt(6)
    v_mfma_f32_16x16x32_bf16 v[44:47], v[20:23], v[148:151], v[44:47]
    v_mfma_f32_16x16x32_bf16 v[48:51], v[20:23], v[152:155], v[48:51]
    s_waitcnt lgkmcnt(4)
    v_mfma_f32_16x16x32_bf16 v[52:55], v[24:27], v[148:151], v[52:55]
    v_mfma_f32_16x16x32_bf16 v[56:59], v[24:27], v[152:155], v[56:59]
    s_waitcnt lgkmcnt(2)
    v_mfma_f32_16x16x32_bf16 v[60:63], v[28:31], v[148:151], v[60:63]
    v_mfma_f32_16x16x32_bf16 v[64:67], v[28:31], v[152:155], v[64:67]
    s_waitcnt lgkmcnt(0)
    v_mfma_f32_16x16x32_bf16 v[68:71], v[32:35], v[148:151], v[68:71]
    v_mfma_f32_16x16x32_bf16 v[72:75], v[32:35], v[152:155], v[72:75]
    v_cvt_pk_bf16_f32 v76, v36, v37
    v_cvt_pk_bf16_f32 v77, v38, v39
    v_cvt_pk_bf16_f32 v78, v44, v45
    v_cvt_pk_bf16_f32 v79, v46, v47
    s_nop 0
    v_permlane16_swap_b32 v76, v78
    v_permlane16_swap_b32 v77, v79
    buffer_store_dwordx4 v[76:79], v6, s[12:15], 0 offen offset:0
    v_cvt_pk_bf16_f32 v80, v52, v53
    v_cvt_pk_bf16_f32 v81, v54, v55
    v_cvt_pk_bf16_f32 v82, v60, v61
    v_cvt_pk_bf16_f32 v83, v62, v63
    s_nop 0
    v_permlane16_swap_b32 v80, v82
    v_permlane16_swap_b32 v81, v83
    buffer_store_dwordx4 v[80:83], v6, s[12:15], 0 offen offset:64
    v_cvt_pk_bf16_f32 v84, v68, v69
    v_cvt_pk_bf16_f32 v85, v70, v71
    buffer_store_dwordx2 v[84:85], v7, s[12:15], 0 offen offset:128
    v_cvt_pk_bf16_f32 v88, v40, v41
    v_cvt_pk_bf16_f32 v89, v42, v43
    v_cvt_pk_bf16_f32 v90, v48, v49
    v_cvt_pk_bf16_f32 v91, v50, v51
    s_nop 0
    v_permlane16_swap_b32 v88, v90
    v_permlane16_swap_b32 v89, v91
    buffer_store_dwordx4 v[88:91], v6, s[12:15], s43 offen offset:0
    v_cvt_pk_bf16_f32 v92, v56, v57
    v_cvt_pk_bf16_f32 v93, v58, v59
    v_cvt_pk_bf16_f32 v94, v64, v65
    v_cvt_pk_bf16_f32 v95, v66, v67
    s_nop 0
    v_permlane16_swap_b32 v92, v94
    v_permlane16_swap_b32 v93, v95
    buffer_store_dwordx4 v[92:95], v6, s[12:15], s43 offen offset:64
    v_cvt_pk_bf16_f32 v96, v72, v73
    v_cvt_pk_bf16_f32 v97, v74, v75
    buffer_store_dwordx2 v[96:97], v7, s[12:15], s43 offen offset:128
k23_rest_121:
    s_endpgm
k2_slow_119:
    s_waitcnt vmcnt(0)
    v_mov_b32 v13, 0xff800000
    s_mov_b32 s58, 0
k2s_p1_127:
    s_mul_i32 s59, s58, 1280
    v_add_u32 v9, s59, v2
    v_add_u32 v10, s59, v3
    ds_read_b64 v[86:87], v9 offset:0
    ds_read_b64 v[88:89], v9 offset:512
    ds_read_b64 v[94:95], v10 offset:1024
    s_cmp_eq_u32 s58, 8
    s_cbranch_scc1 k2s_l_130
    s_cmp_gt_u32 s27, s58
    s_cbranch_scc1 k2s_n_131
    s_cmp_eq_u32 s58, 0
    s_cbranch_scc1 k2s_f_129
    v_mov_b32 v16, 0
    v_mov_b32 v17, 0
    v_mov_b32 v18, 0
    v_mov_b32 v19, 0
    v_mov_b32 v20, 0
    v_mov_b32 v21, 0
    v_mov_b32 v22, 0
    v_mov_b32 v23, 0
    v_mov_b32 v24, 0
    v_mov_b32 v25, 0
    v_mov_b32 v26, 0
    v_mov_b32 v27, 0
    v_mov_b32 v28, 0
    v_mov_b32 v29, 0
    v_mov_b32 v30, 0
    v_mov_b32 v31, 0
    s_branch k2s_j_132
k2s_n_131:
    v_mov_b32 v16, 0xff800000
    v_mov_b32 v17, 0xff800000
    v_mov_b32 v18, 0xff800000
    v_mov_b32 v19, 0xff800000
    v_mov_b32 v20, 0xff800000
    v_mov_b32 v21, 0xff800000
    v_mov_b32 v22, 0xff800000
    v_mov_b32 v23, 0xff800000
    v_mov_b32 v24, 0xff800000
    v_mov_b32 v25, 0xff800000
    v_mov_b32 v26, 0xff800000
    v_mov_b32 v27, 0xff800000
    v_mov_b32 v28, 0xff800000
    v_mov_b32 v29, 0xff800000
    v_mov_b32 v30, 0xff800000
    v_mov_b32 v31, 0xff800000
    s_branch k2s_j_132
k2s_f_129:
    v_lshlrev_b32 v14, 2, v11
    v_sub_u32 v14, v12, v14
    v_mov_b32 v15, 0xff800000
    v_cmp_gt_i32 s[46:47], 0, v14
    s_nop 1
    v_cndmask_b32 v16, v15, 0, s[46:47]
    v_cmp_gt_i32 s[48:49], 1, v14
    s_nop 1
    v_cndmask_b32 v17, v15, 0, s[48:49]
    v_cmp_gt_i32 s[46:47], 2, v14
    s_nop 1
    v_cndmask_b32 v18, v15, 0, s[46:47]
    v_cmp_gt_i32 s[48:49], 3, v14
    s_nop 1
    v_cndmask_b32 v19, v15, 0, s[48:49]
    v_cmp_gt_i32 s[46:47], 16, v14
    s_nop 1
    v_cndmask_b32 v20, v15, 0, s[46:47]
    v_cmp_gt_i32 s[48:49], 17, v14
    s_nop 1
    v_cndmask_b32 v21, v15, 0, s[48:49]
    v_cmp_gt_i32 s[46:47], 18, v14
    s_nop 1
    v_cndmask_b32 v22, v15, 0, s[46:47]
    v_cmp_gt_i32 s[48:49], 19, v14
    s_nop 1
    v_cndmask_b32 v23, v15, 0, s[48:49]
    v_cmp_gt_i32 s[46:47], 8, v14
    s_nop 1
    v_cndmask_b32 v24, v15, 0, s[46:47]
    v_cmp_gt_i32 s[48:49], 9, v14
    s_nop 1
    v_cndmask_b32 v25, v15, 0, s[48:49]
    v_cmp_gt_i32 s[46:47], 10, v14
    s_nop 1
    v_cndmask_b32 v26, v15, 0, s[46:47]
    v_cmp_gt_i32 s[48:49], 11, v14
    s_nop 1
    v_cndmask_b32 v27, v15, 0, s[48:49]
    v_cmp_gt_i32 s[46:47], 24, v14
    s_nop 1
    v_cndmask_b32 v28, v15, 0, s[46:47]
    v_cmp_gt_i32 s[48:49], 25, v14
    s_nop 1
    v_cndmask_b32 v29, v15, 0, s[48:49]
    v_cmp_gt_i32 s[46:47], 26, v14
    s_nop 1
    v_cndmask_b32 v30, v15, 0, s[46:47]
    v_cmp_gt_i32 s[48:49], 27, v14
    s_nop 1
    v_cndmask_b32 v31, v15, 0, s[48:49]
    s_branch k2s_j_132
k2s_l_130:
    v_lshlrev_b32 v14, 2, v11
    v_sub_u32 v14, v12, v14
    v_mov_b32 v15, 0xff800000
    v_cmp_gt_i32 s[46:47], 0, v14
    s_nop 1
    v_cndmask_b32 v16, 0, v15, s[46:47]
    v_cmp_gt_i32 s[48:49], 1, v14
    s_nop 1
    v_cndmask_b32 v17, 0, v15, s[48:49]
    v_cmp_gt_i32 s[46:47], 2, v14
    s_nop 1
    v_cndmask_b32 v18, 0, v15, s[46:47]
    v_cmp_gt_i32 s[48:49], 3, v14
    s_nop 1
    v_cndmask_b32 v19, 0, v15, s[48:49]
    v_cmp_gt_i32 s[46:47], 16, v14
    s_nop 1
    v_cndmask_b32 v20, 0, v15, s[46:47]
    v_cmp_gt_i32 s[48:49], 17, v14
    s_nop 1
    v_cndmask_b32 v21, 0, v15, s[48:49]
    v_cmp_gt_i32 s[46:47], 18, v14
    s_nop 1
    v_cndmask_b32 v22, 0, v15, s[46:47]
    v_cmp_gt_i32 s[48:49], 19, v14
    s_nop 1
    v_cndmask_b32 v23, 0, v15, s[48:49]
    v_cmp_gt_i32 s[46:47], 8, v14
    s_nop 1
    v_cndmask_b32 v24, 0, v15, s[46:47]
    v_cmp_gt_i32 s[48:49], 9, v14
    s_nop 1
    v_cndmask_b32 v25, 0, v15, s[48:49]
    v_cmp_gt_i32 s[46:47], 10, v14
    s_nop 1
    v_cndmask_b32 v26, 0, v15, s[46:47]
    v_cmp_gt_i32 s[48:49], 11, v14
    s_nop 1
    v_cndmask_b32 v27, 0, v15, s[48:49]
    v_cmp_gt_i32 s[46:47], 24, v14
    s_nop 1
    v_cndmask_b32 v28, 0, v15, s[46:47]
    v_cmp_gt_i32 s[48:49], 25, v14
    s_nop 1
    v_cndmask_b32 v29, 0, v15, s[48:49]
    v_cmp_gt_i32 s[46:47], 26, v14
    s_nop 1
    v_cndmask_b32 v30, 0, v15, s[46:47]
    v_cmp_gt_i32 s[48:49], 27, v14
    s_nop 1
    v_cndmask_b32 v31, 0, v15, s[48:49]
k2s_j_132:
    s_waitcnt lgkmcnt(0)
    s_nop 1
    v_mfma_f32_32x32x16_bf16 v[32:47], v[86:89], v[80:83], v[16:31]
    v_mfma_f32_32x32x8bf16_1k v[32:47], v[94:95], v[84:85], v[32:47]
    s_nop 15
    v_max_f32 v13, v13, v32
    v_max_f32 v13, v13, v33
    v_max_f32 v13, v13, v34
    v_max_f32 v13, v13, v35
    v_max_f32 v13, v13, v36
    v_max_f32 v13, v13, v37
    v_max_f32 v13, v13, v38
    v_max_f32 v13, v13, v39
    v_max_f32 v13, v13, v40
    v_max_f32 v13, v13, v41
    v_max_f32 v13, v13, v42
    v_max_f32 v13, v13, v43
    v_max_f32 v13, v13, v44
    v_max_f32 v13, v13, v45
    v_max_f32 v13, v13, v46
    v_max_f32 v13, v13, v47
    s_add_u32 s58, s58, 1
    s_cmp_le_u32 s58, 8
    s_cbranch_scc1 k2s_p1_127
    v_mov_b32 v9, v13
    s_nop 1
    v_permlane32_swap_b32 v9, v13
    s_nop 1
    v_max_f32 v13, v13, v9
    v_mov_b32 v64, 0
    v_mov_b32 v65, 0
    v_mov_b32 v66, 0
    v_mov_b32 v67, 0
    v_mov_b32 v68, 0
    v_mov_b32 v69, 0
    v_mov_b32 v70, 0
    v_mov_b32 v71, 0
    v_mov_b32 v72, 0
    v_mov_b32 v73, 0
    v_mov_b32 v74, 0
    v_mov_b32 v75, 0
    v_mov_b32 v76, 0
    v_mov_b32 v77, 0
    v_mov_b32 v78, 0
    v_mov_b32 v79, 0
    s_mov_b32 s58, 0
k2s_p2_133:
    s_mul_i32 s59, s58, 1280
    v_add_u32 v9, s59, v2
    v_add_u32 v10, s59, v3
    ds_read_b64 v[86:87], v9 offset:0
    ds_read_b64 v[88:89], v9 offset:512
    ds_read_b64 v[94:95], v10 offset:1024
    s_cmp_eq_u32 s58, 8
    s_cbranch_scc1 k2s_l_136
    s_cmp_gt_u32 s27, s58
    s_cbranch_scc1 k2s_n_137
    s_cmp_eq_u32 s58, 0
    s_cbranch_scc1 k2s_f_135
    v_mov_b32 v16, 0
    v_mov_b32 v17, 0
    v_mov_b32 v18, 0
    v_mov_b32 v19, 0
    v_mov_b32 v20, 0
    v_mov_b32 v21, 0
    v_mov_b32 v22, 0
    v_mov_b32 v23, 0
    v_mov_b32 v24, 0
    v_mov_b32 v25, 0
    v_mov_b32 v26, 0
    v_mov_b32 v27, 0
    v_mov_b32 v28, 0
    v_mov_b32 v29, 0
    v_mov_b32 v30, 0
    v_mov_b32 v31, 0
    s_branch k2s_j_138
k2s_n_137:
    v_mov_b32 v16, 0xff800000
    v_mov_b32 v17, 0xff800000
    v_mov_b32 v18, 0xff800000
    v_mov_b32 v19, 0xff800000
    v_mov_b32 v20, 0xff800000
    v_mov_b32 v21, 0xff800000
    v_mov_b32 v22, 0xff800000
    v_mov_b32 v23, 0xff800000
    v_mov_b32 v24, 0xff800000
    v_mov_b32 v25, 0xff800000
    v_mov_b32 v26, 0xff800000
    v_mov_b32 v27, 0xff800000
    v_mov_b32 v28, 0xff800000
    v_mov_b32 v29, 0xff800000
    v_mov_b32 v30, 0xff800000
    v_mov_b32 v31, 0xff800000
    s_branch k2s_j_138
k2s_f_135:
    v_lshlrev_b32 v14, 2, v11
    v_sub_u32 v14, v12, v14
    v_mov_b32 v15, 0xff800000
    v_cmp_gt_i32 s[46:47], 0, v14
    s_nop 1
    v_cndmask_b32 v16, v15, 0, s[46:47]
    v_cmp_gt_i32 s[48:49], 1, v14
    s_nop 1
    v_cndmask_b32 v17, v15, 0, s[48:49]
    v_cmp_gt_i32 s[46:47], 2, v14
    s_nop 1
    v_cndmask_b32 v18, v15, 0, s[46:47]
    v_cmp_gt_i32 s[48:49], 3, v14
    s_nop 1
    v_cndmask_b32 v19, v15, 0, s[48:49]
    v_cmp_gt_i32 s[46:47], 16, v14
    s_nop 1
    v_cndmask_b32 v20, v15, 0, s[46:47]
    v_cmp_gt_i32 s[48:49], 17, v14
    s_nop 1
    v_cndmask_b32 v21, v15, 0, s[48:49]
    v_cmp_gt_i32 s[46:47], 18, v14
    s_nop 1
    v_cndmask_b32 v22, v15, 0, s[46:47]
    v_cmp_gt_i32 s[48:49], 19, v14
    s_nop 1
    v_cndmask_b32 v23, v15, 0, s[48:49]
    v_cmp_gt_i32 s[46:47], 8, v14
    s_nop 1
    v_cndmask_b32 v24, v15, 0, s[46:47]
    v_cmp_gt_i32 s[48:49], 9, v14
    s_nop 1
    v_cndmask_b32 v25, v15, 0, s[48:49]
    v_cmp_gt_i32 s[46:47], 10, v14
    s_nop 1
    v_cndmask_b32 v26, v15, 0, s[46:47]
    v_cmp_gt_i32 s[48:49], 11, v14
    s_nop 1
    v_cndmask_b32 v27, v15, 0, s[48:49]
    v_cmp_gt_i32 s[46:47], 24, v14
    s_nop 1
    v_cndmask_b32 v28, v15, 0, s[46:47]
    v_cmp_gt_i32 s[48:49], 25, v14
    s_nop 1
    v_cndmask_b32 v29, v15, 0, s[48:49]
    v_cmp_gt_i32 s[46:47], 26, v14
    s_nop 1
    v_cndmask_b32 v30, v15, 0, s[46:47]
    v_cmp_gt_i32 s[48:49], 27, v14
    s_nop 1
    v_cndmask_b32 v31, v15, 0, s[48:49]
    s_branch k2s_j_138
k2s_l_136:
    v_lshlrev_b32 v14, 2, v11
    v_sub_u32 v14, v12, v14
    v_mov_b32 v15, 0xff800000
    v_cmp_gt_i32 s[46:47], 0, v14
    s_nop 1
    v_cndmask_b32 v16, 0, v15, s[46:47]
    v_cmp_gt_i32 s[48:49], 1, v14
    s_nop 1
    v_cndmask_b32 v17, 0, v15, s[48:49]
    v_cmp_gt_i32 s[46:47], 2, v14
    s_nop 1
    v_cndmask_b32 v18, 0, v15, s[46:47]
    v_cmp_gt_i32 s[48:49], 3, v14
    s_nop 1
    v_cndmask_b32 v19, 0, v15, s[48:49]
    v_cmp_gt_i32 s[46:47], 16, v14
    s_nop 1
    v_cndmask_b32 v20, 0, v15, s[46:47]
    v_cmp_gt_i32 s[48:49], 17, v14
    s_nop 1
    v_cndmask_b32 v21, 0, v15, s[48:49]
    v_cmp_gt_i32 s[46:47], 18, v14
    s_nop 1
    v_cndmask_b32 v22, 0, v15, s[46:47]
    v_cmp_gt_i32 s[48:49], 19, v14
    s_nop 1
    v_cndmask_b32 v23, 0, v15, s[48:49]
    v_cmp_gt_i32 s[46:47], 8, v14
    s_nop 1
    v_cndmask_b32 v24, 0, v15, s[46:47]
    v_cmp_gt_i32 s[48:49], 9, v14
    s_nop 1
    v_cndmask_b32 v25, 0, v15, s[48:49]
    v_cmp_gt_i32 s[46:47], 10, v14
    s_nop 1
    v_cndmask_b32 v26, 0, v15, s[46:47]
    v_cmp_gt_i32 s[48:49], 11, v14
    s_nop 1
    v_cndmask_b32 v27, 0, v15, s[48:49]
    v_cmp_gt_i32 s[46:47], 24, v14
    s_nop 1
    v_cndmask_b32 v28, 0, v15, s[46:47]
    v_cmp_gt_i32 s[48:49], 25, v14
    s_nop 1
    v_cndmask_b32 v29, 0, v15, s[48:49]
    v_cmp_gt_i32 s[46:47], 26, v14
    s_nop 1
    v_cndmask_b32 v30, 0, v15, s[46:47]
    v_cmp_gt_i32 s[48:49], 27, v14
    s_nop 1
    v_cndmask_b32 v31, 0, v15, s[48:49]
k2s_j_138:
    s_waitcnt lgkmcnt(0)
    s_nop 1
    v_mfma_f32_32x32x16_bf16 v[32:47], v[86:89], v[80:83], v[16:31]
    v_mfma_f32_32x32x8bf16_1k v[32:47], v[94:95], v[84:85], v[32:47]
    s_nop 15
    s_mul_i32 s59, s58, 1280
    v_add_u32 v9, s59, v4
    s_mov_b32 exec_lo, 0xfffff
    s_mov_b32 exec_hi, 0xfffff
    ds_read_b128 v[98:101], v9
    ds_read_b128 v[102:105], v9 offset:640
    s_mov_b64 exec, -1
    v_sub_f32 v32, v32, v13
    v_sub_f32 v33, v33, v13
    v_sub_f32 v34, v34, v13
    v_sub_f32 v35, v35, v13
    v_sub_f32 v36, v36, v13
    v_sub_f32 v37, v37, v13
    v_sub_f32 v38, v38, v13
    v_sub_f32 v39, v39, v13
    v_sub_f32 v40, v40, v13
    v_sub_f32 v41, v41, v13
    v_sub_f32 v42, v42, v13
    v_sub_f32 v43, v43, v13
    v_sub_f32 v44, v44, v13
    v_sub_f32 v45, v45, v13
    v_sub_f32 v46, v46, v13
    v_sub_f32 v47, v47, v13
    v_exp_f32 v32, v32
    v_exp_f32 v33, v33
    v_exp_f32 v34, v34
    v_exp_f32 v35, v35
    v_exp_f32 v36, v36
    v_exp_f32 v37, v37
    v_exp_f32 v38, v38
    v_exp_f32 v39, v39
    v_exp_f32 v40, v40
    v_exp_f32 v41, v41
    v_exp_f32 v42, v42
    v_exp_f32 v43, v43
    v_exp_f32 v44, v44
    v_exp_f32 v45, v45
    v_exp_f32 v46, v46
    v_exp_f32 v47, v47
    s_nop 0
    v_cvt_pk_bf16_f32 v106, v32, v33
    v_cvt_pk_bf16_f32 v107, v34, v35
    v_cvt_pk_bf16_f32 v108, v36, v37
    v_cvt_pk_bf16_f32 v109, v38, v39
    v_cvt_pk_bf16_f32 v110, v40, v41
    v_cvt_pk_bf16_f32 v111, v42, v43
    v_cvt_pk_bf16_f32 v112, v44, v45
    v_cvt_pk_bf16_f32 v113, v46, v47
    s_waitcnt lgkmcnt(0)
    s_nop 1
    v_mfma_f32_32x32x16_bf16 v[64:79], v[98:101], v[106:109], v[64:79]
    v_mfma_f32_32x32x16_bf16 v[64:79], v[102:105], v[110:113], v[64:79]
    s_nop 15
    s_add_u32 s58, s58, 1
    s_cmp_le_u32 s58, 8
    s_cbranch_scc1 k2s_p2_133
    v_cndmask_b32 v7, v72, v76, s[38:39]
    s_nop 1
    s_branch k2_fin_120
k2_end_82:
    s_endpgm
code_end_label:
.section .rodata,"a"
.p2align 6
.amdhsa_kernel concat_heads__linear_attn_block__sliding_block__prompt_kernel
  .amdhsa_next_free_vgpr 168
  .amdhsa_next_free_sgpr 102
  .amdhsa_accum_offset 168
  .amdhsa_group_segment_fixed_size 0
  .amdhsa_kernarg_size 72
  .amdhsa_user_sgpr_count 2
  .amdhsa_user_sgpr_kernarg_segment_ptr 1
  .amdhsa_system_sgpr_workgroup_id_x 1
  .amdhsa_float_denorm_mode_32 3
.end_amdhsa_kernel
.text
```
